```python
import torch

def _softmax(x, axis=-1):
    return torch.softmax(x, dim=axis)
def _gelu(x):
    return torch.nn.functional.gelu(x, approximate="tanh")
def _silu(x):
    return torch.nn.functional.silu(x)
def _sigmoid(x):
    return torch.sigmoid(x)
def _layernorm(x, axis=-1, eps=1e-5):
    m = x.mean(dim=axis, keepdim=True)
    v = x.var(dim=axis, keepdim=True, unbiased=False)
    return (x - m) / torch.sqrt(v + eps)
def _scatter_add(tgt, idx, src, axis=0):
    return tgt.clone().index_add_(axis, idx, src)
def _segment_sum(src, seg, n):
    out = torch.zeros((n,) + src.shape[1:], dtype=src.dtype)
    return out.index_add_(0, seg, src)
def _pad(x, pw):
    flat = tuple(v for pair in reversed(pw) for v in pair)
    return torch.nn.functional.pad(x, flat)

kernel_name = 'parallel_sum__spectral_gfnet__glu_gated_bilinear__prompt'

def setup_inputs():

    _w = (lambda a: (lambda t: t.to(torch.bfloat16) if t.is_floating_point() else t)(torch.as_tensor(a)))
    def _A_setup():
        B, S, D = 1, 2048, 512
        Df = D // 2 + 1
        return {
            "x": _w((lambda *s: torch.randn(*s, dtype=torch.bfloat16) * 0.05)(B, S, D)),
            "w_r": _w((lambda *s: torch.randn(*s, dtype=torch.bfloat16) * 0.4)(S, Df) * 0.02),
            "w_i": _w((lambda *s: torch.randn(*s, dtype=torch.bfloat16) * 0.4)(S, Df) * 0.02),
        }
    _A_in = _A_setup()

    def _B_setup():
        B, S, D, F = 1, 2048, 512, 1792
        return {
            "x": _w((lambda *s: torch.randn(*s, dtype=torch.bfloat16) * 0.05)(B, S, D)),
            "w_gate": _w((lambda *s: torch.randn(*s, dtype=torch.bfloat16) * 0.2)(D, F) * (D ** -0.5)),
            "w_up": _w((lambda *s: torch.randn(*s, dtype=torch.bfloat16) * 0.2)(D, F) * (D ** -0.5)),
            "w_down": _w((lambda *s: torch.randn(*s, dtype=torch.bfloat16) * 0.2)(F, D) * (F ** -0.5)),
        }
    _B_in = _B_setup()

    return {
        "A_x": _A_in["x"],
        "A_w_r": _A_in["w_r"],
        "A_w_i": _A_in["w_i"],
        "B_x": _B_in["x"],
        "B_w_gate": _B_in["w_gate"],
        "B_w_up": _B_in["w_up"],
        "B_w_down": _B_in["w_down"],
    }

def reference(A_x, A_w_r, A_w_i, B_x, B_w_gate, B_w_up, B_w_down):
    def _A_ref(x, w_r, w_i):
        B, S, D = x.shape
        X = (lambda x, axes=(-2,-1): torch.fft.rfft2(x.float(), dim=axes))(x, axes=(-2, -1))
        W = w_r + 1j * w_i
        X = X * W
        y = (lambda x, s, axes=(-2,-1): torch.fft.irfft2(x, s=s, dim=axes).to(torch.bfloat16))(X, (S, D), axes=(-2, -1))
        return y

    def _B_ref(x, w_gate, w_up, w_down):
        g = torch.einsum("bsd,df->bsf", x, w_gate)
        u = torch.einsum("bsd,df->bsf", x, w_up)
        h = g * u
        return torch.einsum("bsf,fd->bsd", h, w_down)

    x = A_x
    xn = _layernorm(x, axis=-1)
    return x + _A_ref(xn, A_w_r, A_w_i) + _B_ref(xn, B_w_gate, B_w_up, B_w_down)
```

```asm
; @launch grid=(256,1,1) block=(256,1,1) lds=163840
.amdgcn_target "amdgcn-amd-amdhsa--gfx950"
.text
.globl parallel_sum__spectral_gfnet__glu_gated_bilinear__prompt_kernel
.p2align 8
.type parallel_sum__spectral_gfnet__glu_gated_bilinear__prompt_kernel,@function
parallel_sum__spectral_gfnet__glu_gated_bilinear__prompt_kernel:
    s_cmp_ge_u32 s2, 256
    s_cbranch_scc1 L_end
    s_load_dwordx16 s[64:79], s[0:1], 0
    s_load_dwordx4 s[80:83], s[0:1], 64
    s_memrealtime s[60:61]
    v_lshrrev_b32 v3, 6, v0
    v_and_b32 v1, 63, v0
    v_readfirstlane_b32 s40, v3
    v_lshlrev_b32 v2, 4, v1
    s_and_b32 s52, s2, 7
    s_lshr_b32 s53, s2, 3
    s_getpc_b64 s[4:5]
L_pc:
    s_lshl_b32 s54, s53, 2
    s_add_u32 s54, s54, s40
    s_min_u32 s54, s54, (L_end-L_pc)/1024-1
    s_lshl_b32 s54, s54, 10
    s_add_u32 s4, s4, s54
    s_addc_u32 s5, s5, 0
    s_and_b32 s4, s4, 0xfffffff0
    v_mov_b32 v49, s5
    v_add_co_u32 v48, vcc, s4, v2
    s_nop 1
    v_addc_co_u32 v49, vcc, 0, v49, vcc
    global_load_dwordx4 v[124:127], v[48:49], off
    s_lshr_b32 s44, s52, 1
    s_and_b32 s41, s52, 1
    s_lshl_b32 s41, s41, 3
    s_and_b32 s48, s53, 7
    s_add_u32 s41, s41, s48
    s_lshr_b32 s43, s53, 3
    s_sub_u32 s43, 3, s43
    s_lshl_b32 s42, s44, 2
    s_add_u32 s42, s42, s43
    s_lshl_b32 s45, s41, 2
    s_add_u32 s45, s45, s40
    s_lshl_b32 s54, s52, 2
    s_add_u32 s49, s54, s43
    s_and_b32 s46, s53, 3
    s_add_u32 s46, s46, s54
    s_lshr_b32 s47, s53, 2
    s_lshl_b32 s50, s40, 12
    s_mul_i32 s56, s44, 7
    s_add_u32 s56, s56, s43
    s_add_u32 s57, s56, 3
    s_lshl_b32 s56, s56, 7
    s_lshl_b32 s57, s57, 7
    s_mul_i32 s94, s43, 3
    s_add_u32 s94, s94, s48
    s_mul_i32 s52, s44, 2
    s_add_u32 s94, s94, s52
    s_and_b32 s94, s94, 0
    s_mul_i32 s94, s94, 1024
    s_mov_b32 s62, 0x80008000
    v_lshrrev_b32 v3, 5, v1
    s_lshl_b32 s52, s42, 17
    s_lshl_b32 s53, s45, 10
    s_add_u32 s52, s52, s53
    v_lshlrev_b32 v35, 16, v3
    v_and_b32 v40, 0x1f0, v2
    v_add3_u32 v35, v35, v40, s52
    v_lshrrev_b32 v40, 3, v1
    v_lshlrev_b32 v40, 16, v40
    v_add_u32 v40, s53, v40
    v_lshrrev_b32 v41, 4, v1
    v_xor_b32 v41, v41, v1
    v_and_b32 v41, 7, v41
    v_lshlrev_b32 v41, 4, v41
    v_xor_b32 v42, 0, v41
    v_add_u32 v8, v40, v42
    v_xor_b32 v42, 64, v41
    v_add_u32 v9, v40, v42
    v_add_u32 v9, 0x7fc00, v9
    v_xor_b32 v42, 0, v41
    v_add_u32 v10, v40, v42
    v_add_u32 v10, 0xff800, v10
    v_xor_b32 v42, 64, v41
    v_add_u32 v11, v40, v42
    v_add_u32 v11, 0x17f400, v11
    s_and_b32 s52, s40, 1
    s_lshr_b32 s54, s40, 1
    s_cmp_eq_u32 s54, 0
    s_cselect_b32 s4, s56, s57
    s_cmp_eq_u32 s43, 3
    s_cselect_b32 s58, s54, s52
    s_cselect_b32 s52, s52, 0
    s_lshl_b32 s52, s52, 5
    v_lshrrev_b32 v40, 3, v1
    v_add_u32 v40, s52, v40
    v_mul_u32_u24 v40, 3584, v40
    v_bfe_u32 v41, v1, 4, 1
    v_lshlrev_b32 v41, 6, v41
    v_and_b32 v42, 0x70, v2
    v_xor_b32 v41, v41, v42
    s_lshl_b32 s52, s58, 5
    v_xor_b32 v41, s52, v41
    v_add_u32 v4, v40, v41
    v_add_u32 v5, 0x6c00, v4
    v_add_u32 v6, 0xd800, v4
    v_add_u32 v7, 0x14400, v4
    s_mov_b32 s10, 0x200000
    s_mov_b32 s11, 0x20000
    s_mov_b32 s14, 0x1c0000
    s_mov_b32 s15, 0x20000
    s_mov_b32 s18, 0x1c0000
    s_mov_b32 s19, 0x20000
    s_mov_b32 s22, 0x101000
    s_mov_b32 s23, 0x20000
    s_mov_b32 s26, 0x101000
    s_mov_b32 s27, 0x20000
    s_mov_b32 s30, 0x200000
    s_mov_b32 s31, 0x20000
    s_mov_b32 s34, 0x1000000
    s_mov_b32 s35, 0x20000
    s_mov_b32 s38, 0x100
    s_mov_b32 s39, 0x20000
    s_waitcnt lgkmcnt(0)
    s_mov_b64 s[36:37], s[80:81]
    s_mov_b64 s[8:9], s[64:65]
    s_or_b32 s60, s60, 1
    s_or_b32 s52, s2, s40
    s_cmp_lg_u32 s52, 0
    s_cbranch_scc1 L_nononce
    v_mov_b32 v42, s60
    v_mov_b32 v43, s61
    s_mov_b64 exec, 1
    buffer_store_dwordx2 v[42:43], off, s[36:39], 0 sc1
    s_mov_b64 exec, -1
L_nononce:
    s_cmp_eq_u32 s58, 0
    s_cselect_b64 s[12:13], s[72:73], s[74:75]
    s_mov_b64 s[16:17], s[76:77]
    s_mov_b64 s[20:21], s[66:67]
    s_mov_b64 s[24:25], s[68:69]
    s_mov_b64 s[28:29], s[78:79]
    s_mov_b64 s[32:33], s[82:83]
    s_cmp_eq_u32 s43, 3
    s_cbranch_scc1 L_light
    s_add_u32 m0, s50, 0
    s_add_u32 s51, s94, 0
    s_and_b32 s51, s51, 0x3ff
    buffer_load_dwordx4 v8, s[8:11], s51 offen offset:0 lds
    buffer_load_dwordx4 v9, s[8:11], s51 offen offset:1024 lds
    buffer_load_dwordx4 v10, s[8:11], s51 offen offset:2048 lds
    buffer_load_dwordx4 v11, s[8:11], s51 offen offset:3072 lds
    s_add_u32 m0, s50, 16384
    s_add_u32 s51, s94, 0
    s_and_b32 s51, s51, 0x3ff
    s_mul_i32 s51, s51, 1792
    s_add_u32 s51, s51, s4
    buffer_load_dwordx4 v4, s[12:15], s51 offen offset:0 lds
    buffer_load_dwordx4 v5, s[12:15], s51 offen offset:1024 lds
    buffer_load_dwordx4 v6, s[12:15], s51 offen offset:2048 lds
    buffer_load_dwordx4 v7, s[12:15], s51 offen offset:3072 lds
    buffer_load_dwordx4 v[120:123], v35, s[8:11], 0 offen
    buffer_load_dwordx4 v[124:127], v35, s[8:11], 0 offen offset:512
    s_lshl_b32 s52, s2, 1
    s_lshr_b32 s93, s40, 1
    s_add_u32 s52, s52, s93
    s_mul_i32 s52, s52, 3584
    v_min_u32 v116, 27, v1
    v_lshlrev_b32 v116, 7, v116
    buffer_load_dword v117, v116, s[12:15], s52 offen
    s_lshl_b32 s52, s45, 8
    s_lshl_b32 s93, s42, 4
    s_add_u32 s52, s52, s93
    s_add_u32 s52, s52, 0xc00000
    buffer_load_dword v117, off, s[32:35], s52 sc1
    v_and_b32 v40, 31, v1
    v_lshlrev_b32 v41, 7, v40
    s_and_b32 s53, s50, 8192
    v_add_u32 v41, s53, v41
    v_bfe_u32 v42, v1, 1, 3
    v_lshrrev_b32 v43, 5, v1
    v_xor_b32 v42, v42, v43
    v_xor_b32 v43, 0, v42
    v_lshl_add_u32 v16, v43, 4, v41
    v_xor_b32 v43, 2, v42
    v_lshl_add_u32 v17, v43, 4, v41
    v_xor_b32 v43, 4, v42
    v_lshl_add_u32 v18, v43, 4, v41
    v_xor_b32 v43, 6, v42
    v_lshl_add_u32 v19, v43, 4, v41
    v_bfe_u32 v40, v1, 4, 1
    v_lshlrev_b32 v41, 12, v40
    s_and_b32 s53, s40, 1
    s_lshl_b32 s53, s53, 13
    v_add_u32 v41, s53, v41
    s_and_b32 s54, s40, 2
    v_lshrrev_b32 v42, 5, v1
    v_lshl_add_u32 v41, v42, 10, v41
    v_bfe_u32 v42, v1, 2, 2
    v_lshl_add_u32 v41, v42, 7, v41
    v_and_b32 v43, 3, v1
    v_lshl_add_u32 v41, v43, 3, v41
    v_and_b32 v42, 2, v42
    v_xor_b32 v42, v42, v40
    v_xor_b32 v42, s54, v42
    v_xor_b32 v43, 0, v42
    v_lshl_add_u32 v12, v43, 5, v41
    v_xor_b32 v43, 1, v42
    v_lshl_add_u32 v13, v43, 5, v41
    v_xor_b32 v43, 2, v42
    v_lshl_add_u32 v14, v43, 5, v41
    v_xor_b32 v43, 3, v42
    v_lshl_add_u32 v15, v43, 5, v41
    v_lshrrev_b32 v40, 2, v1
    v_lshrrev_b32 v41, 4, v1
    v_xor_b32 v40, v40, v41
    v_and_b32 v40, 1, v40
    v_subrev_u32 v40, 1, v40
    v_and_b32 v40, 0x3f803f80, v40
    v_accvgpr_write_b32 a248, v40
    v_accvgpr_write_b32 a249, v40
    v_accvgpr_write_b32 a250, v40
    v_accvgpr_write_b32 a251, v40
    s_and_b32 s55, s45, 62
    s_mul_i32 s55, s55, 114688
    s_lshl_b32 s53, s54, 10
    s_add_u32 s55, s55, s53
    s_lshl_b32 s95, s48, 5
    s_add_u32 s95, s95, s49
    s_lshl_b32 s95, s95, 2
    s_add_u32 s95, s95, s40
    s_lshl_b32 s95, s95, 7
    v_and_b32 v59, 1, v1
    v_mul_lo_u32 v59, v59, s62
    v_and_b32 v61, 15, v1
    s_lshl_b32 s53, s40, 4
    v_add_u32 v61, s53, v61
    v_cvt_f32_u32 v61, v61
    v_mul_f32 v61, 0x3c800000, v61
    v_lshrrev_b32 v60, 4, v1
    v_lshlrev_b32 v60, 3, v60
    v_cvt_f32_u32 v60, v60
    v_mul_f32 v60, v60, v61
    v_mov_b32 v40, v60
    v_fmamk_f32 v41, v61, 0x3f800000, v60
    v_fmamk_f32 v42, v61, 0x40000000, v60
    v_fmamk_f32 v43, v61, 0x40400000, v60
    v_cos_f32 v44, v40
    v_cos_f32 v45, v41
    v_cos_f32 v46, v42
    v_cos_f32 v47, v43
    v_sin_f32 v48, v40
    v_sin_f32 v49, v41
    v_sin_f32 v50, v42
    v_sin_f32 v51, v43
    v_cvt_pk_bf16_f32 v52, v44, v45
    v_cvt_pk_bf16_f32 v53, v48, v49
    v_xor_b32 v54, v59, v52
    v_xor_b32 v55, v59, v53
    v_xor_b32 v56, s62, v53
    v_xor_b32 v57, s62, v55
    v_accvgpr_write_b32 a112, v52
    v_accvgpr_write_b32 a120, v53
    v_accvgpr_write_b32 a116, v54
    v_accvgpr_write_b32 a124, v55
    v_accvgpr_write_b32 a128, v56
    v_accvgpr_write_b32 a132, v57
    v_cvt_pk_bf16_f32 v52, v46, v47
    v_cvt_pk_bf16_f32 v53, v50, v51
    v_xor_b32 v54, v59, v52
    v_xor_b32 v55, v59, v53
    v_xor_b32 v56, s62, v53
    v_xor_b32 v57, s62, v55
    v_accvgpr_write_b32 a113, v52
    v_accvgpr_write_b32 a121, v53
    v_accvgpr_write_b32 a117, v54
    v_accvgpr_write_b32 a125, v55
    v_accvgpr_write_b32 a129, v56
    v_accvgpr_write_b32 a133, v57
    v_fmamk_f32 v40, v61, 0x40800000, v60
    v_fmamk_f32 v41, v61, 0x40a00000, v60
    v_fmamk_f32 v42, v61, 0x40c00000, v60
    v_fmamk_f32 v43, v61, 0x40e00000, v60
    v_cos_f32 v44, v40
    v_cos_f32 v45, v41
    v_cos_f32 v46, v42
    v_cos_f32 v47, v43
    v_sin_f32 v48, v40
    v_sin_f32 v49, v41
    v_sin_f32 v50, v42
    v_sin_f32 v51, v43
    v_cvt_pk_bf16_f32 v52, v44, v45
    v_cvt_pk_bf16_f32 v53, v48, v49
    v_xor_b32 v54, v59, v52
    v_xor_b32 v55, v59, v53
    v_xor_b32 v56, s62, v53
    v_xor_b32 v57, s62, v55
    v_accvgpr_write_b32 a114, v52
    v_accvgpr_write_b32 a122, v53
    v_accvgpr_write_b32 a118, v54
    v_accvgpr_write_b32 a126, v55
    v_accvgpr_write_b32 a130, v56
    v_accvgpr_write_b32 a134, v57
    v_cvt_pk_bf16_f32 v52, v46, v47
    v_cvt_pk_bf16_f32 v53, v50, v51
    v_xor_b32 v54, v59, v52
    v_xor_b32 v55, v59, v53
    v_xor_b32 v56, s62, v53
    v_xor_b32 v57, s62, v55
    v_accvgpr_write_b32 a115, v52
    v_accvgpr_write_b32 a123, v53
    v_accvgpr_write_b32 a119, v54
    v_accvgpr_write_b32 a127, v55
    v_accvgpr_write_b32 a131, v56
    v_accvgpr_write_b32 a135, v57
    v_cvt_f32_u32 v40, s49
    v_mul_f32 v40, 0x3d000000, v40
    v_fmac_f32 v60, v40, v61
    v_mov_b32 v40, v60
    v_fmamk_f32 v41, v61, 0x3f800000, v60
    v_fmamk_f32 v42, v61, 0x40000000, v60
    v_fmamk_f32 v43, v61, 0x40400000, v60
    v_cos_f32 v44, v40
    v_cos_f32 v45, v41
    v_cos_f32 v46, v42
    v_cos_f32 v47, v43
    v_sin_f32 v48, v40
    v_sin_f32 v49, v41
    v_sin_f32 v50, v42
    v_sin_f32 v51, v43
    v_cvt_pk_bf16_f32 v52, v44, v45
    v_cvt_pk_bf16_f32 v53, v48, v49
    v_xor_b32 v54, v59, v52
    v_xor_b32 v55, v59, v53
    v_xor_b32 v56, s62, v53
    v_xor_b32 v57, s62, v55
    v_accvgpr_write_b32 a136, v52
    v_accvgpr_write_b32 a144, v53
    v_accvgpr_write_b32 a140, v54
    v_accvgpr_write_b32 a148, v55
    v_accvgpr_write_b32 a152, v56
    v_accvgpr_write_b32 a156, v57
    v_cvt_pk_bf16_f32 v52, v46, v47
    v_cvt_pk_bf16_f32 v53, v50, v51
    v_xor_b32 v54, v59, v52
    v_xor_b32 v55, v59, v53
    v_xor_b32 v56, s62, v53
    v_xor_b32 v57, s62, v55
    v_accvgpr_write_b32 a137, v52
    v_accvgpr_write_b32 a145, v53
    v_accvgpr_write_b32 a141, v54
    v_accvgpr_write_b32 a149, v55
    v_accvgpr_write_b32 a153, v56
    v_accvgpr_write_b32 a157, v57
    v_fmamk_f32 v40, v61, 0x40800000, v60
    v_fmamk_f32 v41, v61, 0x40a00000, v60
    v_fmamk_f32 v42, v61, 0x40c00000, v60
    v_fmamk_f32 v43, v61, 0x40e00000, v60
    v_cos_f32 v44, v40
    v_cos_f32 v45, v41
    v_cos_f32 v46, v42
    v_cos_f32 v47, v43
    v_sin_f32 v48, v40
    v_sin_f32 v49, v41
    v_sin_f32 v50, v42
    v_sin_f32 v51, v43
    v_cvt_pk_bf16_f32 v52, v44, v45
    v_cvt_pk_bf16_f32 v53, v48, v49
    v_xor_b32 v54, v59, v52
    v_xor_b32 v55, v59, v53
    v_xor_b32 v56, s62, v53
    v_xor_b32 v57, s62, v55
    v_accvgpr_write_b32 a138, v52
    v_accvgpr_write_b32 a146, v53
    v_accvgpr_write_b32 a142, v54
    v_accvgpr_write_b32 a150, v55
    v_accvgpr_write_b32 a154, v56
    v_accvgpr_write_b32 a158, v57
    v_cvt_pk_bf16_f32 v52, v46, v47
    v_cvt_pk_bf16_f32 v53, v50, v51
    v_xor_b32 v54, v59, v52
    v_xor_b32 v55, v59, v53
    v_xor_b32 v56, s62, v53
    v_xor_b32 v57, s62, v55
    v_accvgpr_write_b32 a139, v52
    v_accvgpr_write_b32 a147, v53
    v_accvgpr_write_b32 a143, v54
    v_accvgpr_write_b32 a151, v55
    v_accvgpr_write_b32 a155, v56
    v_accvgpr_write_b32 a159, v57
    v_lshrrev_b32 v40, 3, v1
    v_lshlrev_b32 v40, 10, v40
    v_bfe_u32 v41, v1, 4, 1
    v_lshlrev_b32 v41, 6, v41
    v_and_b32 v42, 0x70, v2
    v_xor_b32 v41, v41, v42
    v_add_u32 v96, v40, v41
    v_add_u32 v97, 7168, v96
    v_add_u32 v98, 14336, v96
    v_add_u32 v99, 21504, v96
    s_mul_i32 s59, s40, 458752
    s_lshl_b32 s53, s47, 7
    s_add_u32 s59, s59, s53
    s_mov_b32 s64, 0
    s_mov_b32 s72, 0
    s_mov_b32 s65, 4096
    s_mov_b32 s73, 256
    s_mov_b32 s66, 8192
    s_mov_b32 s74, 512
    s_mov_b32 s67, 12288
    s_mov_b32 s75, 768
    s_mov_b32 s68, 16384
    s_mov_b32 s76, 1024
    s_mov_b32 s69, 20480
    s_mov_b32 s77, 1280
    s_mov_b32 s70, 24576
    s_mov_b32 s78, 1536
    v_lshrrev_b32 v40, 5, v1
    v_bfe_u32 v41, v1, 2, 2
    v_lshlrev_b32 v42, 9, v40
    v_lshl_add_u32 v42, v41, 7, v42
    v_and_b32 v43, 3, v1
    v_lshl_add_u32 v42, v43, 3, v42
    v_add_u32 v42, s50, v42
    v_and_b32 v41, 2, v41
    v_bfe_u32 v43, v1, 4, 1
    v_or_b32 v41, v41, v43
    s_and_b32 s53, s40, 1
    s_lshl_b32 s53, s53, 1
    v_xor_b32 v41, s53, v41
    v_lshl_add_u32 v62, v41, 5, v42
    v_xor_b32 v63, 64, v62
    s_add_u32 m0, s50, 32768
    s_add_u32 s51, s94, 64
    s_and_b32 s51, s51, 0x3ff
    s_mul_i32 s51, s51, 1792
    s_add_u32 s51, s51, s4
    buffer_load_dwordx4 v4, s[12:15], s51 offen offset:0 lds
    buffer_load_dwordx4 v5, s[12:15], s51 offen offset:1024 lds
    buffer_load_dwordx4 v6, s[12:15], s51 offen offset:2048 lds
    buffer_load_dwordx4 v7, s[12:15], s51 offen offset:3072 lds
    s_add_u32 m0, s50, 49152
    s_add_u32 s51, s94, 128
    s_and_b32 s51, s51, 0x3ff
    buffer_load_dwordx4 v8, s[8:11], s51 offen offset:0 lds
    buffer_load_dwordx4 v9, s[8:11], s51 offen offset:1024 lds
    buffer_load_dwordx4 v10, s[8:11], s51 offen offset:2048 lds
    buffer_load_dwordx4 v11, s[8:11], s51 offen offset:3072 lds
    s_waitcnt vmcnt(12)
    s_barrier
    ds_read_b128 a[16:19], v16 offset:0
    ds_read_b64_tr_b16 a[0:1], v12 offset:16384
    ds_read_b64_tr_b16 a[2:3], v12 offset:16896
    ds_read_b64_tr_b16 a[4:5], v13 offset:16384
    ds_read_b64_tr_b16 a[6:7], v13 offset:16896
    ds_read_b64_tr_b16 a[8:9], v14 offset:16384
    ds_read_b64_tr_b16 a[10:11], v14 offset:16896
    ds_read_b64_tr_b16 a[12:13], v15 offset:16384
    ds_read_b64_tr_b16 a[14:15], v15 offset:16896
    ds_read_b128 a[20:23], v16 offset:4096
    s_waitcnt lgkmcnt(0)
    v_mfma_f32_32x32x16_bf16 v[128:143], a[0:3], a[16:19], 0
    ds_read_b128 a[40:43], v17 offset:0
    ds_read_b64_tr_b16 a[24:25], v12 offset:18432
    v_mfma_f32_32x32x16_bf16 v[144:159], a[4:7], a[16:19], 0
    ds_read_b64_tr_b16 a[26:27], v12 offset:18944
    ds_read_b64_tr_b16 a[28:29], v13 offset:18432
    v_mfma_f32_32x32x16_bf16 v[160:175], a[8:11], a[16:19], 0
    ds_read_b64_tr_b16 a[30:31], v13 offset:18944
    ds_read_b64_tr_b16 a[32:33], v14 offset:18432
    v_mfma_f32_32x32x16_bf16 v[176:191], a[12:15], a[16:19], 0
    ds_read_b64_tr_b16 a[34:35], v14 offset:18944
    ds_read_b64_tr_b16 a[36:37], v15 offset:18432
    v_mfma_f32_16x16x32_bf16 v[20:23], a[248:251], a[0:3], 0
    v_mfma_f32_32x32x16_bf16 v[192:207], a[0:3], a[20:23], 0
    ds_read_b64_tr_b16 a[38:39], v15 offset:18944
    ds_read_b128 a[44:47], v17 offset:4096
    v_mfma_f32_32x32x16_bf16 v[208:223], a[4:7], a[20:23], 0
    buffer_load_dwordx2 v[36:37], off, s[36:39], 0 sc1
    v_mfma_f32_32x32x16_bf16 v[224:239], a[8:11], a[20:23], 0
    v_mfma_f32_32x32x16_bf16 v[240:255], a[12:15], a[20:23], 0
    v_mfma_f32_16x16x32_bf16 v[88:91], a[248:251], a[4:7], 0
    s_waitcnt lgkmcnt(0)
    v_mfma_f32_32x32x16_bf16 v[128:143], a[24:27], a[40:43], v[128:143]
    s_add_u32 m0, s50, 65536
    s_add_u32 s51, s94, 128
    s_and_b32 s51, s51, 0x3ff
    s_mul_i32 s51, s51, 1792
    s_add_u32 s51, s51, s4
    buffer_load_dwordx4 v4, s[12:15], s51 offen offset:0 lds
    buffer_load_dwordx4 v5, s[12:15], s51 offen offset:1024 lds
    buffer_load_dwordx4 v6, s[12:15], s51 offen offset:2048 lds
    buffer_load_dwordx4 v7, s[12:15], s51 offen offset:3072 lds
    s_add_u32 m0, s50, 81920
    s_add_u32 s51, s94, 192
    s_and_b32 s51, s51, 0x3ff
    s_mul_i32 s51, s51, 1792
    s_add_u32 s51, s51, s4
    buffer_load_dwordx4 v4, s[12:15], s51 offen offset:0 lds
    s_waitcnt vmcnt(10)
    s_barrier
    ds_read_b128 a[16:19], v18 offset:0
    ds_read_b64_tr_b16 a[0:1], v12 offset:32768
    buffer_load_dwordx4 v5, s[12:15], s51 offen offset:1024 lds
    v_mfma_f32_32x32x16_bf16 v[144:159], a[28:31], a[40:43], v[144:159]
    ds_read_b64_tr_b16 a[2:3], v12 offset:33280
    ds_read_b64_tr_b16 a[4:5], v13 offset:32768
    v_mfma_f32_32x32x16_bf16 v[160:175], a[32:35], a[40:43], v[160:175]
    ds_read_b64_tr_b16 a[6:7], v13 offset:33280
    ds_read_b64_tr_b16 a[8:9], v14 offset:32768
    buffer_load_dwordx4 v6, s[12:15], s51 offen offset:2048 lds
    v_mfma_f32_32x32x16_bf16 v[176:191], a[36:39], a[40:43], v[176:191]
    ds_read_b64_tr_b16 a[10:11], v14 offset:33280
    ds_read_b64_tr_b16 a[12:13], v15 offset:32768
    v_mfma_f32_16x16x32_bf16 v[20:23], a[248:251], a[24:27], v[20:23]
    v_mfma_f32_32x32x16_bf16 v[192:207], a[24:27], a[44:47], v[192:207]
    ds_read_b64_tr_b16 a[14:15], v15 offset:33280
    ds_read_b128 a[20:23], v18 offset:4096
    buffer_load_dwordx4 v7, s[12:15], s51 offen offset:3072 lds
    v_lshlrev_b32 v64, 16, v120
    v_mfma_f32_32x32x16_bf16 v[208:223], a[28:31], a[44:47], v[208:223]
    v_and_b32 v65, 0xffff0000, v120
    v_lshlrev_b32 v66, 16, v121
    v_and_b32 v67, 0xffff0000, v121
    v_lshlrev_b32 v68, 16, v122
    v_and_b32 v69, 0xffff0000, v122
    v_lshlrev_b32 v70, 16, v123
    v_mfma_f32_32x32x16_bf16 v[224:239], a[32:35], a[44:47], v[224:239]
    s_sub_u32 s52, s2, 64
    s_lshl_b32 s52, s52, 2
    s_add_u32 s52, s52, s40
    s_mul_i32 s52, s52, 2432
    v_min_u32 v116, 18, v1
    v_lshlrev_b32 v116, 7, v116
    buffer_load_dword v117, v116, s[16:19], s52 offen
    s_sub_u32 s52, s2, 64
    s_lshl_b32 s52, s52, 2
    s_add_u32 s52, s52, s40
    s_mul_i32 s52, s52, 1408
    v_min_u32 v116, 10, v1
    v_lshlrev_b32 v116, 7, v116
    buffer_load_dword v117, v116, s[20:23], s52 offen
    s_sub_u32 s52, s2, 64
    s_lshl_b32 s52, s52, 2
    s_add_u32 s52, s52, s40
    s_mul_i32 s52, s52, 1408
    v_min_u32 v116, 10, v1
    v_lshlrev_b32 v116, 7, v116
    buffer_load_dword v117, v116, s[24:27], s52 offen
    s_sub_u32 s52, s2, 64
    s_lshl_b32 s52, s52, 2
    s_add_u32 s52, s52, s40
    s_mul_i32 s52, s52, 384
    s_add_u32 s52, s52, 0xd40000
    v_min_u32 v116, 2, v1
    v_lshlrev_b32 v116, 7, v116
    buffer_load_dword v117, v116, s[32:35], s52 offen sc1
    v_mfma_f32_32x32x16_bf16 v[240:255], a[36:39], a[44:47], v[240:255]
    v_and_b32 v71, 0xffff0000, v123
    v_lshlrev_b32 v72, 16, v124
    v_and_b32 v73, 0xffff0000, v124
    v_lshlrev_b32 v74, 16, v125
    v_and_b32 v75, 0xffff0000, v125
    v_lshlrev_b32 v76, 16, v126
    v_mfma_f32_16x16x32_bf16 v[88:91], a[248:251], a[28:31], v[88:91]
    v_and_b32 v77, 0xffff0000, v126
    v_lshlrev_b32 v78, 16, v127
    s_waitcnt lgkmcnt(0)
    v_mfma_f32_32x32x16_bf16 v[128:143], a[0:3], a[16:19], v[128:143]
    ds_read_b128 a[40:43], v19 offset:0
    ds_read_b64_tr_b16 a[24:25], v12 offset:34816
    s_add_u32 m0, s50, 98304
    s_add_u32 s51, s94, 256
    s_and_b32 s51, s51, 0x3ff
    buffer_load_dwordx4 v8, s[8:11], s51 offen offset:0 lds
    v_mfma_f32_32x32x16_bf16 v[144:159], a[4:7], a[16:19], v[144:159]
    ds_read_b64_tr_b16 a[26:27], v12 offset:35328
    ds_read_b64_tr_b16 a[28:29], v13 offset:34816
    v_and_b32 v79, 0xffff0000, v127
    v_add_f32 v112, v64, v65
    v_add_f32 v113, v66, v67
    v_add_f32 v112, v112, v68
    v_mfma_f32_32x32x16_bf16 v[160:175], a[8:11], a[16:19], v[160:175]
    ds_read_b64_tr_b16 a[30:31], v13 offset:35328
    ds_read_b64_tr_b16 a[32:33], v14 offset:34816
    buffer_load_dwordx4 v9, s[8:11], s51 offen offset:1024 lds
    v_add_f32 v113, v113, v69
    v_mfma_f32_32x32x16_bf16 v[176:191], a[12:15], a[16:19], v[176:191]
    ds_read_b64_tr_b16 a[34:35], v14 offset:35328
    ds_read_b64_tr_b16 a[36:37], v15 offset:34816
    v_add_f32 v112, v112, v70
    v_add_f32 v113, v113, v71
    v_add_f32 v112, v112, v72
    v_add_f32 v113, v113, v73
    v_mfma_f32_16x16x32_bf16 v[20:23], a[248:251], a[0:3], v[20:23]
    v_add_f32 v112, v112, v74
    v_add_f32 v113, v113, v75
    v_mfma_f32_32x32x16_bf16 v[192:207], a[0:3], a[20:23], v[192:207]
    ds_read_b64_tr_b16 a[38:39], v15 offset:35328
    ds_read_b128 a[44:47], v19 offset:4096
    buffer_load_dwordx4 v10, s[8:11], s51 offen offset:2048 lds
    v_add_f32 v112, v112, v76
    v_mfma_f32_32x32x16_bf16 v[208:223], a[4:7], a[20:23], v[208:223]
    v_add_f32 v113, v113, v77
    v_add_f32 v112, v112, v78
    v_add_f32 v113, v113, v79
    v_add_f32 v112, v112, v113
    v_mfma_f32_32x32x16_bf16 v[224:239], a[8:11], a[20:23], v[224:239]
    buffer_load_dwordx4 v11, s[8:11], s51 offen offset:3072 lds
    v_add_f32_dpp v112, v112, v112 quad_perm:[1,0,3,2] row_mask:0xf bank_mask:0xf
    v_mfma_f32_32x32x16_bf16 v[240:255], a[12:15], a[20:23], v[240:255]
    s_nop 0
    v_add_f32_dpp v112, v112, v112 quad_perm:[2,3,0,1] row_mask:0xf bank_mask:0xf
    s_nop 1
    v_add_f32_dpp v112, v112, v112 row_half_mirror row_mask:0xf bank_mask:0xf
    v_mfma_f32_16x16x32_bf16 v[88:91], a[248:251], a[4:7], v[88:91]
    s_waitcnt lgkmcnt(0)
    v_mfma_f32_32x32x16_bf16 v[128:143], a[24:27], a[40:43], v[128:143]
    s_add_u32 m0, s50, 114688
    s_add_u32 s51, s94, 256
    s_and_b32 s51, s51, 0x3ff
    s_mul_i32 s51, s51, 1792
    s_add_u32 s51, s51, s4
    buffer_load_dwordx4 v4, s[12:15], s51 offen offset:0 lds
    s_waitcnt vmcnt(13)
    s_barrier
    ds_read_b128 a[16:19], v16 offset:49152
    v_add_u32 v12, 0x10000, v12
    v_add_u32 v13, 0x10000, v13
    v_add_u32 v14, 0x10000, v14
    v_add_u32 v15, 0x10000, v15
    ds_read_b64_tr_b16 a[0:1], v12 offset:0
    v_mfma_f32_32x32x16_bf16 v[144:159], a[28:31], a[40:43], v[144:159]
    ds_read_b64_tr_b16 a[2:3], v12 offset:512
    ds_read_b64_tr_b16 a[4:5], v13 offset:0
    buffer_load_dwordx4 v5, s[12:15], s51 offen offset:1024 lds
    v_mfma_f32_32x32x16_bf16 v[160:175], a[32:35], a[40:43], v[160:175]
    ds_read_b64_tr_b16 a[6:7], v13 offset:512
    ds_read_b64_tr_b16 a[8:9], v14 offset:0
    v_add_f32_dpp v112, v112, v112 row_mirror row_mask:0xf bank_mask:0xf
    v_mov_b32 v113, v112
    s_nop 1
    v_permlane16_swap_b32 v112, v113
    v_add_f32 v112, v112, v113
    v_mfma_f32_32x32x16_bf16 v[176:191], a[36:39], a[40:43], v[176:191]
    ds_read_b64_tr_b16 a[10:11], v14 offset:512
    ds_read_b64_tr_b16 a[12:13], v15 offset:0
    v_mul_f32 v114, 0xbb000000, v112
    v_add_f32 v64, v64, v114
    v_add_f32 v65, v65, v114
    v_add_f32 v66, v66, v114
    v_mfma_f32_16x16x32_bf16 v[20:23], a[248:251], a[24:27], v[20:23]
    v_add_f32 v67, v67, v114
    v_add_f32 v68, v68, v114
    v_mfma_f32_32x32x16_bf16 v[192:207], a[24:27], a[44:47], v[192:207]
    ds_read_b64_tr_b16 a[14:15], v15 offset:512
    ds_read_b128 a[20:23], v16 offset:53248
    v_add_f32 v69, v69, v114
    v_add_f32 v70, v70, v114
    v_add_f32 v71, v71, v114
    v_add_f32 v72, v72, v114
    v_mfma_f32_32x32x16_bf16 v[208:223], a[28:31], a[44:47], v[208:223]
    v_add_f32 v73, v73, v114
    v_add_f32 v74, v74, v114
    v_add_f32 v75, v75, v114
    v_add_f32 v76, v76, v114
    v_add_f32 v77, v77, v114
    v_add_f32 v78, v78, v114
    v_mfma_f32_32x32x16_bf16 v[224:239], a[32:35], a[44:47], v[224:239]
    v_add_f32 v79, v79, v114
    v_mul_f32 v112, v64, v64
    v_mul_f32 v113, v65, v65
    v_fmac_f32 v112, v66, v66
    v_fmac_f32 v113, v67, v67
    v_fmac_f32 v112, v68, v68
    v_mfma_f32_32x32x16_bf16 v[240:255], a[36:39], a[44:47], v[240:255]
    v_fmac_f32 v113, v69, v69
    v_fmac_f32 v112, v70, v70
    v_fmac_f32 v113, v71, v71
    v_fmac_f32 v112, v72, v72
    v_fmac_f32 v113, v73, v73
    v_fmac_f32 v112, v74, v74
    v_mfma_f32_16x16x32_bf16 v[88:91], a[248:251], a[28:31], v[88:91]
    v_fmac_f32 v113, v75, v75
    v_fmac_f32 v112, v76, v76
    s_waitcnt lgkmcnt(0)
    v_mfma_f32_32x32x16_bf16 v[128:143], a[0:3], a[16:19], v[128:143]
    ds_read_b128 a[40:43], v17 offset:49152
    ds_read_b64_tr_b16 a[24:25], v12 offset:2048
    v_fmac_f32 v113, v77, v77
    v_fmac_f32 v112, v78, v78
    v_fmac_f32 v113, v79, v79
    v_add_f32 v112, v112, v113
    v_mfma_f32_32x32x16_bf16 v[144:159], a[4:7], a[16:19], v[144:159]
    ds_read_b64_tr_b16 a[26:27], v12 offset:2560
    ds_read_b64_tr_b16 a[28:29], v13 offset:2048
    v_add_f32_dpp v112, v112, v112 quad_perm:[1,0,3,2] row_mask:0xf bank_mask:0xf
    s_nop 1
    v_add_f32_dpp v112, v112, v112 quad_perm:[2,3,0,1] row_mask:0xf bank_mask:0xf
    v_mfma_f32_32x32x16_bf16 v[160:175], a[8:11], a[16:19], v[160:175]
    ds_read_b64_tr_b16 a[30:31], v13 offset:2560
    ds_read_b64_tr_b16 a[32:33], v14 offset:2048
    v_add_f32_dpp v112, v112, v112 row_half_mirror row_mask:0xf bank_mask:0xf
    s_nop 1
    v_add_f32_dpp v112, v112, v112 row_mirror row_mask:0xf bank_mask:0xf
    v_mfma_f32_32x32x16_bf16 v[176:191], a[12:15], a[16:19], v[176:191]
    ds_read_b64_tr_b16 a[34:35], v14 offset:2560
    ds_read_b64_tr_b16 a[36:37], v15 offset:2048
    v_mov_b32 v113, v112
    s_nop 1
    v_permlane16_swap_b32 v112, v113
    v_add_f32 v112, v112, v113
    v_mfma_f32_16x16x32_bf16 v[20:23], a[248:251], a[0:3], v[20:23]
    v_mul_f32 v112, 0x3b000000, v112
    v_cvt_pk_bf16_f32 v112, v112, v112
    v_mfma_f32_32x32x16_bf16 v[192:207], a[0:3], a[20:23], v[192:207]
    ds_read_b64_tr_b16 a[38:39], v15 offset:2560
    ds_read_b128 a[44:47], v17 offset:53248
    v_lshlrev_b32 v112, 16, v112
    v_add_f32 v112, 0x3727c5ac, v112
    v_cvt_pk_bf16_f32 v112, v112, v112
    v_lshlrev_b32 v112, 16, v112
    v_mfma_f32_32x32x16_bf16 v[208:223], a[4:7], a[20:23], v[208:223]
    v_sqrt_f32 v112, v112
    s_nop 0
    v_cvt_pk_bf16_f32 v32, v114, v112
    v_readfirstlane_b32 s60, v36
    v_readfirstlane_b32 s61, v37
    s_cmp_eq_u32 s60, 0
    s_cbranch_scc1 L_spin_2
L_ok_1:
    s_lshl_b32 s52, s45, 8
    s_lshl_b32 s93, s42, 4
    s_add_u32 s52, s52, s93
    s_add_u32 s52, s52, 0xc00000
    v_lshrrev_b32 v35, 5, v1
    v_lshlrev_b32 v35, 3, v35
    v_mov_b32 v33, s60
    s_mov_b32 exec_lo, 1
    s_mov_b32 exec_hi, 1
    buffer_store_dwordx2 v[32:33], v35, s[32:35], s52 offen sc1
    s_mov_b64 exec, -1
    s_and_b32 s52, s45, 62
    s_lshl_b32 s52, s52, 8
    v_and_b32 v35, 63, v1
    v_lshl_add_u32 v35, v35, 3, s52
    v_mfma_f32_32x32x16_bf16 v[224:239], a[8:11], a[20:23], v[224:239]
    v_lshrrev_b32 v40, 4, v1
    s_lshl_b32 s53, s40, 2
    v_add_u32 v40, s53, v40
    v_lshlrev_b32 v40, 7, v40
    v_add_u32 v40, s49, v40
    v_mul_u32_u24 v40, 514, v40
    v_mfma_f32_32x32x16_bf16 v[240:255], a[12:15], a[20:23], v[240:255]
    v_and_b32 v41, 15, v1
    v_lshl_add_u32 v40, v41, 2, v40
    s_lshl_b32 s53, s48, 6
    v_add_u32 v57, s53, v40
    s_mov_b32 s90, 16448
    s_mov_b32 s91, 32896
    v_mfma_f32_16x16x32_bf16 v[88:91], a[248:251], a[4:7], v[88:91]
    s_mov_b32 s92, 49344
    s_waitcnt lgkmcnt(0)
    v_mfma_f32_32x32x16_bf16 v[128:143], a[24:27], a[40:43], v[128:143]
    s_waitcnt vmcnt(11)
    s_barrier
    ds_read_b128 a[16:19], v18 offset:49152
    ds_read_b64_tr_b16 a[0:1], v12 offset:16384
    v_mfma_f32_32x32x16_bf16 v[144:159], a[28:31], a[40:43], v[144:159]
    ds_read_b64_tr_b16 a[2:3], v12 offset:16896
    ds_read_b64_tr_b16 a[4:5], v13 offset:16384
    v_mfma_f32_32x32x16_bf16 v[160:175], a[32:35], a[40:43], v[160:175]
    ds_read_b64_tr_b16 a[6:7], v13 offset:16896
    ds_read_b64_tr_b16 a[8:9], v14 offset:16384
    v_mfma_f32_32x32x16_bf16 v[176:191], a[36:39], a[40:43], v[176:191]
    ds_read_b64_tr_b16 a[10:11], v14 offset:16896
    ds_read_b64_tr_b16 a[12:13], v15 offset:16384
    v_mfma_f32_16x16x32_bf16 v[20:23], a[248:251], a[24:27], v[20:23]
    v_mfma_f32_32x32x16_bf16 v[192:207], a[24:27], a[44:47], v[192:207]
    ds_read_b64_tr_b16 a[14:15], v15 offset:16896
    ds_read_b128 a[20:23], v18 offset:53248
    v_mfma_f32_32x32x16_bf16 v[208:223], a[28:31], a[44:47], v[208:223]
    v_mfma_f32_32x32x16_bf16 v[224:239], a[32:35], a[44:47], v[224:239]
    v_mfma_f32_32x32x16_bf16 v[240:255], a[36:39], a[44:47], v[240:255]
    v_mfma_f32_16x16x32_bf16 v[88:91], a[248:251], a[28:31], v[88:91]
    s_waitcnt lgkmcnt(0)
    v_mfma_f32_32x32x16_bf16 v[128:143], a[0:3], a[16:19], v[128:143]
    ds_read_b128 a[40:43], v19 offset:49152
    ds_read_b64_tr_b16 a[24:25], v12 offset:18432
    v_mfma_f32_32x32x16_bf16 v[144:159], a[4:7], a[16:19], v[144:159]
    ds_read_b64_tr_b16 a[26:27], v12 offset:18944
    ds_read_b64_tr_b16 a[28:29], v13 offset:18432
    v_mfma_f32_32x32x16_bf16 v[160:175], a[8:11], a[16:19], v[160:175]
    ds_read_b64_tr_b16 a[30:31], v13 offset:18944
    ds_read_b64_tr_b16 a[32:33], v14 offset:18432
    v_mfma_f32_32x32x16_bf16 v[176:191], a[12:15], a[16:19], v[176:191]
    ds_read_b64_tr_b16 a[34:35], v14 offset:18944
    ds_read_b64_tr_b16 a[36:37], v15 offset:18432
    v_mfma_f32_16x16x32_bf16 v[20:23], a[248:251], a[0:3], v[20:23]
    v_mfma_f32_32x32x16_bf16 v[192:207], a[0:3], a[20:23], v[192:207]
    ds_read_b64_tr_b16 a[38:39], v15 offset:18944
    ds_read_b128 a[44:47], v19 offset:53248
    v_mfma_f32_32x32x16_bf16 v[208:223], a[4:7], a[20:23], v[208:223]
    v_mfma_f32_32x32x16_bf16 v[224:239], a[8:11], a[20:23], v[224:239]
    v_mfma_f32_32x32x16_bf16 v[240:255], a[12:15], a[20:23], v[240:255]
    v_mfma_f32_16x16x32_bf16 v[88:91], a[248:251], a[4:7], v[88:91]
    s_waitcnt lgkmcnt(0)
    v_mfma_f32_32x32x16_bf16 v[128:143], a[24:27], a[40:43], v[128:143]
    buffer_load_dwordx4 v6, s[12:15], s51 offen offset:2048 lds
    buffer_load_dwordx4 v7, s[12:15], s51 offen offset:3072 lds
    s_add_u32 m0, s50, 131072
    s_add_u32 s51, s94, 320
    s_and_b32 s51, s51, 0x3ff
    s_mul_i32 s51, s51, 1792
    s_add_u32 s51, s51, s4
    buffer_load_dwordx4 v4, s[12:15], s51 offen offset:0 lds
    buffer_load_dwordx4 v5, s[12:15], s51 offen offset:1024 lds
    buffer_load_dwordx4 v6, s[12:15], s51 offen offset:2048 lds
    buffer_load_dwordx4 v7, s[12:15], s51 offen offset:3072 lds
    s_add_u32 m0, s50, 16384
    s_add_u32 s51, s94, 384
    s_and_b32 s51, s51, 0x3ff
    buffer_load_dwordx4 v8, s[8:11], s51 offen offset:0 lds
    buffer_load_dwordx4 v9, s[8:11], s51 offen offset:1024 lds
    buffer_load_dwordx4 v10, s[8:11], s51 offen offset:2048 lds
    buffer_load_dwordx4 v11, s[8:11], s51 offen offset:3072 lds
    s_add_u32 m0, s50, 0
    s_add_u32 s51, s94, 384
    s_and_b32 s51, s51, 0x3ff
    s_mul_i32 s51, s51, 1792
    s_add_u32 s51, s51, s4
    buffer_load_dwordx4 v4, s[12:15], s51 offen offset:0 lds
    buffer_load_dwordx4 v5, s[12:15], s51 offen offset:1024 lds
    s_waitcnt vmcnt(10)
    s_barrier
    v_add_u32 v16, 0x10000, v16
    v_add_u32 v17, 0x10000, v17
    v_add_u32 v18, 0x10000, v18
    v_add_u32 v19, 0x10000, v19
    ds_read_b128 a[16:19], v16 offset:32768
    ds_read_b64_tr_b16 a[0:1], v12 offset:49152
    buffer_load_dwordx4 v6, s[12:15], s51 offen offset:2048 lds
    v_mfma_f32_32x32x16_bf16 v[144:159], a[28:31], a[40:43], v[144:159]
    ds_read_b64_tr_b16 a[2:3], v12 offset:49664
    ds_read_b64_tr_b16 a[4:5], v13 offset:49152
    v_mfma_f32_32x32x16_bf16 v[160:175], a[32:35], a[40:43], v[160:175]
    ds_read_b64_tr_b16 a[6:7], v13 offset:49664
    ds_read_b64_tr_b16 a[8:9], v14 offset:49152
    buffer_load_dwordx4 v7, s[12:15], s51 offen offset:3072 lds
    v_mfma_f32_32x32x16_bf16 v[176:191], a[36:39], a[40:43], v[176:191]
    ds_read_b64_tr_b16 a[10:11], v14 offset:49664
    ds_read_b64_tr_b16 a[12:13], v15 offset:49152
    v_mfma_f32_16x16x32_bf16 v[20:23], a[248:251], a[24:27], v[20:23]
    v_mfma_f32_32x32x16_bf16 v[192:207], a[24:27], a[44:47], v[192:207]
    ds_read_b64_tr_b16 a[14:15], v15 offset:49664
    ds_read_b128 a[20:23], v16 offset:36864
    s_add_u32 m0, s50, 32768
    s_lshl_b32 s51, s64, 4
    s_add_u32 s51, s51, s59
    buffer_load_dwordx4 v96, s[16:19], s51 offen offset:0 lds
    v_mfma_f32_32x32x16_bf16 v[208:223], a[28:31], a[44:47], v[208:223]
    v_mfma_f32_32x32x16_bf16 v[224:239], a[32:35], a[44:47], v[224:239]
    v_mfma_f32_32x32x16_bf16 v[240:255], a[36:39], a[44:47], v[240:255]
    buffer_load_dwordx4 v97, s[16:19], s51 offen offset:1024 lds
    v_mfma_f32_16x16x32_bf16 v[88:91], a[248:251], a[28:31], v[88:91]
    s_waitcnt lgkmcnt(0)
    v_mfma_f32_32x32x16_bf16 v[128:143], a[0:3], a[16:19], v[128:143]
    ds_read_b128 a[40:43], v17 offset:32768
    ds_read_b64_tr_b16 a[24:25], v12 offset:51200
    buffer_load_dwordx4 v98, s[16:19], s51 offen offset:2048 lds
    v_mfma_f32_32x32x16_bf16 v[144:159], a[4:7], a[16:19], v[144:159]
    ds_read_b64_tr_b16 a[26:27], v12 offset:51712
    ds_read_b64_tr_b16 a[28:29], v13 offset:51200
    v_mfma_f32_32x32x16_bf16 v[160:175], a[8:11], a[16:19], v[160:175]
    ds_read_b64_tr_b16 a[30:31], v13 offset:51712
    ds_read_b64_tr_b16 a[32:33], v14 offset:51200
    buffer_load_dwordx4 v99, s[16:19], s51 offen offset:3072 lds
    v_mfma_f32_32x32x16_bf16 v[176:191], a[12:15], a[16:19], v[176:191]
    ds_read_b64_tr_b16 a[34:35], v14 offset:51712
    ds_read_b64_tr_b16 a[36:37], v15 offset:51200
    v_mfma_f32_16x16x32_bf16 v[20:23], a[248:251], a[0:3], v[20:23]
    v_mfma_f32_32x32x16_bf16 v[192:207], a[0:3], a[20:23], v[192:207]
    ds_read_b64_tr_b16 a[38:39], v15 offset:51712
    ds_read_b128 a[44:47], v17 offset:36864
    s_add_u32 m0, s50, 65536
    s_add_u32 s51, s94, 448
    s_and_b32 s51, s51, 0x3ff
    s_mul_i32 s51, s51, 1792
    s_add_u32 s51, s51, s4
    buffer_load_dwordx4 v4, s[12:15], s51 offen offset:0 lds
    v_mfma_f32_32x32x16_bf16 v[208:223], a[4:7], a[20:23], v[208:223]
    v_mfma_f32_32x32x16_bf16 v[224:239], a[8:11], a[20:23], v[224:239]
    v_mfma_f32_32x32x16_bf16 v[240:255], a[12:15], a[20:23], v[240:255]
    buffer_load_dwordx4 v5, s[12:15], s51 offen offset:1024 lds
    v_mfma_f32_16x16x32_bf16 v[88:91], a[248:251], a[4:7], v[88:91]
    s_waitcnt lgkmcnt(0)
    v_mfma_f32_32x32x16_bf16 v[128:143], a[24:27], a[40:43], v[128:143]
    s_waitcnt vmcnt(14)
    s_barrier
    ds_read_b128 a[16:19], v18 offset:32768
    v_add_u32 v12, 0x10000, v12
    v_add_u32 v13, 0x10000, v13
    v_add_u32 v14, 0x10000, v14
    v_add_u32 v15, 0x10000, v15
    ds_read_b64_tr_b16 a[0:1], v12 offset:0
    buffer_load_dwordx4 v6, s[12:15], s51 offen offset:2048 lds
    v_mfma_f32_32x32x16_bf16 v[144:159], a[28:31], a[40:43], v[144:159]
    ds_read_b64_tr_b16 a[2:3], v12 offset:512
    ds_read_b64_tr_b16 a[4:5], v13 offset:0
    v_mfma_f32_32x32x16_bf16 v[160:175], a[32:35], a[40:43], v[160:175]
    ds_read_b64_tr_b16 a[6:7], v13 offset:512
    ds_read_b64_tr_b16 a[8:9], v14 offset:0
    buffer_load_dwordx4 v7, s[12:15], s51 offen offset:3072 lds
    v_mfma_f32_32x32x16_bf16 v[176:191], a[36:39], a[40:43], v[176:191]
    ds_read_b64_tr_b16 a[10:11], v14 offset:512
    ds_read_b64_tr_b16 a[12:13], v15 offset:0
    v_mfma_f32_16x16x32_bf16 v[20:23], a[248:251], a[24:27], v[20:23]
    v_mfma_f32_32x32x16_bf16 v[192:207], a[24:27], a[44:47], v[192:207]
    ds_read_b64_tr_b16 a[14:15], v15 offset:512
    ds_read_b128 a[20:23], v18 offset:36864
    s_add_u32 m0, s50, 49152
    s_add_u32 s51, s94, 512
    s_and_b32 s51, s51, 0x3ff
    buffer_load_dwordx4 v8, s[8:11], s51 offen offset:0 lds
    v_mfma_f32_32x32x16_bf16 v[208:223], a[28:31], a[44:47], v[208:223]
    v_mfma_f32_32x32x16_bf16 v[224:239], a[32:35], a[44:47], v[224:239]
    v_mfma_f32_32x32x16_bf16 v[240:255], a[36:39], a[44:47], v[240:255]
    buffer_load_dwordx4 v9, s[8:11], s51 offen offset:1024 lds
    v_mfma_f32_16x16x32_bf16 v[88:91], a[248:251], a[28:31], v[88:91]
    s_waitcnt lgkmcnt(0)
    v_mfma_f32_32x32x16_bf16 v[128:143], a[0:3], a[16:19], v[128:143]
    ds_read_b128 a[40:43], v19 offset:32768
    ds_read_b64_tr_b16 a[24:25], v12 offset:2048
    buffer_load_dwordx4 v10, s[8:11], s51 offen offset:2048 lds
    v_mfma_f32_32x32x16_bf16 v[144:159], a[4:7], a[16:19], v[144:159]
    ds_read_b64_tr_b16 a[26:27], v12 offset:2560
    ds_read_b64_tr_b16 a[28:29], v13 offset:2048
    v_mfma_f32_32x32x16_bf16 v[160:175], a[8:11], a[16:19], v[160:175]
    ds_read_b64_tr_b16 a[30:31], v13 offset:2560
    ds_read_b64_tr_b16 a[32:33], v14 offset:2048
    buffer_load_dwordx4 v11, s[8:11], s51 offen offset:3072 lds
    v_mfma_f32_32x32x16_bf16 v[176:191], a[12:15], a[16:19], v[176:191]
    ds_read_b64_tr_b16 a[34:35], v14 offset:2560
    ds_read_b64_tr_b16 a[36:37], v15 offset:2048
    v_mfma_f32_16x16x32_bf16 v[20:23], a[248:251], a[0:3], v[20:23]
    v_mfma_f32_32x32x16_bf16 v[192:207], a[0:3], a[20:23], v[192:207]
    ds_read_b64_tr_b16 a[38:39], v15 offset:2560
    ds_read_b128 a[44:47], v19 offset:36864
    s_add_u32 m0, s50, 81920
    s_add_u32 s51, s94, 512
    s_and_b32 s51, s51, 0x3ff
    s_mul_i32 s51, s51, 1792
    s_add_u32 s51, s51, s4
    buffer_load_dwordx4 v4, s[12:15], s51 offen offset:0 lds
    v_mfma_f32_32x32x16_bf16 v[208:223], a[4:7], a[20:23], v[208:223]
    v_mfma_f32_32x32x16_bf16 v[224:239], a[8:11], a[20:23], v[224:239]
    v_mfma_f32_32x32x16_bf16 v[240:255], a[12:15], a[20:23], v[240:255]
    buffer_load_dwordx4 v5, s[12:15], s51 offen offset:1024 lds
    v_mfma_f32_16x16x32_bf16 v[88:91], a[248:251], a[4:7], v[88:91]
    s_waitcnt lgkmcnt(0)
    v_mfma_f32_32x32x16_bf16 v[128:143], a[24:27], a[40:43], v[128:143]
    s_waitcnt vmcnt(14)
    s_barrier
    v_add_u32 v16, 0xffff0000, v16
    v_add_u32 v17, 0xffff0000, v17
    v_add_u32 v18, 0xffff0000, v18
    v_add_u32 v19, 0xffff0000, v19
    ds_read_b128 a[16:19], v16 offset:16384
    v_add_u32 v12, 0xfffe0000, v12
    v_add_u32 v13, 0xfffe0000, v13
    v_add_u32 v14, 0xfffe0000, v14
    v_add_u32 v15, 0xfffe0000, v15
    ds_read_b64_tr_b16 a[0:1], v12 offset:0
    buffer_load_dwordx4 v6, s[12:15], s51 offen offset:2048 lds
    v_mfma_f32_32x32x16_bf16 v[144:159], a[28:31], a[40:43], v[144:159]
    ds_read_b64_tr_b16 a[2:3], v12 offset:512
    ds_read_b64_tr_b16 a[4:5], v13 offset:0
    v_mfma_f32_32x32x16_bf16 v[160:175], a[32:35], a[40:43], v[160:175]
    ds_read_b64_tr_b16 a[6:7], v13 offset:512
    ds_read_b64_tr_b16 a[8:9], v14 offset:0
    buffer_load_dwordx4 v7, s[12:15], s51 offen offset:3072 lds
    s_waitcnt vmcnt(12)
    ds_read_b64_tr_b16 a[184:185], v62 offset:32768
    v_mfma_f32_32x32x16_bf16 v[176:191], a[36:39], a[40:43], v[176:191]
    ds_read_b64_tr_b16 a[10:11], v14 offset:512
    ds_read_b64_tr_b16 a[12:13], v15 offset:0
    ds_read_b64_tr_b16 a[186:187], v62 offset:33792
    v_mfma_f32_16x16x32_bf16 v[20:23], a[248:251], a[24:27], v[20:23]
    v_mfma_f32_32x32x16_bf16 v[192:207], a[24:27], a[44:47], v[192:207]
    ds_read_b64_tr_b16 a[14:15], v15 offset:512
    ds_read_b128 a[20:23], v16 offset:20480
    s_add_u32 m0, s50, 114688
    s_lshl_b32 s51, s64, 4
    s_add_u32 s51, s51, s59
    s_add_u32 s51, s51, 32768
    buffer_load_dwordx4 v96, s[16:19], s51 offen offset:0 lds
    v_mfma_f32_32x32x16_bf16 v[208:223], a[28:31], a[44:47], v[208:223]
    ds_read_b64_tr_b16 a[188:189], v63 offset:32768
    v_mfma_f32_32x32x16_bf16 v[224:239], a[32:35], a[44:47], v[224:239]
    ds_read_b64_tr_b16 a[190:191], v63 offset:33792
    v_mfma_f32_32x32x16_bf16 v[240:255], a[36:39], a[44:47], v[240:255]
    buffer_load_dwordx4 v97, s[16:19], s51 offen offset:1024 lds
    ds_read_b64_tr_b16 a[192:193], v62 offset:34816
    v_mfma_f32_16x16x32_bf16 v[88:91], a[248:251], a[28:31], v[88:91]
    s_waitcnt lgkmcnt(3)
    v_mfma_f32_32x32x16_bf16 v[128:143], a[0:3], a[16:19], v[128:143]
    ds_read_b128 a[40:43], v17 offset:16384
    ds_read_b64_tr_b16 a[24:25], v12 offset:2048
    buffer_load_dwordx4 v98, s[16:19], s51 offen offset:2048 lds
    ds_read_b64_tr_b16 a[194:195], v62 offset:35840
    v_mfma_f32_32x32x16_bf16 v[144:159], a[4:7], a[16:19], v[144:159]
    ds_read_b64_tr_b16 a[26:27], v12 offset:2560
    ds_read_b64_tr_b16 a[28:29], v13 offset:2048
    ds_read_b64_tr_b16 a[196:197], v63 offset:34816
    v_mfma_f32_32x32x16_bf16 v[160:175], a[8:11], a[16:19], v[160:175]
    ds_read_b64_tr_b16 a[30:31], v13 offset:2560
    ds_read_b64_tr_b16 a[32:33], v14 offset:2048
    buffer_load_dwordx4 v99, s[16:19], s51 offen offset:3072 lds
    ds_read_b64_tr_b16 a[198:199], v63 offset:35840
    v_mfma_f32_32x32x16_bf16 v[176:191], a[12:15], a[16:19], v[176:191]
    ds_read_b64_tr_b16 a[34:35], v14 offset:2560
    ds_read_b64_tr_b16 a[36:37], v15 offset:2048
    v_mfma_f32_16x16x32_bf16 v[20:23], a[248:251], a[0:3], v[20:23]
    v_mfma_f32_32x32x16_bf16 v[192:207], a[0:3], a[20:23], v[192:207]
    ds_read_b64_tr_b16 a[38:39], v15 offset:2560
    ds_read_b128 a[44:47], v17 offset:20480
    s_add_u32 m0, s50, 98304
    s_add_u32 s51, s94, 576
    s_and_b32 s51, s51, 0x3ff
    s_mul_i32 s51, s51, 1792
    s_add_u32 s51, s51, s4
    buffer_load_dwordx4 v4, s[12:15], s51 offen offset:0 lds
    v_mfma_f32_32x32x16_bf16 v[208:223], a[4:7], a[20:23], v[208:223]
    v_mfma_f32_32x32x16_bf16 v[224:239], a[8:11], a[20:23], v[224:239]
    v_mfma_f32_32x32x16_bf16 v[240:255], a[12:15], a[20:23], v[240:255]
    buffer_load_dwordx4 v5, s[12:15], s51 offen offset:1024 lds
    s_waitcnt lgkmcnt(4)
    v_mfma_f32_16x16x32_bf16 v[88:91], a[248:251], a[4:7], v[88:91]
    s_waitcnt lgkmcnt(0)
    v_mfma_f32_32x32x16_bf16 v[128:143], a[24:27], a[40:43], v[128:143]
    s_waitcnt vmcnt(14)
    s_barrier
    ds_read_b128 a[16:19], v18 offset:16384
    v_add_u32 v12, 0x10000, v12
    v_add_u32 v13, 0x10000, v13
    v_add_u32 v14, 0x10000, v14
    v_add_u32 v15, 0x10000, v15
    ds_read_b64_tr_b16 a[0:1], v12 offset:0
    buffer_load_dwordx4 v6, s[12:15], s51 offen offset:2048 lds
    v_mfma_f32_32x32x16_bf16 v[144:159], a[28:31], a[40:43], v[144:159]
    ds_read_b64_tr_b16 a[2:3], v12 offset:512
    ds_read_b64_tr_b16 a[4:5], v13 offset:0
    v_mfma_f32_32x32x16_bf16 v[160:175], a[32:35], a[40:43], v[160:175]
    ds_read_b64_tr_b16 a[6:7], v13 offset:512
    ds_read_b64_tr_b16 a[8:9], v14 offset:0
    buffer_load_dwordx4 v7, s[12:15], s51 offen offset:3072 lds
    v_mfma_f32_32x32x16_bf16 v[176:191], a[36:39], a[40:43], v[176:191]
    ds_read_b64_tr_b16 a[10:11], v14 offset:512
    ds_read_b64_tr_b16 a[12:13], v15 offset:0
    v_mfma_f32_16x16x32_bf16 v[20:23], a[248:251], a[24:27], v[20:23]
    v_mfma_f32_32x32x16_bf16 v[192:207], a[24:27], a[44:47], v[192:207]
    ds_read_b64_tr_b16 a[14:15], v15 offset:512
    ds_read_b128 a[20:23], v18 offset:20480
    s_add_u32 m0, s50, 131072
    s_add_u32 s51, s94, 640
    s_and_b32 s51, s51, 0x3ff
    buffer_load_dwordx4 v8, s[8:11], s51 offen offset:0 lds
    v_mfma_f32_32x32x16_bf16 v[208:223], a[28:31], a[44:47], v[208:223]
    v_mfma_f32_32x32x16_bf16 v[224:239], a[32:35], a[44:47], v[224:239]
    v_mfma_f32_32x32x16_bf16 v[240:255], a[36:39], a[44:47], v[240:255]
    buffer_load_dwordx4 v9, s[8:11], s51 offen offset:1024 lds
    v_mfma_f32_16x16x32_bf16 v[88:91], a[248:251], a[28:31], v[88:91]
    s_waitcnt lgkmcnt(0)
    v_mfma_f32_32x32x16_bf16 v[128:143], a[0:3], a[16:19], v[128:143]
    ds_read_b128 a[40:43], v19 offset:16384
    ds_read_b64_tr_b16 a[24:25], v12 offset:2048
    buffer_load_dwordx4 v10, s[8:11], s51 offen offset:2048 lds
    v_mfma_f32_32x32x16_bf16 v[144:159], a[4:7], a[16:19], v[144:159]
    ds_read_b64_tr_b16 a[26:27], v12 offset:2560
    ds_read_b64_tr_b16 a[28:29], v13 offset:2048
    v_mfma_f32_32x32x16_bf16 v[160:175], a[8:11], a[16:19], v[160:175]
    ds_read_b64_tr_b16 a[30:31], v13 offset:2560
    ds_read_b64_tr_b16 a[32:33], v14 offset:2048
    buffer_load_dwordx4 v11, s[8:11], s51 offen offset:3072 lds
    v_mfma_f32_32x32x16_bf16 v[176:191], a[12:15], a[16:19], v[176:191]
    ds_read_b64_tr_b16 a[34:35], v14 offset:2560
    ds_read_b64_tr_b16 a[36:37], v15 offset:2048
    v_mfma_f32_16x16x32_bf16 v[20:23], a[248:251], a[0:3], v[20:23]
    v_mfma_f32_32x32x16_bf16 v[192:207], a[0:3], a[20:23], v[192:207]
    ds_read_b64_tr_b16 a[38:39], v15 offset:2560
    ds_read_b128 a[44:47], v19 offset:20480
    s_add_u32 m0, s50, 32768
    s_add_u32 s51, s94, 640
    s_and_b32 s51, s51, 0x3ff
    s_mul_i32 s51, s51, 1792
    s_add_u32 s51, s51, s4
    buffer_load_dwordx4 v4, s[12:15], s51 offen offset:0 lds
    v_mfma_f32_32x32x16_bf16 v[208:223], a[4:7], a[20:23], v[208:223]
    v_mfma_f32_32x32x16_bf16 v[224:239], a[8:11], a[20:23], v[224:239]
    v_mfma_f32_32x32x16_bf16 v[240:255], a[12:15], a[20:23], v[240:255]
    buffer_load_dwordx4 v5, s[12:15], s51 offen offset:1024 lds
    v_mfma_f32_16x16x32_bf16 v[88:91], a[248:251], a[4:7], v[88:91]
    s_waitcnt lgkmcnt(0)
    v_mfma_f32_32x32x16_bf16 v[128:143], a[24:27], a[40:43], v[128:143]
    s_waitcnt vmcnt(14)
    s_barrier
    ds_read_b128 a[16:19], v16 offset:49152
    ds_read_b64_tr_b16 a[0:1], v12 offset:16384
    buffer_load_dwordx4 v6, s[12:15], s51 offen offset:2048 lds
    v_mfma_f32_32x32x16_bf16 v[144:159], a[28:31], a[40:43], v[144:159]
    ds_read_b64_tr_b16 a[2:3], v12 offset:16896
    ds_read_b64_tr_b16 a[4:5], v13 offset:16384
    v_mfma_f32_32x32x16_bf16 v[160:175], a[32:35], a[40:43], v[160:175]
    ds_read_b64_tr_b16 a[6:7], v13 offset:16896
    ds_read_b64_tr_b16 a[8:9], v14 offset:16384
    buffer_load_dwordx4 v7, s[12:15], s51 offen offset:3072 lds
    v_mfma_f32_32x32x16_bf16 v[176:191], a[36:39], a[40:43], v[176:191]
    ds_read_b64_tr_b16 a[10:11], v14 offset:16896
    ds_read_b64_tr_b16 a[12:13], v15 offset:16384
    s_waitcnt vmcnt(12)
    v_add_u32 v62, 0x10000, v62
    v_add_u32 v63, 0x10000, v63
    ds_read_b64_tr_b16 a[200:201], v62 offset:49152
    v_mfma_f32_16x16x32_bf16 v[20:23], a[248:251], a[24:27], v[20:23]
    v_mfma_f32_32x32x16_bf16 v[192:207], a[24:27], a[44:47], v[192:207]
    ds_read_b64_tr_b16 a[14:15], v15 offset:16896
    ds_read_b128 a[20:23], v16 offset:53248
    s_add_u32 m0, s50, 0
    s_lshl_b32 s51, s65, 4
    s_add_u32 s51, s51, s59
    buffer_load_dwordx4 v96, s[16:19], s51 offen offset:0 lds
    v_mfma_f32_32x32x16_bf16 v[208:223], a[28:31], a[44:47], v[208:223]
    ds_read_b64_tr_b16 a[202:203], v62 offset:50176
    v_mfma_f32_32x32x16_bf16 v[224:239], a[32:35], a[44:47], v[224:239]
    ds_read_b64_tr_b16 a[204:205], v63 offset:49152
    v_mfma_f32_32x32x16_bf16 v[240:255], a[36:39], a[44:47], v[240:255]
    buffer_load_dwordx4 v97, s[16:19], s51 offen offset:1024 lds
    ds_read_b64_tr_b16 a[206:207], v63 offset:50176
    v_mfma_f32_16x16x32_bf16 v[88:91], a[248:251], a[28:31], v[88:91]
    s_waitcnt lgkmcnt(3)
    v_mfma_f32_32x32x16_bf16 v[128:143], a[0:3], a[16:19], v[128:143]
    ds_read_b128 a[40:43], v17 offset:49152
    ds_read_b64_tr_b16 a[24:25], v12 offset:18432
    buffer_load_dwordx4 v98, s[16:19], s51 offen offset:2048 lds
    ds_read_b64_tr_b16 a[208:209], v62 offset:51200
    v_mfma_f32_32x32x16_bf16 v[144:159], a[4:7], a[16:19], v[144:159]
    ds_read_b64_tr_b16 a[26:27], v12 offset:18944
    ds_read_b64_tr_b16 a[28:29], v13 offset:18432
    ds_read_b64_tr_b16 a[210:211], v62 offset:52224
    v_mfma_f32_32x32x16_bf16 v[160:175], a[8:11], a[16:19], v[160:175]
    ds_read_b64_tr_b16 a[30:31], v13 offset:18944
    ds_read_b64_tr_b16 a[32:33], v14 offset:18432
    buffer_load_dwordx4 v99, s[16:19], s51 offen offset:3072 lds
    ds_read_b64_tr_b16 a[212:213], v63 offset:51200
    v_mfma_f32_32x32x16_bf16 v[176:191], a[12:15], a[16:19], v[176:191]
    ds_read_b64_tr_b16 a[34:35], v14 offset:18944
    ds_read_b64_tr_b16 a[36:37], v15 offset:18432
    ds_read_b64_tr_b16 a[214:215], v63 offset:52224
    v_mfma_f32_16x16x32_bf16 v[20:23], a[248:251], a[0:3], v[20:23]
    v_mfma_f32_32x32x16_bf16 v[192:207], a[0:3], a[20:23], v[192:207]
    ds_read_b64_tr_b16 a[38:39], v15 offset:18944
    ds_read_b128 a[44:47], v17 offset:53248
    s_add_u32 m0, s50, 16384
    s_add_u32 s51, s94, 704
    s_and_b32 s51, s51, 0x3ff
    s_mul_i32 s51, s51, 1792
    s_add_u32 s51, s51, s4
    buffer_load_dwordx4 v4, s[12:15], s51 offen offset:0 lds
    v_mfma_f32_32x32x16_bf16 v[208:223], a[4:7], a[20:23], v[208:223]
    buffer_load_dword v80, v57, s[20:23], 0 offen offset:2
    buffer_load_dword v81, v57, s[24:27], 0 offen offset:2
    v_mfma_f32_32x32x16_bf16 v[224:239], a[8:11], a[20:23], v[224:239]
    buffer_load_dword v82, v57, s[20:23], s90 offen offset:2
    buffer_load_dword v83, v57, s[24:27], s90 offen offset:2
    v_mfma_f32_32x32x16_bf16 v[240:255], a[12:15], a[20:23], v[240:255]
    v_mfma_f32_16x16x32_bf16 v[88:91], a[248:251], a[4:7], v[88:91]
    s_waitcnt lgkmcnt(0)
    v_mfma_f32_32x32x16_bf16 v[128:143], a[24:27], a[40:43], v[128:143]
    buffer_load_dwordx4 v5, s[12:15], s51 offen offset:1024 lds
    s_waitcnt vmcnt(18)
    s_barrier
    ds_read_b128 a[16:19], v18 offset:49152
    ds_read_b64_tr_b16 a[0:1], v12 offset:32768
    v_mfma_f32_32x32x16_bf16 v[144:159], a[28:31], a[40:43], v[144:159]
    ds_read_b64_tr_b16 a[2:3], v12 offset:33280
    ds_read_b64_tr_b16 a[4:5], v13 offset:32768
    buffer_load_dword v84, v57, s[20:23], s91 offen offset:2
    v_mfma_f32_32x32x16_bf16 v[160:175], a[32:35], a[40:43], v[160:175]
    ds_read_b64_tr_b16 a[6:7], v13 offset:33280
    ds_read_b64_tr_b16 a[8:9], v14 offset:32768
    buffer_load_dword v85, v57, s[24:27], s91 offen offset:2
    v_mfma_f32_32x32x16_bf16 v[176:191], a[36:39], a[40:43], v[176:191]
    ds_read_b64_tr_b16 a[10:11], v14 offset:33280
    ds_read_b64_tr_b16 a[12:13], v15 offset:32768
    buffer_load_dword v86, v57, s[20:23], s92 offen offset:2
    v_mfma_f32_16x16x32_bf16 v[20:23], a[248:251], a[24:27], v[20:23]
    buffer_load_dword v87, v57, s[24:27], s92 offen offset:2
    v_mfma_f32_32x32x16_bf16 v[192:207], a[24:27], a[44:47], v[192:207]
    ds_read_b64_tr_b16 a[14:15], v15 offset:33280
    ds_read_b128 a[20:23], v18 offset:53248
    s_lshl_b32 s53, s46, 1
    s_lshr_b32 s54, s40, 1
    s_add_u32 s53, s53, s54
    s_lshl_b32 s63, s53, 15
    v_mfma_f32_32x32x16_bf16 v[208:223], a[28:31], a[44:47], v[208:223]
    s_add_u32 s63, s63, s50
    v_lshlrev_b32 v40, 2, v1
    s_lshr_b32 s53, s63, 15
    s_xor_b32 s53, s53, 0
    s_lshl_b32 s53, s53, 2
    s_add_u32 s53, s53, s40
    v_mfma_f32_32x32x16_bf16 v[224:239], a[32:35], a[44:47], v[224:239]
    buffer_load_dwordx4 v6, s[12:15], s51 offen offset:2048 lds
    s_mul_i32 s54, s53, 28672
    v_add_u32 v100, s54, v2
    s_mul_i32 s54, s53, 1792
    v_mfma_f32_32x32x16_bf16 v[240:255], a[36:39], a[44:47], v[240:255]
    s_add_u32 s54, s54, 0xc80000
    v_add_u32 v102, s54, v40
    s_lshr_b32 s53, s63, 15
    s_xor_b32 s53, s53, 1
    s_lshl_b32 s53, s53, 2
    s_add_u32 s53, s53, s40
    v_mfma_f32_16x16x32_bf16 v[88:91], a[248:251], a[28:31], v[88:91]
    s_mul_i32 s54, s53, 28672
    v_add_u32 v101, s54, v2
    s_waitcnt lgkmcnt(0)
    v_mfma_f32_32x32x16_bf16 v[128:143], a[0:3], a[16:19], v[128:143]
    ds_read_b128 a[40:43], v19 offset:49152
    ds_read_b64_tr_b16 a[24:25], v12 offset:34816
    buffer_load_dwordx4 v7, s[12:15], s51 offen offset:3072 lds
    s_mul_i32 s54, s53, 1792
    v_mfma_f32_32x32x16_bf16 v[144:159], a[4:7], a[16:19], v[144:159]
    s_mov_b32 s52, 0xc00000
    buffer_load_dwordx2 v[36:37], v35, s[32:35], s52 offen sc1
    ds_read_b64_tr_b16 a[26:27], v12 offset:35328
    ds_read_b64_tr_b16 a[28:29], v13 offset:34816
    v_mfma_f32_32x32x16_bf16 v[160:175], a[8:11], a[16:19], v[160:175]
    ds_read_b64_tr_b16 a[30:31], v13 offset:35328
    ds_read_b64_tr_b16 a[32:33], v14 offset:34816
    s_add_u32 s54, s54, 0xc80000
    v_add_u32 v103, s54, v40
    v_mfma_f32_32x32x16_bf16 v[176:191], a[12:15], a[16:19], v[176:191]
    ds_read_b64_tr_b16 a[34:35], v14 offset:35328
    ds_read_b64_tr_b16 a[36:37], v15 offset:34816
    s_add_u32 m0, s50, 65536
    s_add_u32 s51, s94, 768
    s_and_b32 s51, s51, 0x3ff
    buffer_load_dwordx4 v8, s[8:11], s51 offen offset:0 lds
    v_mfma_f32_16x16x32_bf16 v[20:23], a[248:251], a[0:3], v[20:23]
    v_mfma_f32_32x32x16_bf16 v[192:207], a[0:3], a[20:23], v[192:207]
    ds_read_b64_tr_b16 a[38:39], v15 offset:35328
    ds_read_b128 a[44:47], v19 offset:53248
    v_mfma_f32_32x32x16_bf16 v[208:223], a[4:7], a[20:23], v[208:223]
    v_mfma_f32_32x32x16_bf16 v[224:239], a[8:11], a[20:23], v[224:239]
    buffer_load_dwordx4 v9, s[8:11], s51 offen offset:1024 lds
    v_mfma_f32_32x32x16_bf16 v[240:255], a[12:15], a[20:23], v[240:255]
    v_mfma_f32_16x16x32_bf16 v[88:91], a[248:251], a[4:7], v[88:91]
    s_waitcnt lgkmcnt(0)
    v_mfma_f32_32x32x16_bf16 v[128:143], a[24:27], a[40:43], v[128:143]
    s_waitcnt vmcnt(19)
    s_barrier
    v_add_u32 v16, 0x20000, v16
    v_add_u32 v17, 0x20000, v17
    v_add_u32 v18, 0x20000, v18
    v_add_u32 v19, 0x20000, v19
    ds_read_b128 a[16:19], v16 offset:0
    v_add_u32 v12, 0xffff0000, v12
    v_add_u32 v13, 0xffff0000, v13
    v_add_u32 v14, 0xffff0000, v14
    v_add_u32 v15, 0xffff0000, v15
    ds_read_b64_tr_b16 a[0:1], v12 offset:32768
    buffer_load_dwordx4 v10, s[8:11], s51 offen offset:2048 lds
    v_mfma_f32_32x32x16_bf16 v[144:159], a[28:31], a[40:43], v[144:159]
    ds_read_b64_tr_b16 a[2:3], v12 offset:33280
    ds_read_b64_tr_b16 a[4:5], v13 offset:32768
    v_mfma_f32_32x32x16_bf16 v[160:175], a[32:35], a[40:43], v[160:175]
    ds_read_b64_tr_b16 a[6:7], v13 offset:33280
    ds_read_b64_tr_b16 a[8:9], v14 offset:32768
    buffer_load_dwordx4 v11, s[8:11], s51 offen offset:3072 lds
    s_waitcnt vmcnt(17)
    v_add_u32 v62, 0xffff0000, v62
    v_add_u32 v63, 0xffff0000, v63
    ds_read_b64_tr_b16 a[216:217], v62 offset:0
    v_mfma_f32_32x32x16_bf16 v[176:191], a[36:39], a[40:43], v[176:191]
    ds_read_b64_tr_b16 a[10:11], v14 offset:33280
    ds_read_b64_tr_b16 a[12:13], v15 offset:32768
    ds_read_b64_tr_b16 a[218:219], v62 offset:1024
    v_mfma_f32_16x16x32_bf16 v[20:23], a[248:251], a[24:27], v[20:23]
    v_mfma_f32_32x32x16_bf16 v[192:207], a[24:27], a[44:47], v[192:207]
    ds_read_b64_tr_b16 a[14:15], v15 offset:33280
    ds_read_b128 a[20:23], v16 offset:4096
    s_add_u32 m0, s50, 81920
    s_add_u32 s51, s94, 768
    s_and_b32 s51, s51, 0x3ff
    s_mul_i32 s51, s51, 1792
    s_add_u32 s51, s51, s4
    buffer_load_dwordx4 v4, s[12:15], s51 offen offset:0 lds
    v_mfma_f32_32x32x16_bf16 v[208:223], a[28:31], a[44:47], v[208:223]
    ds_read_b64_tr_b16 a[220:221], v63 offset:0
    v_mfma_f32_32x32x16_bf16 v[224:239], a[32:35], a[44:47], v[224:239]
    ds_read_b64_tr_b16 a[222:223], v63 offset:1024
    v_mfma_f32_32x32x16_bf16 v[240:255], a[36:39], a[44:47], v[240:255]
    buffer_load_dwordx4 v5, s[12:15], s51 offen offset:1024 lds
    ds_read_b64_tr_b16 a[224:225], v62 offset:2048
    v_mfma_f32_16x16x32_bf16 v[88:91], a[248:251], a[28:31], v[88:91]
    s_waitcnt lgkmcnt(3)
    v_mfma_f32_32x32x16_bf16 v[128:143], a[0:3], a[16:19], v[128:143]
    ds_read_b128 a[40:43], v17 offset:0
    ds_read_b64_tr_b16 a[24:25], v12 offset:34816
    buffer_load_dwordx4 v6, s[12:15], s51 offen offset:2048 lds
    ds_read_b64_tr_b16 a[226:227], v62 offset:3072
    v_mfma_f32_32x32x16_bf16 v[144:159], a[4:7], a[16:19], v[144:159]
    ds_read_b64_tr_b16 a[26:27], v12 offset:35328
    ds_read_b64_tr_b16 a[28:29], v13 offset:34816
    ds_read_b64_tr_b16 a[228:229], v63 offset:2048
    v_mfma_f32_32x32x16_bf16 v[160:175], a[8:11], a[16:19], v[160:175]
    ds_read_b64_tr_b16 a[30:31], v13 offset:35328
    ds_read_b64_tr_b16 a[32:33], v14 offset:34816
    buffer_load_dwordx4 v7, s[12:15], s51 offen offset:3072 lds
    ds_read_b64_tr_b16 a[230:231], v63 offset:3072
    v_mfma_f32_32x32x16_bf16 v[176:191], a[12:15], a[16:19], v[176:191]
    ds_read_b64_tr_b16 a[34:35], v14 offset:35328
    ds_read_b64_tr_b16 a[36:37], v15 offset:34816
    v_mfma_f32_16x16x32_bf16 v[20:23], a[248:251], a[0:3], v[20:23]
    v_mfma_f32_32x32x16_bf16 v[192:207], a[0:3], a[20:23], v[192:207]
    ds_read_b64_tr_b16 a[38:39], v15 offset:35328
    ds_read_b128 a[44:47], v17 offset:4096
    s_add_u32 m0, s50, 114688
    s_add_u32 s51, s94, 832
    s_and_b32 s51, s51, 0x3ff
    s_mul_i32 s51, s51, 1792
    s_add_u32 s51, s51, s4
    buffer_load_dwordx4 v4, s[12:15], s51 offen offset:0 lds
    v_mfma_f32_32x32x16_bf16 v[208:223], a[4:7], a[20:23], v[208:223]
    v_mfma_f32_32x32x16_bf16 v[224:239], a[8:11], a[20:23], v[224:239]
    v_mfma_f32_32x32x16_bf16 v[240:255], a[12:15], a[20:23], v[240:255]
    buffer_load_dwordx4 v5, s[12:15], s51 offen offset:1024 lds
    s_waitcnt lgkmcnt(4)
    v_mfma_f32_16x16x32_bf16 v[88:91], a[248:251], a[4:7], v[88:91]
    s_waitcnt lgkmcnt(0)
    v_mfma_f32_32x32x16_bf16 v[128:143], a[24:27], a[40:43], v[128:143]
    s_waitcnt vmcnt(11)
    s_barrier
    ds_read_b128 a[16:19], v18 offset:0
    ds_read_b64_tr_b16 a[0:1], v12 offset:16384
    buffer_load_dwordx4 v6, s[12:15], s51 offen offset:2048 lds
    v_mfma_f32_32x32x16_bf16 v[144:159], a[28:31], a[40:43], v[144:159]
    s_waitcnt vmcnt(11)
    v_cmp_ne_u32 vcc, s60, v37
    s_cbranch_vccnz L_spin_4
L_ok_3:
    v_mov_b32 v37, v36
    s_nop 1
    v_permlane32_swap_b32 v36, v37
    v_cmp_gt_u32 vcc, 32, v1
    v_and_b32 v94, 0xffff0000, v37
    v_and_b32 v93, 0xffff, v37
    v_rcp_f32 v37, v94
    v_cndmask_b32 v93, 0, v93, vcc
    v_mul_f32 v94, v37, v37
    v_lshl_or_b32 v92, v93, 16, v93
    v_and_b32 v34, 0xffff0000, v36
    v_and_b32 v33, 0xffff, v36
    v_rcp_f32 v37, v34
    v_cndmask_b32 v33, 0, v33, vcc
    v_mul_f32 v34, v37, v37
    v_lshl_or_b32 v32, v33, 16, v33
    ds_read_b64_tr_b16 a[2:3], v12 offset:16896
    ds_read_b64_tr_b16 a[4:5], v13 offset:16384
    buffer_load_dwordx4 v7, s[12:15], s51 offen offset:3072 lds
    v_mfma_f32_32x32x16_bf16 v[160:175], a[32:35], a[40:43], v[160:175]
    ds_read_b64_tr_b16 a[6:7], v13 offset:16896
    ds_read_b64_tr_b16 a[8:9], v14 offset:16384
    v_lshrrev_b32 v40, 3, v1
    v_lshlrev_b32 v40, 7, v40
    v_bfe_u32 v41, v1, 4, 1
    v_lshlrev_b32 v41, 5, v41
    v_mfma_f32_32x32x16_bf16 v[176:191], a[36:39], a[40:43], v[176:191]
    ds_read_b64_tr_b16 a[10:11], v14 offset:16896
    ds_read_b64_tr_b16 a[12:13], v15 offset:16384
    s_add_u32 m0, s50, 49152
    s_lshl_b32 s51, s65, 4
    s_add_u32 s51, s51, s59
    s_add_u32 s51, s51, 32768
    buffer_load_dwordx4 v96, s[16:19], s51 offen offset:0 lds
    v_mfma_f32_16x16x32_bf16 v[20:23], a[248:251], a[24:27], v[20:23]
    v_and_b32 v42, 0x70, v2
    v_xor_b32 v41, v41, v42
    v_mfma_f32_32x32x16_bf16 v[192:207], a[24:27], a[44:47], v[192:207]
    ds_read_b64_tr_b16 a[14:15], v15 offset:16896
    ds_read_b128 a[20:23], v18 offset:4096
    v_add_u32 v36, v40, v41
    v_xor_b32 v37, 64, v36
    v_and_b32 v35, 0x3c, v1
    v_lshlrev_b32 v35, 6, v35
    v_mfma_f32_32x32x16_bf16 v[208:223], a[28:31], a[44:47], v[208:223]
    buffer_load_dwordx4 v97, s[16:19], s51 offen offset:1024 lds
    s_lshr_b32 s53, s48, 1
    s_lshl_b32 s53, s53, 14
    s_add_u32 s53, s53, s50
    v_mfma_f32_32x32x16_bf16 v[224:239], a[32:35], a[44:47], v[224:239]
    s_and_b32 s54, s48, 1
    s_lshl_b32 s54, s54, 5
    s_add_u32 s54, s54, s49
    s_lshl_b32 s54, s54, 2
    s_add_u32 s53, s53, s54
    s_add_u32 s53, s53, 0xd00000
    v_mfma_f32_32x32x16_bf16 v[240:255], a[36:39], a[44:47], v[240:255]
    buffer_load_dwordx4 v98, s[16:19], s51 offen offset:2048 lds
    v_add_u32 v35, s53, v35
    v_mfma_f32_16x16x32_bf16 v[88:91], a[248:251], a[28:31], v[88:91]
    s_waitcnt lgkmcnt(0)
    v_mfma_f32_32x32x16_bf16 v[128:143], a[0:3], a[16:19], v[128:143]
    ds_read_b128 a[40:43], v19 offset:0
    ds_read_b64_tr_b16 a[24:25], v12 offset:18432
    buffer_load_dwordx4 v99, s[16:19], s51 offen offset:3072 lds
    v_mfma_f32_32x32x16_bf16 v[144:159], a[4:7], a[16:19], v[144:159]
    ds_read_b64_tr_b16 a[26:27], v12 offset:18944
    ds_read_b64_tr_b16 a[28:29], v13 offset:18432
    v_mfma_f32_32x32x16_bf16 v[160:175], a[8:11], a[16:19], v[160:175]
    ds_read_b64_tr_b16 a[30:31], v13 offset:18944
    ds_read_b64_tr_b16 a[32:33], v14 offset:18432
    s_add_u32 m0, s50, 98304
    s_add_u32 s51, s94, 896
    s_and_b32 s51, s51, 0x3ff
    buffer_load_dwordx4 v8, s[8:11], s51 offen offset:0 lds
    v_mfma_f32_32x32x16_bf16 v[176:191], a[12:15], a[16:19], v[176:191]
    ds_read_b64_tr_b16 a[34:35], v14 offset:18944
    ds_read_b64_tr_b16 a[36:37], v15 offset:18432
    v_mfma_f32_16x16x32_bf16 v[20:23], a[248:251], a[0:3], v[20:23]
    v_mfma_f32_32x32x16_bf16 v[192:207], a[0:3], a[20:23], v[192:207]
    ds_read_b64_tr_b16 a[38:39], v15 offset:18944
    ds_read_b128 a[44:47], v19 offset:4096
    buffer_load_dwordx4 v9, s[8:11], s51 offen offset:1024 lds
    v_mfma_f32_32x32x16_bf16 v[208:223], a[4:7], a[20:23], v[208:223]
    v_mfma_f32_32x32x16_bf16 v[224:239], a[8:11], a[20:23], v[224:239]
    buffer_load_dwordx4 v10, s[8:11], s51 offen offset:2048 lds
    v_mfma_f32_32x32x16_bf16 v[240:255], a[12:15], a[20:23], v[240:255]
    v_mfma_f32_16x16x32_bf16 v[88:91], a[248:251], a[4:7], v[88:91]
    s_waitcnt lgkmcnt(0)
    v_mfma_f32_32x32x16_bf16 v[128:143], a[24:27], a[40:43], v[128:143]
    buffer_load_dwordx4 v11, s[8:11], s51 offen offset:3072 lds
    s_waitcnt vmcnt(12)
    s_barrier
    v_add_u32 v16, 0xffff0000, v16
    v_add_u32 v17, 0xffff0000, v17
    v_add_u32 v18, 0xffff0000, v18
    v_add_u32 v19, 0xffff0000, v19
    ds_read_b128 a[16:19], v16 offset:0
    v_add_u32 v12, 0x10000, v12
    v_add_u32 v13, 0x10000, v13
    v_add_u32 v14, 0x10000, v14
    v_add_u32 v15, 0x10000, v15
    ds_read_b64_tr_b16 a[0:1], v12 offset:16384
    s_add_u32 m0, s50, 0
    s_add_u32 s51, s94, 896
    s_and_b32 s51, s51, 0x3ff
    s_mul_i32 s51, s51, 1792
    s_add_u32 s51, s51, s4
    buffer_load_dwordx4 v4, s[12:15], s51 offen offset:0 lds
    v_mfma_f32_32x32x16_bf16 v[144:159], a[28:31], a[40:43], v[144:159]
    ds_read_b64_tr_b16 a[2:3], v12 offset:16896
    ds_read_b64_tr_b16 a[4:5], v13 offset:16384
    v_mfma_f32_32x32x16_bf16 v[160:175], a[32:35], a[40:43], v[160:175]
    ds_read_b64_tr_b16 a[6:7], v13 offset:16896
    ds_read_b64_tr_b16 a[8:9], v14 offset:16384
    buffer_load_dwordx4 v5, s[12:15], s51 offen offset:1024 lds
    v_mfma_f32_32x32x16_bf16 v[176:191], a[36:39], a[40:43], v[176:191]
    ds_read_b64_tr_b16 a[10:11], v14 offset:16896
    ds_read_b64_tr_b16 a[12:13], v15 offset:16384
    v_mfma_f32_16x16x32_bf16 v[20:23], a[248:251], a[24:27], v[20:23]
    v_mfma_f32_32x32x16_bf16 v[192:207], a[24:27], a[44:47], v[192:207]
    ds_read_b64_tr_b16 a[14:15], v15 offset:16896
    ds_read_b128 a[20:23], v16 offset:4096
    buffer_load_dwordx4 v6, s[12:15], s51 offen offset:2048 lds
    v_mfma_f32_32x32x16_bf16 v[208:223], a[28:31], a[44:47], v[208:223]
    v_mfma_f32_32x32x16_bf16 v[224:239], a[32:35], a[44:47], v[224:239]
    buffer_load_dwordx4 v7, s[12:15], s51 offen offset:3072 lds
    v_mfma_f32_32x32x16_bf16 v[240:255], a[36:39], a[44:47], v[240:255]
    v_mfma_f32_16x16x32_bf16 v[88:91], a[248:251], a[28:31], v[88:91]
    s_waitcnt lgkmcnt(0)
    v_mfma_f32_32x32x16_bf16 v[128:143], a[0:3], a[16:19], v[128:143]
    ds_read_b128 a[40:43], v17 offset:0
    ds_read_b64_tr_b16 a[24:25], v12 offset:18432
    s_add_u32 m0, s50, 32768
    s_add_u32 s51, s94, 960
    s_and_b32 s51, s51, 0x3ff
    s_mul_i32 s51, s51, 1792
    s_add_u32 s51, s51, s4
    buffer_load_dwordx4 v4, s[12:15], s51 offen offset:0 lds
    v_mfma_f32_32x32x16_bf16 v[144:159], a[4:7], a[16:19], v[144:159]
    ds_read_b64_tr_b16 a[26:27], v12 offset:18944
    ds_read_b64_tr_b16 a[28:29], v13 offset:18432
    v_mfma_f32_32x32x16_bf16 v[160:175], a[8:11], a[16:19], v[160:175]
    ds_read_b64_tr_b16 a[30:31], v13 offset:18944
    ds_read_b64_tr_b16 a[32:33], v14 offset:18432
    buffer_load_dwordx4 v5, s[12:15], s51 offen offset:1024 lds
    v_mfma_f32_32x32x16_bf16 v[176:191], a[12:15], a[16:19], v[176:191]
    ds_read_b64_tr_b16 a[34:35], v14 offset:18944
    ds_read_b64_tr_b16 a[36:37], v15 offset:18432
    v_mfma_f32_16x16x32_bf16 v[20:23], a[248:251], a[0:3], v[20:23]
    v_mfma_f32_32x32x16_bf16 v[192:207], a[0:3], a[20:23], v[192:207]
    ds_read_b64_tr_b16 a[38:39], v15 offset:18944
    ds_read_b128 a[44:47], v17 offset:4096
    buffer_load_dwordx4 v6, s[12:15], s51 offen offset:2048 lds
    v_mfma_f32_32x32x16_bf16 v[208:223], a[4:7], a[20:23], v[208:223]
    v_mfma_f32_32x32x16_bf16 v[224:239], a[8:11], a[20:23], v[224:239]
    buffer_load_dwordx4 v7, s[12:15], s51 offen offset:3072 lds
    v_mfma_f32_32x32x16_bf16 v[240:255], a[12:15], a[20:23], v[240:255]
    v_mfma_f32_16x16x32_bf16 v[88:91], a[248:251], a[4:7], v[88:91]
    s_waitcnt lgkmcnt(0)
    v_mfma_f32_32x32x16_bf16 v[128:143], a[24:27], a[40:43], v[128:143]
    s_add_u32 m0, s50, 131072
    s_lshl_b32 s51, s66, 4
    s_add_u32 s51, s51, s59
    buffer_load_dwordx4 v96, s[16:19], s51 offen offset:0 lds
    s_waitcnt vmcnt(17)
    s_barrier
    ds_read_b128 a[104:107], v18 offset:0
    ds_read_b64_tr_b16 a[88:89], v12 offset:49152
    ds_read_b64_tr_b16 a[90:91], v12 offset:49664
    ds_read_b64_tr_b16 a[92:93], v13 offset:49152
    v_mfma_f32_32x32x16_bf16 v[144:159], a[28:31], a[40:43], v[144:159]
    ds_read_b64_tr_b16 a[94:95], v13 offset:49664
    ds_read_b64_tr_b16 a[96:97], v14 offset:49152
    ds_read_b64_tr_b16 a[98:99], v14 offset:49664
    ds_read_b64_tr_b16 a[100:101], v15 offset:49152
    buffer_load_dwordx4 v97, s[16:19], s51 offen offset:1024 lds
    v_mfma_f32_32x32x16_bf16 v[160:175], a[32:35], a[40:43], v[160:175]
    ds_read_b64_tr_b16 a[102:103], v15 offset:49664
    ds_read_b128 a[64:67], v19 offset:0
    ds_read_b64_tr_b16 a[48:49], v12 offset:51200
    ds_read_b64_tr_b16 a[50:51], v12 offset:51712
    v_mfma_f32_32x32x16_bf16 v[176:191], a[36:39], a[40:43], v[176:191]
    ds_read_b64_tr_b16 a[52:53], v13 offset:51200
    ds_read_b64_tr_b16 a[54:55], v13 offset:51712
    ds_read_b64_tr_b16 a[56:57], v14 offset:51200
    buffer_load_dwordx4 v98, s[16:19], s51 offen offset:2048 lds
    v_mfma_f32_16x16x32_bf16 v[20:23], a[248:251], a[24:27], v[20:23]
    v_mfma_f32_32x32x16_bf16 v[192:207], a[24:27], a[44:47], v[192:207]
    ds_read_b64_tr_b16 a[58:59], v14 offset:51712
    ds_read_b64_tr_b16 a[60:61], v15 offset:51200
    ds_read_b64_tr_b16 a[62:63], v15 offset:51712
    s_waitcnt vmcnt(15)
    ds_read_b64_tr_b16 a[232:233], v62 offset:49152
    v_mfma_f32_32x32x16_bf16 v[208:223], a[28:31], a[44:47], v[208:223]
    buffer_load_dwordx4 v99, s[16:19], s51 offen offset:3072 lds
    ds_read_b64_tr_b16 a[234:235], v62 offset:50176
    v_mfma_f32_32x32x16_bf16 v[224:239], a[32:35], a[44:47], v[224:239]
    ds_read_b64_tr_b16 a[236:237], v63 offset:49152
    v_mfma_f32_32x32x16_bf16 v[240:255], a[36:39], a[44:47], v[240:255]
    s_add_u32 m0, s50, 16384
    s_lshl_b32 s51, s66, 4
    s_add_u32 s51, s51, s59
    s_add_u32 s51, s51, 32768
    buffer_load_dwordx4 v96, s[16:19], s51 offen offset:0 lds
    v_mfma_f32_16x16x32_bf16 v[88:91], a[248:251], a[28:31], v[88:91]
    s_waitcnt lgkmcnt(12)
    v_mfma_f32_32x32x16_bf16 v[128:143], a[88:91], a[104:107], v[128:143]
    s_waitcnt vmcnt(9)
    s_barrier
    ds_read_b128 a[84:87], v16 offset:32768
    v_add_u32 v12, 0xffff0000, v12
    v_add_u32 v13, 0xffff0000, v13
    v_add_u32 v14, 0xffff0000, v14
    v_add_u32 v15, 0xffff0000, v15
    ds_read_b64_tr_b16 a[68:69], v12 offset:0
    ds_read_b64_tr_b16 a[70:71], v12 offset:512
    buffer_load_dwordx4 v97, s[16:19], s51 offen offset:1024 lds
    v_mfma_f32_32x32x16_bf16 v[144:159], a[92:95], a[104:107], v[144:159]
    ds_read_b64_tr_b16 a[72:73], v13 offset:0
    ds_read_b64_tr_b16 a[74:75], v13 offset:512
    ds_read_b64_tr_b16 a[238:239], v63 offset:50176
    v_mfma_f32_32x32x16_bf16 v[160:175], a[96:99], a[104:107], v[160:175]
    ds_read_b64_tr_b16 a[76:77], v14 offset:0
    ds_read_b64_tr_b16 a[78:79], v14 offset:512
    buffer_load_dwordx4 v98, s[16:19], s51 offen offset:2048 lds
    ds_read_b64_tr_b16 a[240:241], v62 offset:51200
    v_mfma_f32_32x32x16_bf16 v[176:191], a[100:103], a[104:107], v[176:191]
    ds_read_b64_tr_b16 a[80:81], v15 offset:0
    ds_read_b64_tr_b16 a[82:83], v15 offset:512
    ds_read_b64_tr_b16 a[242:243], v62 offset:52224
    v_mfma_f32_16x16x32_bf16 v[20:23], a[248:251], a[88:91], v[20:23]
    v_mfma_f32_16x16x32_bf16 v[88:91], a[248:251], a[92:95], v[88:91]
    s_waitcnt lgkmcnt(14)
    v_mfma_f32_32x32x16_bf16 v[128:143], a[48:51], a[64:67], v[128:143]
    ds_read_b128 a[104:107], v17 offset:32768
    ds_read_b64_tr_b16 a[88:89], v12 offset:2048
    ds_read_b64_tr_b16 a[90:91], v12 offset:2560
    buffer_load_dwordx4 v99, s[16:19], s51 offen offset:3072 lds
    v_mfma_f32_32x32x16_bf16 v[144:159], a[52:55], a[64:67], v[144:159]
    ds_read_b64_tr_b16 a[92:93], v13 offset:2048
    ds_read_b64_tr_b16 a[94:95], v13 offset:2560
    ds_read_b64_tr_b16 a[244:245], v63 offset:51200
    v_mfma_f32_32x32x16_bf16 v[160:175], a[56:59], a[64:67], v[160:175]
    ds_read_b64_tr_b16 a[96:97], v14 offset:2048
    ds_read_b64_tr_b16 a[98:99], v14 offset:2560
    s_add_u32 m0, s50, 81920
    s_lshl_b32 s51, s67, 4
    s_add_u32 s51, s51, s59
    buffer_load_dwordx4 v96, s[16:19], s51 offen offset:0 lds
    v_mfma_f32_32x32x16_bf16 v[176:191], a[60:63], a[64:67], v[176:191]
    ds_read_b64_tr_b16 a[100:101], v15 offset:2048
    ds_read_b64_tr_b16 a[102:103], v15 offset:2560
    ds_read_b64_tr_b16 a[246:247], v63 offset:52224
    v_mfma_f32_16x16x32_bf16 v[20:23], a[248:251], a[48:51], v[20:23]
    v_mfma_f32_16x16x32_bf16 v[88:91], a[248:251], a[52:55], v[88:91]
    s_waitcnt lgkmcnt(12)
    v_mfma_f32_32x32x16_bf16 v[128:143], a[68:71], a[84:87], v[128:143]
    buffer_load_dwordx4 v97, s[16:19], s51 offen offset:1024 lds
    s_waitcnt vmcnt(10)
    s_barrier
    ds_read_b128 a[64:67], v18 offset:32768
    ds_read_b64_tr_b16 a[48:49], v12 offset:32768
    ds_read_b64_tr_b16 a[50:51], v12 offset:33280
    v_mfma_f32_32x32x16_bf16 v[144:159], a[72:75], a[84:87], v[144:159]
    ds_read_b64_tr_b16 a[52:53], v13 offset:32768
    ds_read_b64_tr_b16 a[54:55], v13 offset:33280
    v_mfma_f32_32x32x16_bf16 v[160:175], a[76:79], a[84:87], v[160:175]
    ds_read_b64_tr_b16 a[56:57], v14 offset:32768
    ds_read_b64_tr_b16 a[58:59], v14 offset:33280
    buffer_load_dwordx4 v98, s[16:19], s51 offen offset:2048 lds
    v_mfma_f32_32x32x16_bf16 v[176:191], a[80:83], a[84:87], v[176:191]
    ds_read_b64_tr_b16 a[60:61], v15 offset:32768
    ds_read_b64_tr_b16 a[62:63], v15 offset:33280
    v_mfma_f32_16x16x32_bf16 v[20:23], a[248:251], a[68:71], v[20:23]
    v_mfma_f32_16x16x32_bf16 v[88:91], a[248:251], a[72:75], v[88:91]
    s_waitcnt lgkmcnt(10)
    v_mfma_f32_32x32x16_bf16 v[128:143], a[88:91], a[104:107], v[128:143]
    ds_read_b128 a[84:87], v19 offset:32768
    ds_read_b64_tr_b16 a[68:69], v12 offset:34816
    ds_read_b64_tr_b16 a[70:71], v12 offset:35328
    buffer_load_dwordx4 v99, s[16:19], s51 offen offset:3072 lds
    v_mfma_f32_32x32x16_bf16 v[144:159], a[92:95], a[104:107], v[144:159]
    ds_read_b64_tr_b16 a[72:73], v13 offset:34816
    ds_read_b64_tr_b16 a[74:75], v13 offset:35328
    s_waitcnt lgkmcnt(14)
    v_mfma_f32_32x32x16_bf16 v[160:175], a[96:99], a[104:107], v[160:175]
    ds_read_b64_tr_b16 a[76:77], v14 offset:34816
    ds_read_b64_tr_b16 a[78:79], v14 offset:35328
    s_add_u32 m0, s50, 49152
    s_lshl_b32 s51, s67, 4
    s_add_u32 s51, s51, s59
    s_add_u32 s51, s51, 32768
    buffer_load_dwordx4 v96, s[16:19], s51 offen offset:0 lds
    v_mfma_f32_32x32x16_bf16 v[176:191], a[100:103], a[104:107], v[176:191]
    ds_read_b64_tr_b16 a[80:81], v15 offset:34816
    ds_read_b64_tr_b16 a[82:83], v15 offset:35328
    v_mfma_f32_16x16x32_bf16 v[20:23], a[248:251], a[88:91], v[20:23]
    v_mfma_f32_16x16x32_bf16 v[88:91], a[248:251], a[92:95], v[88:91]
    s_waitcnt lgkmcnt(9)
    v_mfma_f32_32x32x16_bf16 v[128:143], a[48:51], a[64:67], v[128:143]
    ds_read_b128 a[104:107], v18 offset:4096
    v_add_u32 v12, 0x10000, v12
    v_add_u32 v13, 0x10000, v13
    v_add_u32 v14, 0x10000, v14
    v_add_u32 v15, 0x10000, v15
    ds_read_b64_tr_b16 a[88:89], v12 offset:49152
    ds_read_b64_tr_b16 a[90:91], v12 offset:49664
    buffer_load_dwordx4 v97, s[16:19], s51 offen offset:1024 lds
    v_mfma_f32_32x32x16_bf16 v[144:159], a[52:55], a[64:67], v[144:159]
    ds_read_b64_tr_b16 a[92:93], v13 offset:49152
    ds_read_b64_tr_b16 a[94:95], v13 offset:49664
    v_mfma_f32_32x32x16_bf16 v[160:175], a[56:59], a[64:67], v[160:175]
    ds_read_b64_tr_b16 a[96:97], v14 offset:49152
    ds_read_b64_tr_b16 a[98:99], v14 offset:49664
    buffer_load_dwordx4 v98, s[16:19], s51 offen offset:2048 lds
    v_mfma_f32_32x32x16_bf16 v[176:191], a[60:63], a[64:67], v[176:191]
    ds_read_b64_tr_b16 a[100:101], v15 offset:49152
    ds_read_b64_tr_b16 a[102:103], v15 offset:49664
    s_waitcnt vmcnt(11)
    v_add_u32 v62, 0x20000, v62
    v_add_u32 v63, 0x20000, v63
    ds_read_b64_tr_b16 a[160:161], v62 offset:0
    v_mfma_f32_16x16x32_bf16 v[20:23], a[248:251], a[48:51], v[20:23]
    v_mfma_f32_16x16x32_bf16 v[88:91], a[248:251], a[52:55], v[88:91]
    s_waitcnt lgkmcnt(10)
    v_mfma_f32_16x16x32_bf16 v[20:23], a[248:251], a[68:71], v[20:23]
    v_mfma_f32_16x16x32_bf16 v[88:91], a[248:251], a[72:75], v[88:91]
    v_mfma_f32_32x32x16_bf16 v[128:143], a[68:71], a[84:87], v[128:143]
    ds_read_b128 a[64:67], v19 offset:4096
    ds_read_b64_tr_b16 a[48:49], v12 offset:51200
    ds_read_b64_tr_b16 a[50:51], v12 offset:51712
    buffer_load_dwordx4 v99, s[16:19], s51 offen offset:3072 lds
    v_mfma_f32_32x32x16_bf16 v[144:159], a[72:75], a[84:87], v[144:159]
    ds_read_b64_tr_b16 a[52:53], v13 offset:51200
    ds_read_b64_tr_b16 a[54:55], v13 offset:51712
    ds_read_b64_tr_b16 a[162:163], v62 offset:1024
    v_mfma_f32_32x32x16_bf16 v[160:175], a[76:79], a[84:87], v[160:175]
    ds_read_b64_tr_b16 a[56:57], v14 offset:51200
    ds_read_b64_tr_b16 a[58:59], v14 offset:51712
    ds_read_b64_tr_b16 a[164:165], v63 offset:0
    v_mfma_f32_32x32x16_bf16 v[176:191], a[80:83], a[84:87], v[176:191]
    ds_read_b64_tr_b16 a[166:167], v63 offset:1024
    ds_read_b64_tr_b16 a[168:169], v62 offset:2048
    ds_read_b64_tr_b16 a[170:171], v62 offset:3072
    ds_read_b64_tr_b16 a[172:173], v63 offset:2048
    ds_read_b64_tr_b16 a[174:175], v63 offset:3072
    s_waitcnt lgkmcnt(0)
    v_cvt_pk_bf16_f32 v56, v20, v20
    v_lshlrev_b32 v56, 16, v56
    v_sub_f32 v57, v20, v56
    v_cvt_pk_bf16_f32 v58, v20, v57
    v_and_b32 v56, 0xffff0000, v58
    v_sub_f32 v57, v57, v56
    v_cvt_pk_bf16_f32 v59, v57, 0
    s_and_b32 s93, s40, 1
    s_lshl_b32 s93, s93, 2
    s_and_b32 s52, s40, 2
    s_add_u32 s93, s93, s52
    s_lshl_b32 s93, s93, 9
    s_add_u32 s93, s93, 155648
    v_lshl_add_u32 v0, v1, 3, s93
    ds_write_b64 v0, v[58:59] offset:0
    v_cvt_pk_bf16_f32 v60, v88, v88
    v_lshlrev_b32 v60, 16, v60
    v_sub_f32 v61, v88, v60
    v_cvt_pk_bf16_f32 v62, v88, v61
    v_and_b32 v60, 0xffff0000, v62
    v_sub_f32 v61, v61, v60
    v_cvt_pk_bf16_f32 v63, v61, 0
    ds_write_b64 v0, v[62:63] offset:512
    ds_read_b64_tr_b16 a[60:61], v15 offset:51200
    ds_read_b64_tr_b16 a[62:63], v15 offset:51712
    s_add_u32 m0, s50, 131072
    s_lshl_b32 s51, s68, 4
    s_add_u32 s51, s51, s59
    buffer_load_dwordx4 v96, s[16:19], s51 offen offset:0 lds
    v_mfma_f32_32x32x16_bf16 v[192:207], a[88:91], a[104:107], v[192:207]
    ds_read_b128 a[84:87], v16 offset:36864
    v_add_u32 v12, 0xffff0000, v12
    v_add_u32 v13, 0xffff0000, v13
    v_add_u32 v14, 0xffff0000, v14
    v_add_u32 v15, 0xffff0000, v15
    ds_read_b64_tr_b16 a[68:69], v12 offset:0
    ds_read_b64_tr_b16 a[70:71], v12 offset:512
    v_mfma_f32_32x32x16_bf16 v[208:223], a[92:95], a[104:107], v[208:223]
    s_lshr_b32 s51, s50, 1
    s_add_u32 m0, s51, 147456
    s_lshl_b32 s93, s95, 4
    s_add_u32 s51, s93, 0x800000
    buffer_load_dwordx4 v36, s[32:35], s51 offen offset:0 sc1 lds
    buffer_load_dwordx4 v37, s[32:35], s51 offen offset:1024 sc1 lds
    buffer_load_dword v38, v35, s[32:35], 0 offen sc1
    ds_read_b64_tr_b16 a[72:73], v13 offset:0
    ds_read_b64_tr_b16 a[74:75], v13 offset:512
    v_mfma_f32_32x32x16_bf16 v[224:239], a[96:99], a[104:107], v[224:239]
    s_waitcnt lgkmcnt(7)
    s_barrier
    ds_read_b64 v[56:57], v0
    v_xor_b32 v3, 512, v0
    ds_read_b64 v[58:59], v3
    v_xor_b32 v3, 1024, v0
    ds_read_b64 v[60:61], v3
    v_xor_b32 v3, 1536, v0
    ds_read_b64 v[62:63], v3
    ds_read_b64_tr_b16 a[76:77], v14 offset:0
    ds_read_b64_tr_b16 a[78:79], v14 offset:512
    s_add_u32 m0, s50, 131072
    s_lshl_b32 s51, s68, 4
    s_add_u32 s51, s51, s59
    buffer_load_dwordx4 v97, s[16:19], s51 offen offset:1024 lds
    v_mfma_f32_32x32x16_bf16 v[240:255], a[100:103], a[104:107], v[240:255]
    ds_read_b64_tr_b16 a[80:81], v15 offset:0
    ds_read_b64_tr_b16 a[82:83], v15 offset:512
    s_waitcnt lgkmcnt(13)
    v_mfma_f32_32x32x16_bf16 v[192:207], a[48:51], a[64:67], v[192:207]
    s_barrier
    s_waitcnt lgkmcnt(4)
    v_mfma_f32_32x32x8_bf16 v[128:143], v[56:57], v[32:33], v[128:143]
    ds_read_b128 a[104:107], v17 offset:36864
    ds_read_b64_tr_b16 a[88:89], v12 offset:2048
    ds_read_b64_tr_b16 a[90:91], v12 offset:2560
    buffer_load_dwordx4 v98, s[16:19], s51 offen offset:2048 lds
    v_mfma_f32_32x32x16_bf16 v[208:223], a[52:55], a[64:67], v[208:223]
    v_mfma_f32_32x32x8_bf16 v[144:159], v[58:59], v[32:33], v[144:159]
    ds_read_b64_tr_b16 a[92:93], v13 offset:2048
    ds_read_b64_tr_b16 a[94:95], v13 offset:2560
    buffer_load_dwordx4 v99, s[16:19], s51 offen offset:3072 lds
    v_mfma_f32_32x32x16_bf16 v[224:239], a[56:59], a[64:67], v[224:239]
    v_mfma_f32_32x32x8_bf16 v[160:175], v[60:61], v[32:33], v[160:175]
    ds_read_b64_tr_b16 a[96:97], v14 offset:2048
    ds_read_b64_tr_b16 a[98:99], v14 offset:2560
    s_add_u32 m0, s50, 65536
    s_lshl_b32 s51, s68, 4
    s_add_u32 s51, s51, s59
    s_add_u32 s51, s51, 32768
    buffer_load_dwordx4 v96, s[16:19], s51 offen offset:0 lds
    v_mfma_f32_32x32x16_bf16 v[240:255], a[60:63], a[64:67], v[240:255]
    v_mfma_f32_32x32x8_bf16 v[176:191], v[62:63], v[32:33], v[176:191]
    ds_read_b64_tr_b16 a[100:101], v15 offset:2048
    ds_read_b64_tr_b16 a[102:103], v15 offset:2560
    s_waitcnt lgkmcnt(9)
    v_mfma_f32_32x32x16_bf16 v[192:207], a[68:71], a[84:87], v[192:207]
    ds_read_b128 a[64:67], v18 offset:36864
    ds_read_b64_tr_b16 a[48:49], v12 offset:32768
    ds_read_b64_tr_b16 a[50:51], v12 offset:33280
    v_mfma_f32_32x32x16_bf16 v[208:223], a[72:75], a[84:87], v[208:223]
    ds_read_b64_tr_b16 a[52:53], v13 offset:32768
    ds_read_b64_tr_b16 a[54:55], v13 offset:33280
    s_bitcmp1_b32 s40, 0
    s_cselect_b32 s5, s57, s56
    s_lshl_b32 s5, s5, 5
    s_add_u32 s5, s5, s55
    v_lshlrev_b32 v22, 2, v1
    v_mul_f32 v128, v128, v34
    v_mul_f32 v129, v129, v34
    v_mul_f32 v130, v130, v34
    v_mul_f32 v131, v131, v34
    v_mul_f32 v132, v132, v34
    v_mfma_f32_32x32x16_bf16 v[224:239], a[76:79], a[84:87], v[224:239]
    ds_read_b64_tr_b16 a[56:57], v14 offset:32768
    ds_read_b64_tr_b16 a[58:59], v14 offset:33280
    v_mul_f32 v133, v133, v34
    v_mul_f32 v134, v134, v34
    v_mul_f32 v135, v135, v34
    v_mul_f32 v136, v128, v136
    v_mul_f32 v137, v129, v137
    v_mul_f32 v138, v130, v138
    v_mul_f32 v139, v131, v139
    v_mul_f32 v140, v132, v140
    v_mul_f32 v141, v133, v141
    v_mul_f32 v142, v134, v142
    v_mfma_f32_32x32x16_bf16 v[240:255], a[80:83], a[84:87], v[240:255]
    ds_read_b64_tr_b16 a[60:61], v15 offset:32768
    ds_read_b64_tr_b16 a[62:63], v15 offset:33280
    v_mul_f32 v143, v135, v143
    v_cvt_pk_bf16_f32 v128, v136, v137
    v_cvt_pk_bf16_f32 v129, v138, v139
    v_cvt_pk_bf16_f32 v130, v140, v141
    v_cvt_pk_bf16_f32 v131, v142, v143
    v_add3_u32 v20, v128, v129, 0
    v_add3_u32 v20, v130, v131, v20
    v_mul_f32 v144, v144, v34
    v_mul_f32 v145, v145, v34
    v_mul_f32 v146, v146, v34
    s_waitcnt lgkmcnt(9)
    v_mfma_f32_32x32x16_bf16 v[192:207], a[88:91], a[104:107], v[192:207]
    s_barrier
    ds_read_b128 a[84:87], v19 offset:36864
    ds_read_b64_tr_b16 a[68:69], v12 offset:34816
    ds_read_b64_tr_b16 a[70:71], v12 offset:35328
    s_xor_b32 s52, s5, 0
    buffer_store_dwordx4 v[128:131], v2, s[32:35], s52 offen sc1
    v_mul_f32 v147, v147, v34
    v_mul_f32 v148, v148, v34
    v_mul_f32 v149, v149, v34
    v_mul_f32 v150, v150, v34
    v_mfma_f32_32x32x16_bf16 v[208:223], a[92:95], a[104:107], v[208:223]
    ds_read_b64_tr_b16 a[72:73], v13 offset:34816
    ds_read_b64_tr_b16 a[74:75], v13 offset:35328
    v_mul_f32 v151, v151, v34
    v_mul_f32 v152, v144, v152
    v_mul_f32 v153, v145, v153
    v_mul_f32 v154, v146, v154
    v_mul_f32 v155, v147, v155
    v_mul_f32 v156, v148, v156
    v_mul_f32 v157, v149, v157
    v_mul_f32 v158, v150, v158
    v_mul_f32 v159, v151, v159
    v_cvt_pk_bf16_f32 v144, v152, v153
    v_mfma_f32_32x32x16_bf16 v[224:239], a[96:99], a[104:107], v[224:239]
    ds_read_b64_tr_b16 a[76:77], v14 offset:34816
    ds_read_b64_tr_b16 a[78:79], v14 offset:35328
    buffer_load_dwordx4 v97, s[16:19], s51 offen offset:1024 lds
    v_cvt_pk_bf16_f32 v145, v154, v155
    v_cvt_pk_bf16_f32 v146, v156, v157
    v_cvt_pk_bf16_f32 v147, v158, v159
    v_add3_u32 v20, v144, v145, v20
    v_add3_u32 v20, v146, v147, v20
    v_mul_f32 v160, v160, v34
    v_mul_f32 v161, v161, v34
    v_mfma_f32_32x32x16_bf16 v[240:255], a[100:103], a[104:107], v[240:255]
    ds_read_b64_tr_b16 a[80:81], v15 offset:34816
    ds_read_b64_tr_b16 a[82:83], v15 offset:35328
    s_xor_b32 s52, s5, 1024
    buffer_store_dwordx4 v[144:147], v2, s[32:35], s52 offen sc1
    v_mul_f32 v162, v162, v34
    v_mul_f32 v163, v163, v34
    v_mul_f32 v164, v164, v34
    v_mul_f32 v165, v165, v34
    v_mul_f32 v166, v166, v34
    v_mul_f32 v167, v167, v34
    s_waitcnt lgkmcnt(9)
    v_mfma_f32_32x32x16_bf16 v[192:207], a[48:51], a[64:67], v[192:207]
    v_mul_f32 v168, v160, v168
    v_mul_f32 v169, v161, v169
    v_mul_f32 v170, v162, v170
    v_mul_f32 v171, v163, v171
    v_mul_f32 v172, v164, v172
    v_mul_f32 v173, v165, v173
    v_mul_f32 v174, v166, v174
    v_mul_f32 v175, v167, v175
    v_cvt_pk_bf16_f32 v160, v168, v169
    v_cvt_pk_bf16_f32 v161, v170, v171
    v_cvt_pk_bf16_f32 v162, v172, v173
    v_cvt_pk_bf16_f32 v163, v174, v175
    v_mfma_f32_32x32x16_bf16 v[208:223], a[52:55], a[64:67], v[208:223]
    s_xor_b32 s52, s5, 2048
    buffer_store_dwordx4 v[160:163], v2, s[32:35], s52 offen sc1
    v_add3_u32 v20, v160, v161, v20
    v_add3_u32 v20, v162, v163, v20
    v_mul_f32 v176, v176, v34
    v_mul_f32 v177, v177, v34
    v_mul_f32 v178, v178, v34
    v_mul_f32 v179, v179, v34
    v_mul_f32 v180, v180, v34
    v_mul_f32 v181, v181, v34
    v_mfma_f32_32x32x16_bf16 v[224:239], a[56:59], a[64:67], v[224:239]
    v_mul_f32 v182, v182, v34
    v_mul_f32 v183, v183, v34
    v_mul_f32 v184, v176, v184
    v_mul_f32 v185, v177, v185
    v_mul_f32 v186, v178, v186
    v_mul_f32 v187, v179, v187
    v_mul_f32 v188, v180, v188
    v_mul_f32 v189, v181, v189
    v_mul_f32 v190, v182, v190
    v_mul_f32 v191, v183, v191
    v_cvt_pk_bf16_f32 v176, v184, v185
    v_cvt_pk_bf16_f32 v177, v186, v187
    v_mfma_f32_32x32x16_bf16 v[240:255], a[60:63], a[64:67], v[240:255]
    buffer_load_dwordx4 v98, s[16:19], s51 offen offset:2048 lds
    v_cvt_pk_bf16_f32 v178, v188, v189
    v_cvt_pk_bf16_f32 v179, v190, v191
    v_add3_u32 v20, v176, v177, v20
    v_add3_u32 v20, v178, v179, v20
    v_sub_u32 v20, s60, v20
    s_waitcnt lgkmcnt(0)
    v_mfma_f32_32x32x16_bf16 v[192:207], a[68:71], a[84:87], v[192:207]
    s_barrier
    s_xor_b32 s52, s5, 3072
    buffer_store_dwordx4 v[176:179], v2, s[32:35], s52 offen sc1
    v_mfma_f32_32x32x16_bf16 v[208:223], a[72:75], a[84:87], v[208:223]
    v_mfma_f32_32x32x16_bf16 v[224:239], a[76:79], a[84:87], v[224:239]
    s_lshr_b32 s52, s5, 12
    s_lshl_b32 s52, s52, 8
    s_add_u32 s52, s52, 0xc80000
    buffer_store_dword v20, v22, s[32:35], s52 offen sc1
    v_mfma_f32_32x32x16_bf16 v[240:255], a[80:83], a[84:87], v[240:255]
    v_mov_b32 v8, v96
    v_mov_b32 v16, v100
    v_mov_b32 v9, v97
    v_mov_b32 v17, v101
    v_mov_b32 v10, v98
    v_mov_b32 v18, v102
    v_mov_b32 v11, v99
    v_mov_b32 v19, v103
    v_mfma_f32_32x32x8_bf16 v[192:207], v[56:57], v[92:93], v[192:207]
    v_mfma_f32_32x32x8_bf16 v[208:223], v[58:59], v[92:93], v[208:223]
    v_mfma_f32_32x32x8_bf16 v[224:239], v[60:61], v[92:93], v[224:239]
    v_mfma_f32_32x32x8_bf16 v[240:255], v[62:63], v[92:93], v[240:255]
    v_lshrrev_b32 v40, 5, v1
    v_bfe_u32 v41, v1, 2, 2
    v_lshlrev_b32 v42, 9, v40
    v_lshl_add_u32 v42, v41, 7, v42
    v_and_b32 v43, 3, v1
    v_lshl_add_u32 v42, v43, 3, v42
    v_add_u32 v42, s50, v42
    v_and_b32 v41, 2, v41
    v_bfe_u32 v43, v1, 4, 1
    v_or_b32 v41, v41, v43
    s_and_b32 s53, s40, 1
    s_lshl_b32 s53, s53, 1
    v_xor_b32 v41, s53, v41
    v_lshl_add_u32 v12, v41, 5, v42
    v_xor_b32 v13, 64, v12
    v_lshrrev_b32 v40, 1, v1
    v_lshlrev_b32 v40, 7, v40
    v_and_b32 v41, 1, v1
    v_lshl_add_u32 v40, v41, 5, v40
    v_add_u32 v14, s50, v40
    v_mul_f32 v192, v192, v94
    v_mul_f32 v193, v193, v94
    v_mul_f32 v194, v194, v94
    v_mul_f32 v195, v195, v94
    v_mul_f32 v196, v196, v94
    v_mul_f32 v197, v197, v94
    v_mul_f32 v198, v198, v94
    v_mul_f32 v199, v199, v94
    v_mul_f32 v200, v192, v200
    v_mul_f32 v201, v193, v201
    v_mul_f32 v202, v194, v202
    v_mul_f32 v203, v195, v203
    v_mul_f32 v204, v196, v204
    v_mul_f32 v205, v197, v205
    v_mul_f32 v206, v198, v206
    v_mul_f32 v207, v199, v207
    v_cvt_pk_bf16_f32 v192, v200, v201
    v_cvt_pk_bf16_f32 v193, v202, v203
    v_cvt_pk_bf16_f32 v194, v204, v205
    v_cvt_pk_bf16_f32 v195, v206, v207
    s_xor_b32 s52, s5, 0
    s_add_u32 s52, s52, 114688
    buffer_store_dwordx4 v[192:195], v2, s[32:35], s52 offen sc1
    v_add3_u32 v21, v192, v193, 0
    v_add3_u32 v21, v194, v195, v21
    v_mul_f32 v208, v208, v94
    v_mul_f32 v209, v209, v94
    v_mul_f32 v210, v210, v94
    v_mul_f32 v211, v211, v94
    v_mul_f32 v212, v212, v94
    v_mul_f32 v213, v213, v94
    v_mul_f32 v214, v214, v94
    v_mul_f32 v215, v215, v94
    v_mul_f32 v216, v208, v216
    v_mul_f32 v217, v209, v217
    v_mul_f32 v218, v210, v218
    v_mul_f32 v219, v211, v219
    v_mul_f32 v220, v212, v220
    v_mul_f32 v221, v213, v221
    v_mul_f32 v222, v214, v222
    v_mul_f32 v223, v215, v223
    v_cvt_pk_bf16_f32 v208, v216, v217
    v_cvt_pk_bf16_f32 v209, v218, v219
    v_cvt_pk_bf16_f32 v210, v220, v221
    v_cvt_pk_bf16_f32 v211, v222, v223
    s_xor_b32 s52, s5, 1024
    s_add_u32 s52, s52, 114688
    buffer_store_dwordx4 v[208:211], v2, s[32:35], s52 offen sc1
    v_add3_u32 v21, v208, v209, v21
    v_add3_u32 v21, v210, v211, v21
    v_mul_f32 v224, v224, v94
    v_mul_f32 v225, v225, v94
    v_mul_f32 v226, v226, v94
    v_mul_f32 v227, v227, v94
    v_mul_f32 v228, v228, v94
    v_mul_f32 v229, v229, v94
    v_mul_f32 v230, v230, v94
    v_mul_f32 v231, v231, v94
    v_mul_f32 v232, v224, v232
    v_mul_f32 v233, v225, v233
    v_mul_f32 v234, v226, v234
    v_mul_f32 v235, v227, v235
    v_mul_f32 v236, v228, v236
    v_mul_f32 v237, v229, v237
    v_mul_f32 v238, v230, v238
    v_mul_f32 v239, v231, v239
    v_cvt_pk_bf16_f32 v224, v232, v233
    v_cvt_pk_bf16_f32 v225, v234, v235
    v_cvt_pk_bf16_f32 v226, v236, v237
    v_cvt_pk_bf16_f32 v227, v238, v239
    s_xor_b32 s52, s5, 2048
    s_add_u32 s52, s52, 114688
    buffer_store_dwordx4 v[224:227], v2, s[32:35], s52 offen sc1
    v_add3_u32 v21, v224, v225, v21
    v_add3_u32 v21, v226, v227, v21
    v_mul_f32 v240, v240, v94
    v_mul_f32 v241, v241, v94
    v_mul_f32 v242, v242, v94
    v_mul_f32 v243, v243, v94
    v_mul_f32 v244, v244, v94
    v_mul_f32 v245, v245, v94
    v_mul_f32 v246, v246, v94
    v_mul_f32 v247, v247, v94
    v_mul_f32 v248, v240, v248
    v_mul_f32 v249, v241, v249
    v_mul_f32 v250, v242, v250
    v_mul_f32 v251, v243, v251
    v_mul_f32 v252, v244, v252
    v_mul_f32 v253, v245, v253
    v_mul_f32 v254, v246, v254
    v_mul_f32 v255, v247, v255
    v_cvt_pk_bf16_f32 v240, v248, v249
    v_cvt_pk_bf16_f32 v241, v250, v251
    v_cvt_pk_bf16_f32 v242, v252, v253
    v_cvt_pk_bf16_f32 v243, v254, v255
    s_xor_b32 s52, s5, 3072
    s_add_u32 s52, s52, 114688
    buffer_store_dwordx4 v[240:243], v2, s[32:35], s52 offen sc1
    v_add3_u32 v21, v240, v241, v21
    v_add3_u32 v21, v242, v243, v21
    v_sub_u32 v21, s60, v21
    s_lshr_b32 s52, s5, 12
    s_lshl_b32 s52, s52, 8
    s_add_u32 s52, s52, 0xc81c00
    buffer_store_dword v21, v22, s[32:35], s52 offen sc1
    s_barrier
    v_lshrrev_b32 v60, 4, v1
    v_bfe_u32 v57, v1, 2, 2
    v_lshlrev_b32 v58, 10, v60
    v_lshl_add_u32 v58, v57, 7, v58
    v_and_b32 v59, 3, v1
    v_lshl_add_u32 v58, v59, 3, v58
    v_add_u32 v58, 147456, v58
    v_lshrrev_b32 v57, 1, v57
    v_and_b32 v56, 1, v60
    v_lshl_or_b32 v57, v56, 1, v57
    buffer_load_dwordx4 v11, s[16:19], s51 offen offset:3072 lds
    v_xor_b32 v59, 0, v57
    v_lshl_add_u32 v52, v59, 5, v58
    v_xor_b32 v59, 1, v57
    v_lshl_add_u32 v53, v59, 5, v58
    v_xor_b32 v59, 2, v57
    v_lshl_add_u32 v54, v59, 5, v58
    v_xor_b32 v59, 3, v57
    v_lshl_add_u32 v55, v59, 5, v58
    v_lshrrev_b32 v56, 1, v60
    s_lshl_b32 s53, s40, 1
    v_add_u32 v56, s53, v56
    v_lshlrev_b32 v58, 1, v1
    v_xor_b32 v56, v56, v58
    v_and_b32 v56, 7, v56
    v_and_b32 v57, 15, v1
    v_lshlrev_b32 v61, 9, v57
    v_lshl_add_u32 v61, v56, 4, v61
    v_and_b32 v56, 1, v60
    v_lshl_add_u32 v61, v56, 3, v61
    v_add_u32 v61, 155648, v61
    v_bfe_u32 v56, v1, 2, 2
    v_and_b32 v58, 3, v1
    v_lshl_add_u32 v56, v56, 3, v58
    v_xor_b32 v58, v58, v60
    v_lshlrev_b32 v62, 8, v56
    v_lshl_add_u32 v62, v58, 4, v62
    v_add_u32 v62, 155648, v62
    s_lshr_b32 s53, s50, 1
    s_add_u32 s53, s53, 147456
    v_and_b32 v56, 7, v1
    v_xor_b32 v63, v56, v60
    v_lshlrev_b32 v63, 4, v63
    v_lshl_add_u32 v63, v57, 7, v63
    v_add_u32 v63, s53, v63
    v_lshrrev_b32 v58, 3, v1
    v_xor_b32 v59, v56, v58
    v_lshlrev_b32 v59, 4, v59
    v_lshl_add_u32 v59, v58, 7, v59
    v_add_u32 v59, s53, v59
    v_lshlrev_b32 v32, 15, v58
    v_lshl_add_u32 v32, v56, 4, v32
    v_lshrrev_b32 v58, 2, v1
    v_and_b32 v56, 3, v1
    v_lshlrev_b32 v33, 12, v58
    v_lshl_add_u32 v33, v56, 2, v33
    v_lshl_add_u32 v56, v56, 4, v58
    v_lshlrev_b32 v56, 2, v56
    v_xor_b32 v57, 64, v63
    s_lshl_b32 s6, s40, 19
    s_lshl_b32 s53, s48, 12
    s_add_u32 s6, s6, s53
    s_lshl_b32 s53, s49, 7
    s_add_u32 s6, s6, s53
    s_lshr_b32 s53, s50, 1
    s_add_u32 s53, s53, 147456
    v_lshl_add_u32 v48, v1, 5, s53
    s_waitcnt vmcnt(17)
    ds_read_b128 v[40:43], v48
    ds_read_b128 v[44:47], v48 offset:16
    s_waitcnt lgkmcnt(0)
    v_add3_u32 v40, v40, v41, v42
    v_add3_u32 v44, v44, v45, v46
    v_add3_u32 v40, v40, v43, v47
    v_add_u32 v40, v40, v44
    s_nop 1
    v_add_u32_dpp v40, v40, v40 quad_perm:[1,0,3,2] row_mask:0xf bank_mask:0xf
    s_nop 1
    v_add_u32_dpp v40, v40, v40 quad_perm:[2,3,0,1] row_mask:0xf bank_mask:0xf
    v_add_u32 v40, v40, v38
    v_cmp_ne_u32 vcc, s60, v40
    s_cbranch_vccnz L_spin_6
L_ok_5:
    s_barrier
    ds_read_b64_tr_b16 a[24:25], v52 offset:0
    ds_read_b64_tr_b16 a[26:27], v52 offset:512
    ds_read_b64_tr_b16 a[28:29], v53 offset:0
    ds_read_b64_tr_b16 a[30:31], v53 offset:512
    ds_read_b64_tr_b16 a[32:33], v54 offset:0
    ds_read_b64_tr_b16 a[34:35], v54 offset:512
    ds_read_b64_tr_b16 a[36:37], v55 offset:0
    ds_read_b64_tr_b16 a[38:39], v55 offset:512
    ds_read_b64_tr_b16 a[40:41], v52 offset:4096
    ds_read_b64_tr_b16 a[42:43], v52 offset:4608
    ds_read_b64_tr_b16 a[44:45], v53 offset:4096
    ds_read_b64_tr_b16 a[46:47], v53 offset:4608
    ds_read_b64_tr_b16 a[248:249], v54 offset:4096
    ds_read_b64_tr_b16 a[250:251], v54 offset:4608
    ds_read_b64_tr_b16 a[252:253], v55 offset:4096
    ds_read_b64_tr_b16 a[254:255], v55 offset:4608
    s_waitcnt lgkmcnt(8)
    v_mfma_f32_16x16x32_bf16 v[64:67], a[112:115], a[24:27], 0
    v_mfma_f32_16x16x32_bf16 v[68:71], a[112:115], a[32:35], 0
    v_mfma_f32_16x16x32_bf16 v[64:67], a[120:123], a[32:35], v[64:67]
    v_mfma_f32_16x16x32_bf16 v[68:71], a[128:131], a[24:27], v[68:71]
    v_mfma_f32_16x16x32_bf16 v[72:75], a[112:115], a[28:31], 0
    v_mfma_f32_16x16x32_bf16 v[76:79], a[112:115], a[36:39], 0
    v_mfma_f32_16x16x32_bf16 v[72:75], a[120:123], a[36:39], v[72:75]
    v_mfma_f32_16x16x32_bf16 v[76:79], a[128:131], a[28:31], v[76:79]
    s_waitcnt lgkmcnt(0)
    v_mfma_f32_16x16x32_bf16 v[64:67], a[116:119], a[40:43], v[64:67]
    v_mfma_f32_16x16x32_bf16 v[68:71], a[116:119], a[248:251], v[68:71]
    v_mfma_f32_16x16x32_bf16 v[64:67], a[124:127], a[248:251], v[64:67]
    v_mfma_f32_16x16x32_bf16 v[68:71], a[132:135], a[40:43], v[68:71]
    v_mfma_f32_16x16x32_bf16 v[72:75], a[116:119], a[44:47], v[72:75]
    v_mfma_f32_16x16x32_bf16 v[76:79], a[116:119], a[252:255], v[76:79]
    v_mfma_f32_16x16x32_bf16 v[72:75], a[124:127], a[252:255], v[72:75]
    v_mfma_f32_16x16x32_bf16 v[76:79], a[132:135], a[44:47], v[76:79]
    v_lshlrev_b32 v48, 16, v80
    v_lshlrev_b32 v49, 16, v81
    s_nop 0
    v_mul_f32 v40, v64, v48
    v_mul_f32 v44, v64, v49
    v_fma_f32 v40, -v68, v49, v40
    v_fmac_f32 v44, v68, v48
    v_lshlrev_b32 v50, 16, v82
    v_lshlrev_b32 v51, 16, v83
    v_mul_f32 v41, v65, v50
    v_mul_f32 v45, v65, v51
    v_fma_f32 v41, -v69, v51, v41
    v_fmac_f32 v45, v69, v50
    v_lshlrev_b32 v48, 16, v84
    v_lshlrev_b32 v49, 16, v85
    v_mul_f32 v42, v66, v48
    v_mul_f32 v46, v66, v49
    v_fma_f32 v42, -v70, v49, v42
    v_fmac_f32 v46, v70, v48
    v_lshlrev_b32 v50, 16, v86
    v_lshlrev_b32 v51, 16, v87
    v_mul_f32 v43, v67, v50
    v_mul_f32 v47, v67, v51
    v_fma_f32 v43, -v71, v51, v43
    v_fmac_f32 v47, v71, v50
    v_cvt_pk_bf16_f32 v64, v40, v41
    v_cvt_pk_bf16_f32 v65, v42, v43
    ds_write_b64 v61, v[64:65] offset:0
    v_cvt_pk_bf16_f32 v66, v44, v45
    v_cvt_pk_bf16_f32 v67, v46, v47
    ds_write_b64 v61, v[66:67] offset:128
    v_and_b32 v48, 0xffff0000, v80
    v_and_b32 v49, 0xffff0000, v81
    v_mul_f32 v40, v72, v48
    v_mul_f32 v44, v72, v49
    v_fma_f32 v40, -v76, v49, v40
    v_fmac_f32 v44, v76, v48
    v_and_b32 v50, 0xffff0000, v82
    v_and_b32 v51, 0xffff0000, v83
    v_mul_f32 v41, v73, v50
    v_mul_f32 v45, v73, v51
    v_fma_f32 v41, -v77, v51, v41
    v_fmac_f32 v45, v77, v50
    v_and_b32 v48, 0xffff0000, v84
    v_and_b32 v49, 0xffff0000, v85
    v_mul_f32 v42, v74, v48
    v_mul_f32 v46, v74, v49
    v_fma_f32 v42, -v78, v49, v42
    v_fmac_f32 v46, v78, v48
    v_and_b32 v50, 0xffff0000, v86
    v_and_b32 v51, 0xffff0000, v87
    v_mul_f32 v43, v75, v50
    v_mul_f32 v47, v75, v51
    v_fma_f32 v43, -v79, v51, v43
    v_fmac_f32 v47, v79, v50
    v_xor_b32 v61, 16, v61
    v_cvt_pk_bf16_f32 v72, v40, v41
    v_cvt_pk_bf16_f32 v73, v42, v43
    ds_write_b64 v61, v[72:73] offset:256
    v_cvt_pk_bf16_f32 v74, v44, v45
    v_cvt_pk_bf16_f32 v75, v46, v47
    ds_write_b64 v61, v[74:75] offset:384
    s_waitcnt lgkmcnt(0)
    s_barrier
    ds_read_b128 a[24:27], v62 offset:0
    ds_read_b128 a[28:31], v62 offset:1088
    ds_read_b128 a[32:35], v62 offset:128
    ds_read_b128 a[36:39], v62 offset:1216
    ds_read_b128 a[40:43], v62 offset:64
    ds_read_b128 a[44:47], v62 offset:1024
    ds_read_b128 a[248:251], v62 offset:192
    ds_read_b128 a[252:255], v62 offset:1152
    s_waitcnt lgkmcnt(4)
    buffer_load_dwordx4 v[160:163], v16, s[32:35], s64 offen offset:0 sc1
    v_mfma_f32_16x16x32_bf16 v[64:67], a[24:27], a[136:139], 0
    v_mfma_f32_16x16x32_bf16 v[68:71], a[32:35], a[136:139], 0
    v_mfma_f32_16x16x32_bf16 v[64:67], a[32:35], a[152:155], v[64:67]
    v_mfma_f32_16x16x32_bf16 v[68:71], a[24:27], a[144:147], v[68:71]
    buffer_load_dwordx4 v[164:167], v17, s[32:35], s64 offen offset:0 sc1
    v_mfma_f32_16x16x32_bf16 v[72:75], a[28:31], a[136:139], 0
    v_mfma_f32_16x16x32_bf16 v[76:79], a[36:39], a[136:139], 0
    v_mfma_f32_16x16x32_bf16 v[72:75], a[36:39], a[152:155], v[72:75]
    v_mfma_f32_16x16x32_bf16 v[76:79], a[28:31], a[144:147], v[76:79]
    buffer_load_dwordx4 v[168:171], v16, s[32:35], s64 offen offset:1024 sc1
    s_waitcnt lgkmcnt(0)
    v_mfma_f32_16x16x32_bf16 v[64:67], a[40:43], a[140:143], v[64:67]
    v_mfma_f32_16x16x32_bf16 v[68:71], a[248:251], a[140:143], v[68:71]
    v_mfma_f32_16x16x32_bf16 v[64:67], a[248:251], a[156:159], v[64:67]
    buffer_load_dwordx4 v[172:175], v17, s[32:35], s64 offen offset:1024 sc1
    v_mfma_f32_16x16x32_bf16 v[68:71], a[40:43], a[148:151], v[68:71]
    v_mfma_f32_16x16x32_bf16 v[72:75], a[44:47], a[140:143], v[72:75]
    v_mfma_f32_16x16x32_bf16 v[76:79], a[252:255], a[140:143], v[76:79]
    v_mfma_f32_16x16x32_bf16 v[72:75], a[252:255], a[156:159], v[72:75]
    buffer_load_dwordx4 v[176:179], v16, s[32:35], s64 offen offset:2048 sc1
    v_mfma_f32_16x16x32_bf16 v[76:79], a[44:47], a[148:151], v[76:79]
    s_nop 0
    v_cvt_pk_bf16_f32 v40, v64, v65
    v_cvt_pk_bf16_f32 v41, v66, v67
    s_nop 2
    v_cvt_pk_bf16_f32 v42, v72, v73
    v_cvt_pk_bf16_f32 v43, v74, v75
    v_cvt_pk_bf16_f32 v44, v68, v69
    buffer_load_dwordx4 v[180:183], v17, s[32:35], s64 offen offset:2048 sc1
    v_cvt_pk_bf16_f32 v45, v70, v71
    v_cvt_pk_bf16_f32 v46, v76, v77
    v_cvt_pk_bf16_f32 v47, v78, v79
    ds_write_b128 v63, v[40:43]
    ds_write_b128 v57, v[44:47]
    v_add3_u32 v48, v40, v41, 0
    v_add3_u32 v49, v42, v43, v44
    v_add3_u32 v48, v48, v45, v46
    v_add3_u32 v48, v48, v49, v47
    buffer_load_dwordx4 v[184:187], v16, s[32:35], s64 offen offset:3072 sc1
    v_sub_u32 v48, s60, v48
    ds_read_b128 a[144:147], v59 offset:0
    ds_read_b128 a[148:151], v59 offset:1024
    ds_bpermute_b32 v34, v56, v48
    buffer_load_dwordx4 v[188:191], v17, s[32:35], s64 offen offset:3072 sc1
    buffer_load_dword v24, v18, s[32:35], s72 offen sc1
    buffer_load_dword v25, v19, s[32:35], s72 offen sc1
    v_lshrrev_b32 v40, 3, v1
    v_lshlrev_b32 v40, 7, v40
    v_bfe_u32 v41, v1, 4, 1
    v_xor_b32 v41, s40, v41
    v_and_b32 v41, 1, v41
    v_lshlrev_b32 v41, 6, v41
    s_waitcnt lgkmcnt(0)
    s_add_u32 s52, s6, 0xa00000
    buffer_store_dwordx4 a[144:147], v32, s[32:35], s52 offen sc1
    s_add_u32 s52, s6, 0xa40000
    buffer_store_dwordx4 a[148:151], v32, s[32:35], s52 offen sc1
    v_and_b32 v42, 0x70, v2
    v_xor_b32 v41, v41, v42
    v_add_u32 v38, v40, v41
    v_lshlrev_b32 v35, 3, v1
    v_and_b32 v43, 31, v1
    v_lshlrev_b32 v43, 16, v43
    v_lshrrev_b32 v44, 5, v1
    v_lshl_add_u32 v36, v44, 3, v43
    v_lshl_add_u32 v37, v44, 4, v43
    s_lshr_b32 s54, s63, 15
    s_lshl_b32 s54, s54, 10
    s_lshr_b32 s52, s6, 3
    s_add_u32 s52, s52, 0xd40000
    buffer_store_dword v34, v33, s[32:35], s52 offen sc1
    s_lshl_b32 s53, s47, 7
    s_add_u32 s54, s54, s53
    s_and_b32 s53, s40, 1
    s_lshl_b32 s53, s53, 6
    s_add_u32 s7, s54, s53
    v_and_b32 v59, 1, v1
    v_mul_lo_u32 v59, v59, s62
    v_and_b32 v61, 31, v1
    v_cvt_f32_u32 v61, v61
    v_mul_f32 v61, 0x3d000000, v61
    v_lshrrev_b32 v60, 5, v1
    buffer_load_dwordx4 v[192:195], v16, s[32:35], s65 offen offset:0 sc1
    v_lshlrev_b32 v60, 2, v60
    v_cvt_f32_u32 v60, v60
    v_mul_f32 v60, v60, v61
    v_mov_b32 v40, v60
    v_fmamk_f32 v41, v61, 0x3f800000, v60
    v_fmamk_f32 v42, v61, 0x40000000, v60
    v_fmamk_f32 v43, v61, 0x40400000, v60
    v_cos_f32 v44, v40
    v_cos_f32 v45, v41
    buffer_load_dwordx4 v[196:199], v17, s[32:35], s65 offen offset:0 sc1
    v_cos_f32 v46, v42
    v_cos_f32 v47, v43
    v_sin_f32 v48, v40
    v_sin_f32 v49, v41
    v_sin_f32 v50, v42
    v_sin_f32 v51, v43
    buffer_load_dwordx4 v[200:203], v16, s[32:35], s65 offen offset:1024 sc1
    v_cvt_pk_bf16_f32 v52, v44, v45
    v_cvt_pk_bf16_f32 v53, v48, v49
    v_xor_b32 v54, v59, v52
    v_xor_b32 v55, v59, v53
    v_xor_b32 v56, s62, v53
    v_xor_b32 v57, s62, v55
    v_accvgpr_write_b32 a24, v52
    v_accvgpr_write_b32 a32, v53
    v_accvgpr_write_b32 a28, v54
    v_accvgpr_write_b32 a36, v55
    v_accvgpr_write_b32 a40, v56
    v_accvgpr_write_b32 a44, v57
    v_cvt_pk_bf16_f32 v52, v46, v47
    v_cvt_pk_bf16_f32 v53, v50, v51
    buffer_load_dwordx4 v[204:207], v17, s[32:35], s65 offen offset:1024 sc1
    v_xor_b32 v54, v59, v52
    v_xor_b32 v55, v59, v53
    v_xor_b32 v56, s62, v53
    v_xor_b32 v57, s62, v55
    v_accvgpr_write_b32 a25, v52
    v_accvgpr_write_b32 a33, v53
    v_accvgpr_write_b32 a29, v54
    v_accvgpr_write_b32 a37, v55
    v_accvgpr_write_b32 a41, v56
    v_accvgpr_write_b32 a45, v57
    v_fmamk_f32 v40, v61, 0x41000000, v60
    v_fmamk_f32 v41, v61, 0x41100000, v60
    v_fmamk_f32 v42, v61, 0x41200000, v60
    buffer_load_dwordx4 v[208:211], v16, s[32:35], s65 offen offset:2048 sc1
    v_fmamk_f32 v43, v61, 0x41300000, v60
    v_cos_f32 v44, v40
    v_cos_f32 v45, v41
    v_cos_f32 v46, v42
    v_cos_f32 v47, v43
    v_sin_f32 v48, v40
    v_sin_f32 v49, v41
    v_sin_f32 v50, v42
    buffer_load_dwordx4 v[212:215], v17, s[32:35], s65 offen offset:2048 sc1
    v_sin_f32 v51, v43
    v_cvt_pk_bf16_f32 v52, v44, v45
    v_cvt_pk_bf16_f32 v53, v48, v49
    v_xor_b32 v54, v59, v52
    v_xor_b32 v55, v59, v53
    v_xor_b32 v56, s62, v53
    v_xor_b32 v57, s62, v55
    v_accvgpr_write_b32 a26, v52
    v_accvgpr_write_b32 a34, v53
    v_accvgpr_write_b32 a30, v54
    v_accvgpr_write_b32 a38, v55
    buffer_load_dwordx4 v[216:219], v16, s[32:35], s65 offen offset:3072 sc1
    v_accvgpr_write_b32 a42, v56
    v_accvgpr_write_b32 a46, v57
    v_cvt_pk_bf16_f32 v52, v46, v47
    v_cvt_pk_bf16_f32 v53, v50, v51
    v_xor_b32 v54, v59, v52
    v_xor_b32 v55, v59, v53
    v_xor_b32 v56, s62, v53
    v_xor_b32 v57, s62, v55
    v_accvgpr_write_b32 a27, v52
    v_accvgpr_write_b32 a35, v53
    v_accvgpr_write_b32 a31, v54
    v_accvgpr_write_b32 a39, v55
    v_accvgpr_write_b32 a43, v56
    v_accvgpr_write_b32 a47, v57
    buffer_load_dwordx4 v[220:223], v17, s[32:35], s65 offen offset:3072 sc1
    v_and_b32 v40, 1, v1
    v_cmp_eq_u32 s[84:85], 1, v40
    v_bfe_u32 v41, v1, 1, 1
    v_mul_lo_u32 v58, v41, s62
    v_xor_b32 v41, v41, v40
    v_mul_lo_u32 v59, v41, s62
    s_and_b32 s53, s40, 1
    s_waitcnt vmcnt(11)
    v_add3_u32 v24, v160, v161, v24
    v_add3_u32 v24, v162, v163, v24
    v_add3_u32 v24, v168, v169, v24
    v_add3_u32 v24, v170, v171, v24
    v_add3_u32 v24, v176, v177, v24
    v_add3_u32 v24, v178, v179, v24
    v_add3_u32 v24, v184, v185, v24
    v_add3_u32 v24, v186, v187, v24
    v_add3_u32 v25, v164, v165, v25
    v_add3_u32 v25, v166, v167, v25
    v_add3_u32 v25, v172, v173, v25
    v_add3_u32 v25, v174, v175, v25
    v_add3_u32 v25, v180, v181, v25
    v_add3_u32 v25, v182, v183, v25
    v_add3_u32 v25, v188, v189, v25
    v_add3_u32 v25, v190, v191, v25
    v_bitop3_b32 v24, v24, v25, s60 bitop3:0x7e
    v_cmp_ne_u32 vcc, 0, v24
    s_cbranch_vccnz L_spin_8
L_ok_7:
    v_mfma_f32_32x32x16_bf16 a[48:63], a[184:187], v[160:163], 0
    buffer_load_dword v26, v18, s[32:35], s73 offen sc1
    buffer_load_dword v27, v19, s[32:35], s73 offen sc1
    v_mfma_f32_32x32x16_bf16 a[64:79], a[188:191], v[160:163], 0
    s_xor_b32 s53, s53, 0
    s_lshl_b32 s53, s53, 5
    s_lshl_b32 s54, s47, 6
    s_add_u32 s53, s53, s54
    v_and_b32 v61, 31, v1
    v_add_u32 v61, s53, v61
    v_mfma_f32_32x32x16_bf16 a[80:95], a[184:187], v[164:167], 0
    v_cvt_f32_u32 v61, v61
    v_mul_f32 v61, 0x3b000000, v61
    s_lshl_b32 s53, s40, 5
    v_lshrrev_b32 v60, 5, v1
    v_lshl_add_u32 v60, v60, 2, s53
    v_cvt_f32_u32 v60, v60
    v_mfma_f32_32x32x16_bf16 a[96:111], a[188:191], v[164:167], 0
    buffer_load_dwordx4 v[224:227], v16, s[32:35], s66 offen offset:0 sc1
    v_mul_f32 v60, v60, v61
    v_fmamk_f32 v40, v61, 0x3f800000, v60
    v_fmamk_f32 v41, v61, 0x40000000, v60
    v_mfma_f32_32x32x16_bf16 a[48:63], a[192:195], v[168:171], a[48:63]
    v_fmamk_f32 v42, v61, 0x40400000, v60
    v_fmamk_f32 v43, v61, 0x40800000, v60
    v_cos_f32 v44, v40
    v_cos_f32 v45, v41
    v_mfma_f32_32x32x16_bf16 a[64:79], a[196:199], v[168:171], a[64:79]
    buffer_load_dwordx4 v[228:231], v17, s[32:35], s66 offen offset:0 sc1
    v_cos_f32 v46, v42
    v_mfma_f32_32x32x16_bf16 a[80:95], a[192:195], v[172:175], a[80:95]
    v_cos_f32 v47, v43
    v_sin_f32_e64 v48, -v40
    v_sin_f32_e64 v49, -v41
    v_mfma_f32_32x32x16_bf16 a[96:111], a[196:199], v[172:175], a[96:111]
    v_sin_f32_e64 v50, -v42
    v_sin_f32_e64 v51, -v43
    v_cvt_pk_bf16_f32 v64, v44, v45
    v_cvt_pk_bf16_f32 v80, v48, v49
    v_mfma_f32_32x32x16_bf16 a[48:63], a[200:203], v[176:179], a[48:63]
    v_cndmask_b32 v96, v64, v80, s[84:85]
    v_cndmask_b32 v112, v80, v64, s[84:85]
    v_xor_b32 v96, v58, v96
    v_xor_b32 v112, v59, v112
    v_cvt_pk_bf16_f32 v65, v46, v47
    v_cvt_pk_bf16_f32 v81, v50, v51
    v_cndmask_b32 v97, v65, v81, s[84:85]
    v_cndmask_b32 v113, v81, v65, s[84:85]
    v_xor_b32 v97, v58, v97
    v_xor_b32 v113, v59, v113
    v_fmamk_f32 v40, v61, 0x41100000, v60
    v_fmamk_f32 v41, v61, 0x41200000, v60
    v_fmamk_f32 v42, v61, 0x41300000, v60
    v_fmamk_f32 v43, v61, 0x41400000, v60
    buffer_load_dwordx4 v[232:235], v16, s[32:35], s66 offen offset:1024 sc1
    v_cos_f32 v44, v40
    v_cos_f32 v45, v41
    v_cos_f32 v46, v42
    v_cos_f32 v47, v43
    v_sin_f32_e64 v48, -v40
    v_sin_f32_e64 v49, -v41
    v_sin_f32_e64 v50, -v42
    v_sin_f32_e64 v51, -v43
    v_cvt_pk_bf16_f32 v66, v44, v45
    v_cvt_pk_bf16_f32 v82, v48, v49
    v_cndmask_b32 v98, v66, v82, s[84:85]
    v_cndmask_b32 v114, v82, v66, s[84:85]
    v_xor_b32 v98, v58, v98
    v_xor_b32 v114, v59, v114
    v_cvt_pk_bf16_f32 v67, v46, v47
    v_cvt_pk_bf16_f32 v83, v50, v51
    v_cndmask_b32 v99, v67, v83, s[84:85]
    v_cndmask_b32 v115, v83, v67, s[84:85]
    v_xor_b32 v99, v58, v99
    v_xor_b32 v115, v59, v115
    v_fmamk_f32 v40, v61, 0x41880000, v60
    v_fmamk_f32 v41, v61, 0x41900000, v60
    v_fmamk_f32 v42, v61, 0x41980000, v60
    v_fmamk_f32 v43, v61, 0x41a00000, v60
    v_cos_f32 v44, v40
    v_cos_f32 v45, v41
    buffer_load_dwordx4 v[236:239], v17, s[32:35], s66 offen offset:1024 sc1
    v_cos_f32 v46, v42
    v_cos_f32 v47, v43
    v_sin_f32_e64 v48, -v40
    v_sin_f32_e64 v49, -v41
    v_sin_f32_e64 v50, -v42
    v_sin_f32_e64 v51, -v43
    v_cvt_pk_bf16_f32 v72, v44, v45
    v_cvt_pk_bf16_f32 v88, v48, v49
    buffer_load_dwordx4 v[240:243], v16, s[32:35], s66 offen offset:2048 sc1
    v_cndmask_b32 v104, v72, v88, s[84:85]
    v_cndmask_b32 v120, v88, v72, s[84:85]
    v_xor_b32 v104, v58, v104
    v_xor_b32 v120, v59, v120
    v_cvt_pk_bf16_f32 v73, v46, v47
    v_cvt_pk_bf16_f32 v89, v50, v51
    v_cndmask_b32 v105, v73, v89, s[84:85]
    v_cndmask_b32 v121, v89, v73, s[84:85]
    v_xor_b32 v105, v58, v105
    v_xor_b32 v121, v59, v121
    v_fmamk_f32 v40, v61, 0x41c80000, v60
    v_fmamk_f32 v41, v61, 0x41d00000, v60
    v_fmamk_f32 v42, v61, 0x41d80000, v60
    buffer_load_dwordx4 v[244:247], v17, s[32:35], s66 offen offset:2048 sc1
    v_fmamk_f32 v43, v61, 0x41e00000, v60
    v_cos_f32 v44, v40
    v_cos_f32 v45, v41
    v_cos_f32 v46, v42
    v_cos_f32 v47, v43
    v_sin_f32_e64 v48, -v40
    v_sin_f32_e64 v49, -v41
    v_sin_f32_e64 v50, -v42
    buffer_load_dwordx4 v[248:251], v16, s[32:35], s66 offen offset:3072 sc1
    v_sin_f32_e64 v51, -v43
    v_cvt_pk_bf16_f32 v74, v44, v45
    v_cvt_pk_bf16_f32 v90, v48, v49
    v_cndmask_b32 v106, v74, v90, s[84:85]
    v_cndmask_b32 v122, v90, v74, s[84:85]
    v_xor_b32 v106, v58, v106
    v_xor_b32 v122, v59, v122
    v_cvt_pk_bf16_f32 v75, v46, v47
    v_cvt_pk_bf16_f32 v91, v50, v51
    v_cndmask_b32 v107, v75, v91, s[84:85]
    v_cndmask_b32 v123, v91, v75, s[84:85]
    buffer_load_dwordx4 v[252:255], v17, s[32:35], s66 offen offset:3072 sc1
    v_xor_b32 v107, v58, v107
    v_xor_b32 v123, v59, v123
    s_and_b32 s53, s40, 1
    s_xor_b32 s53, s53, 1
    s_lshl_b32 s53, s53, 5
    s_lshl_b32 s54, s47, 6
    s_add_u32 s53, s53, s54
    v_and_b32 v61, 31, v1
    v_add_u32 v61, s53, v61
    v_cvt_f32_u32 v61, v61
    v_mul_f32 v61, 0x3b000000, v61
    s_lshl_b32 s53, s40, 5
    v_lshrrev_b32 v60, 5, v1
    v_lshl_add_u32 v60, v60, 2, s53
    buffer_load_dword v28, v18, s[32:35], s74 offen sc1
    buffer_load_dword v29, v19, s[32:35], s74 offen sc1
    v_cvt_f32_u32 v60, v60
    v_mul_f32 v60, v60, v61
    v_fmamk_f32 v40, v61, 0x3f800000, v60
    v_fmamk_f32 v41, v61, 0x40000000, v60
    v_fmamk_f32 v42, v61, 0x40400000, v60
    v_fmamk_f32 v43, v61, 0x40800000, v60
    v_cos_f32 v44, v40
    v_cos_f32 v45, v41
    v_cos_f32 v46, v42
    buffer_load_dwordx4 v[128:131], v16, s[32:35], s67 offen offset:0 sc1
    v_cos_f32 v47, v43
    v_sin_f32_e64 v48, -v40
    v_sin_f32_e64 v49, -v41
    s_waitcnt vmcnt(11)
    v_mfma_f32_32x32x16_bf16 a[64:79], a[204:207], v[176:179], a[64:79]
    buffer_load_dwordx4 v[132:135], v17, s[32:35], s67 offen offset:0 sc1
    v_add3_u32 v26, v192, v193, v26
    v_add3_u32 v26, v194, v195, v26
    v_add3_u32 v26, v200, v201, v26
    v_mfma_f32_32x32x16_bf16 a[80:95], a[200:203], v[180:183], a[80:95]
    v_add3_u32 v26, v202, v203, v26
    v_add3_u32 v26, v208, v209, v26
    v_add3_u32 v26, v210, v211, v26
    v_add3_u32 v26, v216, v217, v26
    v_add3_u32 v26, v218, v219, v26
    v_add3_u32 v27, v196, v197, v27
    v_mfma_f32_32x32x16_bf16 a[96:111], a[204:207], v[180:183], a[96:111]
    buffer_load_dwordx4 v[136:139], v16, s[32:35], s67 offen offset:1024 sc1
    v_add3_u32 v27, v198, v199, v27
    v_add3_u32 v27, v204, v205, v27
    v_add3_u32 v27, v206, v207, v27
    v_mfma_f32_32x32x16_bf16 a[48:63], a[208:211], v[184:187], a[48:63]
    v_add3_u32 v27, v212, v213, v27
    v_add3_u32 v27, v214, v215, v27
    v_add3_u32 v27, v220, v221, v27
    v_add3_u32 v27, v222, v223, v27
    v_bitop3_b32 v26, v26, v27, s60 bitop3:0x7e
    v_mfma_f32_32x32x16_bf16 a[64:79], a[212:215], v[184:187], a[64:79]
    buffer_load_dwordx4 v[140:143], v17, s[32:35], s67 offen offset:1024 sc1
    v_cmp_ne_u32 vcc, 0, v26
    s_cbranch_vccnz L_spin_10
L_ok_9:
    v_mfma_f32_32x32x16_bf16 a[80:95], a[208:211], v[188:191], a[80:95]
    v_sin_f32_e64 v50, -v42
    v_sin_f32_e64 v51, -v43
    v_cvt_pk_bf16_f32 v68, v44, v45
    v_cvt_pk_bf16_f32 v84, v48, v49
    v_mfma_f32_32x32x16_bf16 a[96:111], a[212:215], v[188:191], a[96:111]
    buffer_load_dwordx4 v[144:147], v16, s[32:35], s67 offen offset:2048 sc1
    v_cndmask_b32 v100, v68, v84, s[84:85]
    v_cndmask_b32 v116, v84, v68, s[84:85]
    v_xor_b32 v100, v58, v100
    v_mfma_f32_32x32x16_bf16 a[48:63], a[216:219], v[192:195], a[48:63]
    v_xor_b32 v116, v59, v116
    v_cvt_pk_bf16_f32 v69, v46, v47
    v_cvt_pk_bf16_f32 v85, v50, v51
    v_cndmask_b32 v101, v69, v85, s[84:85]
    v_cndmask_b32 v117, v85, v69, s[84:85]
    v_xor_b32 v101, v58, v101
    v_mfma_f32_32x32x16_bf16 a[64:79], a[220:223], v[192:195], a[64:79]
    buffer_load_dwordx4 v[148:151], v17, s[32:35], s67 offen offset:2048 sc1
    v_xor_b32 v117, v59, v117
    v_fmamk_f32 v40, v61, 0x41100000, v60
    v_fmamk_f32 v41, v61, 0x41200000, v60
    v_mfma_f32_32x32x16_bf16 a[80:95], a[216:219], v[196:199], a[80:95]
    v_fmamk_f32 v42, v61, 0x41300000, v60
    v_fmamk_f32 v43, v61, 0x41400000, v60
    v_cos_f32 v44, v40
    v_cos_f32 v45, v41
    v_mfma_f32_32x32x16_bf16 a[96:111], a[220:223], v[196:199], a[96:111]
    buffer_load_dwordx4 v[152:155], v16, s[32:35], s67 offen offset:3072 sc1
    v_cos_f32 v46, v42
    v_mfma_f32_32x32x16_bf16 a[48:63], a[224:227], v[200:203], a[48:63]
    v_cos_f32 v47, v43
    v_sin_f32_e64 v48, -v40
    v_sin_f32_e64 v49, -v41
    v_mfma_f32_32x32x16_bf16 a[64:79], a[228:231], v[200:203], a[64:79]
    buffer_load_dwordx4 v[156:159], v17, s[32:35], s67 offen offset:3072 sc1
    v_sin_f32_e64 v50, -v42
    v_mfma_f32_32x32x16_bf16 a[80:95], a[224:227], v[204:207], a[80:95]
    v_sin_f32_e64 v51, -v43
    v_cvt_pk_bf16_f32 v70, v44, v45
    v_cvt_pk_bf16_f32 v86, v48, v49
    v_cndmask_b32 v102, v70, v86, s[84:85]
    v_cndmask_b32 v118, v86, v70, s[84:85]
    v_mfma_f32_32x32x16_bf16 a[96:111], a[228:231], v[204:207], a[96:111]
    buffer_load_dword v30, v18, s[32:35], s75 offen sc1
    buffer_load_dword v31, v19, s[32:35], s75 offen sc1
    v_mfma_f32_32x32x16_bf16 a[48:63], a[232:235], v[208:211], a[48:63]
    v_xor_b32 v102, v58, v102
    v_xor_b32 v118, v59, v118
    v_cvt_pk_bf16_f32 v71, v46, v47
    s_waitcnt vmcnt(10)
    v_mfma_f32_32x32x16_bf16 a[64:79], a[236:239], v[208:211], a[64:79]
    buffer_load_dwordx4 v[160:163], v16, s[32:35], s68 offen offset:0 sc1
    v_add3_u32 v28, v224, v225, v28
    v_add3_u32 v28, v226, v227, v28
    v_add3_u32 v28, v232, v233, v28
    v_mfma_f32_32x32x16_bf16 a[80:95], a[232:235], v[212:215], a[80:95]
    v_add3_u32 v28, v234, v235, v28
    v_add3_u32 v28, v240, v241, v28
    v_add3_u32 v28, v242, v243, v28
    v_add3_u32 v28, v248, v249, v28
    v_add3_u32 v28, v250, v251, v28
    v_add3_u32 v29, v228, v229, v29
    v_mfma_f32_32x32x16_bf16 a[96:111], a[236:239], v[212:215], a[96:111]
    buffer_load_dwordx4 v[164:167], v17, s[32:35], s68 offen offset:0 sc1
    v_add3_u32 v29, v230, v231, v29
    v_add3_u32 v29, v236, v237, v29
    v_add3_u32 v29, v238, v239, v29
    v_mfma_f32_32x32x16_bf16 a[48:63], a[240:243], v[216:219], a[48:63]
    v_add3_u32 v29, v244, v245, v29
    v_add3_u32 v29, v246, v247, v29
    v_add3_u32 v29, v252, v253, v29
    v_add3_u32 v29, v254, v255, v29
    v_bitop3_b32 v28, v28, v29, s60 bitop3:0x7e
    v_cvt_pk_bf16_f32 v87, v50, v51
    v_mfma_f32_32x32x16_bf16 a[64:79], a[244:247], v[216:219], a[64:79]
    buffer_load_dwordx4 v[168:171], v16, s[32:35], s68 offen offset:1024 sc1
    v_cmp_ne_u32 vcc, 0, v28
    s_cbranch_vccnz L_spin_12
L_ok_11:
    v_cndmask_b32 v103, v71, v87, s[84:85]
    v_mfma_f32_32x32x16_bf16 a[80:95], a[240:243], v[220:223], a[80:95]
    v_cndmask_b32 v119, v87, v71, s[84:85]
    v_xor_b32 v103, v58, v103
    v_xor_b32 v119, v59, v119
    v_fmamk_f32 v40, v61, 0x41880000, v60
    v_fmamk_f32 v41, v61, 0x41900000, v60
    v_fmamk_f32 v42, v61, 0x41980000, v60
    v_mfma_f32_32x32x16_bf16 a[96:111], a[244:247], v[220:223], a[96:111]
    buffer_load_dwordx4 v[172:175], v17, s[32:35], s68 offen offset:1024 sc1
    v_fmamk_f32 v43, v61, 0x41a00000, v60
    v_cos_f32 v44, v40
    v_mfma_f32_32x32x16_bf16 a[48:63], a[160:163], v[224:227], a[48:63]
    ds_read_b64_tr_b16 a[8:9], v12 offset:16384
    v_cos_f32 v45, v41
    v_cos_f32 v46, v42
    v_mfma_f32_32x32x16_bf16 a[64:79], a[164:167], v[224:227], a[64:79]
    ds_read_b64_tr_b16 a[10:11], v12 offset:17408
    buffer_load_dwordx4 v[176:179], v16, s[32:35], s68 offen offset:2048 sc1
    v_cos_f32 v47, v43
    v_mfma_f32_32x32x16_bf16 a[80:95], a[160:163], v[228:231], a[80:95]
    ds_read_b64_tr_b16 a[12:13], v13 offset:16384
    v_sin_f32_e64 v48, -v40
    v_sin_f32_e64 v49, -v41
    v_mfma_f32_32x32x16_bf16 a[96:111], a[164:167], v[228:231], a[96:111]
    ds_read_b64_tr_b16 a[14:15], v13 offset:17408
    buffer_load_dwordx4 v[180:183], v17, s[32:35], s68 offen offset:2048 sc1
    v_sin_f32_e64 v50, -v42
    v_mfma_f32_32x32x16_bf16 a[48:63], a[168:171], v[232:235], a[48:63]
    ds_read_b64_tr_b16 a[16:17], v12 offset:18432
    v_sin_f32_e64 v51, -v43
    v_cvt_pk_bf16_f32 v76, v44, v45
    v_cvt_pk_bf16_f32 v92, v48, v49
    v_cndmask_b32 v108, v76, v92, s[84:85]
    v_mfma_f32_32x32x16_bf16 a[64:79], a[172:175], v[232:235], a[64:79]
    ds_read_b64_tr_b16 a[18:19], v12 offset:19456
    buffer_load_dwordx4 v[184:187], v16, s[32:35], s68 offen offset:3072 sc1
    v_cndmask_b32 v124, v92, v76, s[84:85]
    v_xor_b32 v108, v58, v108
    v_mfma_f32_32x32x16_bf16 a[80:95], a[168:171], v[236:239], a[80:95]
    ds_read_b64_tr_b16 a[20:21], v13 offset:18432
    v_xor_b32 v124, v59, v124
    v_cvt_pk_bf16_f32 v77, v46, v47
    v_cvt_pk_bf16_f32 v93, v50, v51
    v_cndmask_b32 v109, v77, v93, s[84:85]
    v_cndmask_b32 v125, v93, v77, s[84:85]
    v_mfma_f32_32x32x16_bf16 a[96:111], a[172:175], v[236:239], a[96:111]
    ds_read_b64_tr_b16 a[22:23], v13 offset:19456
    buffer_load_dwordx4 v[188:191], v17, s[32:35], s68 offen offset:3072 sc1
    v_xor_b32 v109, v58, v109
    v_xor_b32 v125, v59, v125
    s_waitcnt lgkmcnt(4)
    v_mfma_f32_32x32x16_bf16 a[48:63], a[8:11], v[240:243], a[48:63]
    v_add_u32 v12, 0x10000, v12
    v_add_u32 v13, 0x10000, v13
    v_add_u32 v14, 0x10000, v14
    ds_read_b64_tr_b16 a[0:1], v12 offset:16384
    v_fmamk_f32 v40, v61, 0x41c80000, v60
    v_fmamk_f32 v41, v61, 0x41d00000, v60
    buffer_load_dword v24, v18, s[32:35], s76 offen sc1
    buffer_load_dword v25, v19, s[32:35], s76 offen sc1
    s_waitcnt vmcnt(10)
    v_mfma_f32_32x32x16_bf16 a[64:79], a[12:15], v[240:243], a[64:79]
    ds_read_b64_tr_b16 a[2:3], v12 offset:17408
    s_add_u32 m0, s50, 114688
    s_xor_b32 s51, s63, 0
    s_add_u32 s51, s51, 0xa00000
    buffer_load_dwordx4 v38, s[32:35], s51 offen offset:0 sc1 lds
    v_mfma_f32_32x32x16_bf16 a[80:95], a[8:11], v[244:247], a[80:95]
    ds_read_b64_tr_b16 a[4:5], v13 offset:16384
    v_add3_u32 v30, v128, v129, v30
    v_add3_u32 v30, v130, v131, v30
    v_add3_u32 v30, v136, v137, v30
    v_add3_u32 v30, v138, v139, v30
    v_add3_u32 v30, v144, v145, v30
    v_mfma_f32_32x32x16_bf16 a[96:111], a[12:15], v[244:247], a[96:111]
    ds_read_b64_tr_b16 a[6:7], v13 offset:17408
    buffer_load_dwordx4 v38, s[32:35], s51 offen offset:1024 sc1 lds
    v_add3_u32 v30, v146, v147, v30
    v_add3_u32 v30, v152, v153, v30
    s_waitcnt lgkmcnt(4)
    v_mfma_f32_32x32x16_bf16 a[48:63], a[16:19], v[248:251], a[48:63]
    ds_read_b64_tr_b16 a[8:9], v12 offset:18432
    v_add3_u32 v30, v154, v155, v30
    v_add3_u32 v31, v132, v133, v31
    v_add3_u32 v31, v134, v135, v31
    v_add3_u32 v31, v140, v141, v31
    v_add3_u32 v31, v142, v143, v31
    v_mfma_f32_32x32x16_bf16 a[64:79], a[20:23], v[248:251], a[64:79]
    ds_read_b64_tr_b16 a[10:11], v12 offset:19456
    buffer_load_dwordx4 v38, s[32:35], s51 offen offset:2048 sc1 lds
    v_add3_u32 v31, v148, v149, v31
    v_add3_u32 v31, v150, v151, v31
    v_mfma_f32_32x32x16_bf16 a[80:95], a[16:19], v[252:255], a[80:95]
    ds_read_b64_tr_b16 a[12:13], v13 offset:18432
    v_add3_u32 v31, v156, v157, v31
    v_add3_u32 v31, v158, v159, v31
    v_bitop3_b32 v30, v30, v31, s60 bitop3:0x7e
    v_cmp_ne_u32 vcc, 0, v30
    s_cbranch_vccnz L_spin_14
L_ok_13:
    v_mfma_f32_32x32x16_bf16 a[96:111], a[20:23], v[252:255], a[96:111]
    ds_read_b64_tr_b16 a[14:15], v13 offset:19456
    buffer_load_dwordx4 v38, s[32:35], s51 offen offset:3072 sc1 lds
    s_sub_u32 s52, s51, 0xa00000
    s_lshr_b32 s52, s52, 3
    s_add_u32 s52, s52, 0xd40000
    buffer_load_dwordx2 v[4:5], v35, s[32:35], s52 offen sc1
    s_waitcnt lgkmcnt(4)
    v_mfma_f32_32x32x16_bf16 a[48:63], a[0:3], v[128:131], a[48:63]
    v_add_u32 v12, 0xffff0000, v12
    v_add_u32 v13, 0xffff0000, v13
    v_add_u32 v14, 0xffff0000, v14
    ds_read_b64_tr_b16 a[16:17], v12 offset:49152
    v_fmamk_f32 v42, v61, 0x41d80000, v60
    v_fmamk_f32 v43, v61, 0x41e00000, v60
    v_mfma_f32_32x32x16_bf16 a[64:79], a[4:7], v[128:131], a[64:79]
    ds_read_b64_tr_b16 a[18:19], v12 offset:50176
    s_add_u32 m0, s50, 0
    s_xor_b32 s51, s63, 0
    s_add_u32 s51, s51, 0xa04000
    buffer_load_dwordx4 v38, s[32:35], s51 offen offset:0 sc1 lds
    v_mfma_f32_32x32x16_bf16 a[80:95], a[0:3], v[132:135], a[80:95]
    ds_read_b64_tr_b16 a[20:21], v13 offset:49152
    v_cos_f32 v44, v40
    v_cos_f32 v45, v41
    v_mfma_f32_32x32x16_bf16 a[96:111], a[4:7], v[132:135], a[96:111]
    ds_read_b64_tr_b16 a[22:23], v13 offset:50176
    buffer_load_dwordx4 v38, s[32:35], s51 offen offset:1024 sc1 lds
    v_cos_f32 v46, v42
    s_waitcnt lgkmcnt(4)
    v_mfma_f32_32x32x16_bf16 a[48:63], a[8:11], v[136:139], a[48:63]
    ds_read_b64_tr_b16 a[0:1], v12 offset:51200
    v_cos_f32 v47, v43
    v_sin_f32_e64 v48, -v40
    v_mfma_f32_32x32x16_bf16 a[64:79], a[12:15], v[136:139], a[64:79]
    ds_read_b64_tr_b16 a[2:3], v12 offset:52224
    buffer_load_dwordx4 v38, s[32:35], s51 offen offset:2048 sc1 lds
    v_sin_f32_e64 v49, -v41
    v_mfma_f32_32x32x16_bf16 a[80:95], a[8:11], v[140:143], a[80:95]
    ds_read_b64_tr_b16 a[4:5], v13 offset:51200
    v_sin_f32_e64 v50, -v42
    v_sin_f32_e64 v51, -v43
    v_cvt_pk_bf16_f32 v78, v44, v45
    v_mfma_f32_32x32x16_bf16 a[96:111], a[12:15], v[140:143], a[96:111]
    ds_read_b64_tr_b16 a[6:7], v13 offset:52224
    buffer_load_dwordx4 v38, s[32:35], s51 offen offset:3072 sc1 lds
    s_sub_u32 s52, s51, 0xa00000
    s_lshr_b32 s52, s52, 3
    s_add_u32 s52, s52, 0xd40000
    buffer_load_dwordx2 v[6:7], v35, s[32:35], s52 offen sc1
    s_waitcnt lgkmcnt(4)
    v_mfma_f32_32x32x16_bf16 a[48:63], a[16:19], v[144:147], a[48:63]
    v_add_u32 v12, 0x20000, v12
    v_add_u32 v13, 0x20000, v13
    v_add_u32 v14, 0x20000, v14
    ds_read_b64_tr_b16 a[8:9], v12 offset:0
    v_cvt_pk_bf16_f32 v94, v48, v49
    s_waitcnt vmcnt(10)
    v_mfma_f32_32x32x16_bf16 a[64:79], a[20:23], v[144:147], a[64:79]
    ds_read_b64_tr_b16 a[10:11], v12 offset:1024
    s_add_u32 m0, s50, 98304
    s_xor_b32 s51, s63, 32768
    s_add_u32 s51, s51, 0xa00000
    buffer_load_dwordx4 v38, s[32:35], s51 offen offset:0 sc1 lds
    v_mfma_f32_32x32x16_bf16 a[80:95], a[16:19], v[148:151], a[80:95]
    ds_read_b64_tr_b16 a[12:13], v13 offset:0
    v_add3_u32 v24, v160, v161, v24
    v_add3_u32 v24, v162, v163, v24
    v_add3_u32 v24, v168, v169, v24
    v_add3_u32 v24, v170, v171, v24
    v_add3_u32 v24, v176, v177, v24
    v_mfma_f32_32x32x16_bf16 a[96:111], a[20:23], v[148:151], a[96:111]
    ds_read_b64_tr_b16 a[14:15], v13 offset:1024
    buffer_load_dwordx4 v38, s[32:35], s51 offen offset:1024 sc1 lds
    v_add3_u32 v24, v178, v179, v24
    v_add3_u32 v24, v184, v185, v24
    s_waitcnt lgkmcnt(4)
    v_mfma_f32_32x32x16_bf16 a[48:63], a[0:3], v[152:155], a[48:63]
    ds_read_b64_tr_b16 a[16:17], v12 offset:2048
    v_add3_u32 v24, v186, v187, v24
    v_add3_u32 v25, v164, v165, v25
    v_add3_u32 v25, v166, v167, v25
    v_add3_u32 v25, v172, v173, v25
    v_add3_u32 v25, v174, v175, v25
    v_mfma_f32_32x32x16_bf16 a[64:79], a[4:7], v[152:155], a[64:79]
    ds_read_b64_tr_b16 a[18:19], v12 offset:3072
    buffer_load_dwordx4 v38, s[32:35], s51 offen offset:2048 sc1 lds
    v_add3_u32 v25, v180, v181, v25
    v_add3_u32 v25, v182, v183, v25
    v_mfma_f32_32x32x16_bf16 a[80:95], a[0:3], v[156:159], a[80:95]
    ds_read_b64_tr_b16 a[20:21], v13 offset:2048
    v_add3_u32 v25, v188, v189, v25
    v_add3_u32 v25, v190, v191, v25
    v_bitop3_b32 v24, v24, v25, s60 bitop3:0x7e
    v_cmp_ne_u32 vcc, 0, v24
    s_cbranch_vccnz L_spin_16
L_ok_15:
    v_mfma_f32_32x32x16_bf16 a[96:111], a[4:7], v[156:159], a[96:111]
    ds_read_b64_tr_b16 a[22:23], v13 offset:3072
    buffer_load_dwordx4 v38, s[32:35], s51 offen offset:3072 sc1 lds
    s_sub_u32 s52, s51, 0xa00000
    s_lshr_b32 s52, s52, 3
    s_add_u32 s52, s52, 0xd40000
    buffer_load_dwordx2 v[20:21], v35, s[32:35], s52 offen sc1
    s_waitcnt lgkmcnt(4)
    v_mfma_f32_32x32x16_bf16 a[48:63], a[8:11], v[160:163], a[48:63]
    v_add_u32 v12, 0xffff0000, v12
    v_add_u32 v13, 0xffff0000, v13
    v_add_u32 v14, 0xffff0000, v14
    ds_read_b64_tr_b16 a[0:1], v12 offset:0
    v_cndmask_b32 v110, v78, v94, s[84:85]
    v_cndmask_b32 v126, v94, v78, s[84:85]
    v_mfma_f32_32x32x16_bf16 a[64:79], a[12:15], v[160:163], a[64:79]
    ds_read_b64_tr_b16 a[2:3], v12 offset:1024
    s_add_u32 m0, s50, 32768
    s_xor_b32 s51, s63, 32768
    s_add_u32 s51, s51, 0xa04000
    buffer_load_dwordx4 v38, s[32:35], s51 offen offset:0 sc1 lds
    v_mfma_f32_32x32x16_bf16 a[80:95], a[8:11], v[164:167], a[80:95]
    ds_read_b64_tr_b16 a[4:5], v13 offset:0
    v_xor_b32 v110, v58, v110
    v_xor_b32 v126, v59, v126
    v_cvt_pk_bf16_f32 v79, v46, v47
    v_cvt_pk_bf16_f32 v95, v50, v51
    v_cndmask_b32 v111, v79, v95, s[84:85]
    v_mfma_f32_32x32x16_bf16 a[96:111], a[12:15], v[164:167], a[96:111]
    ds_read_b64_tr_b16 a[6:7], v13 offset:1024
    buffer_load_dwordx4 v38, s[32:35], s51 offen offset:1024 sc1 lds
    v_cndmask_b32 v127, v95, v79, s[84:85]
    v_xor_b32 v111, v58, v111
    s_waitcnt lgkmcnt(4)
    v_mfma_f32_32x32x16_bf16 a[48:63], a[16:19], v[168:171], a[48:63]
    ds_read_b64_tr_b16 a[8:9], v12 offset:2048
    v_xor_b32 v127, v59, v127
    s_waitcnt vmcnt(12)
    ds_read_b128 v[40:43], v14 offset:49152
    ds_read_b128 v[44:47], v14 offset:49216
    ds_read_b128 v[48:51], v14 offset:49168
    ds_read_b128 v[52:55], v14 offset:49232
    v_mfma_f32_32x32x16_bf16 a[64:79], a[20:23], v[168:171], a[64:79]
    ds_read_b64_tr_b16 a[10:11], v12 offset:3072
    buffer_load_dwordx4 v38, s[32:35], s51 offen offset:2048 sc1 lds
    v_mfma_f32_32x32x16_bf16 a[80:95], a[16:19], v[172:175], a[80:95]
    ds_read_b64_tr_b16 a[12:13], v13 offset:2048
    v_mfma_f32_32x32x16_bf16 a[96:111], a[20:23], v[172:175], a[96:111]
    ds_read_b64_tr_b16 a[14:15], v13 offset:3072
    buffer_load_dwordx4 v38, s[32:35], s51 offen offset:3072 sc1 lds
    s_sub_u32 s52, s51, 0xa00000
    s_lshr_b32 s52, s52, 3
    s_add_u32 s52, s52, 0xd40000
    buffer_load_dwordx2 v[22:23], v35, s[32:35], s52 offen sc1
    s_waitcnt lgkmcnt(8)
    v_mfma_f32_32x32x16_bf16 a[48:63], a[0:3], v[176:179], a[48:63]
    s_waitcnt lgkmcnt(3)
    v_add3_u32 v4, v40, v41, v4
    v_add3_u32 v4, v42, v43, v4
    v_add3_u32 v4, v44, v45, v4
    v_add3_u32 v4, v46, v47, v4
    v_add3_u32 v5, v48, v49, v5
    v_mfma_f32_32x32x16_bf16 a[64:79], a[4:7], v[176:179], a[64:79]
    buffer_load_dwordx4 v[192:195], v16, s[32:35], s69 offen offset:0 sc1
    v_add3_u32 v5, v50, v51, v5
    v_add3_u32 v5, v52, v53, v5
    v_add3_u32 v5, v54, v55, v5
    v_mfma_f32_32x32x16_bf16 a[80:95], a[0:3], v[180:183], a[80:95]
    v_bitop3_b32 v4, v4, v5, s60 bitop3:0x7e
    v_cmp_ne_u32 vcc, 0, v4
    s_cbranch_vccnz L_spin_18
L_ok_17:
    ds_read_b64_tr_b16 a[112:113], v12 offset:49152
    ds_read_b64_tr_b16 a[114:115], v12 offset:50176
    ds_read_b64_tr_b16 a[120:121], v13 offset:49152
    v_mfma_f32_32x32x16_bf16 a[96:111], a[4:7], v[180:183], a[96:111]
    buffer_load_dwordx4 v[196:199], v17, s[32:35], s69 offen offset:0 sc1
    ds_read_b64_tr_b16 a[122:123], v13 offset:50176
    ds_read_b64_tr_b16 a[116:117], v12 offset:51200
    ds_read_b64_tr_b16 a[118:119], v12 offset:52224
    s_waitcnt lgkmcnt(6)
    v_mfma_f32_32x32x16_bf16 a[48:63], a[8:11], v[184:187], a[48:63]
    ds_read_b64_tr_b16 a[124:125], v13 offset:51200
    ds_read_b64_tr_b16 a[126:127], v13 offset:52224
    s_waitcnt vmcnt(12)
    v_add_u32 v12, 0xffff0000, v12
    v_add_u32 v13, 0xffff0000, v13
    v_add_u32 v14, 0xffff0000, v14
    ds_read_b128 v[40:43], v14 offset:0
    ds_read_b128 v[44:47], v14 offset:64
    ds_read_b128 v[48:51], v14 offset:16
    ds_read_b128 v[52:55], v14 offset:80
    v_mfma_f32_32x32x16_bf16 a[64:79], a[12:15], v[184:187], a[64:79]
    buffer_load_dwordx4 v[200:203], v16, s[32:35], s69 offen offset:1024 sc1
    v_mfma_f32_32x32x16_bf16 a[80:95], a[8:11], v[188:191], a[80:95]
    v_mfma_f32_32x32x16_bf16 a[96:111], a[12:15], v[188:191], a[96:111]
    buffer_load_dwordx4 v[204:207], v17, s[32:35], s69 offen offset:1024 sc1
    s_waitcnt lgkmcnt(0)
    v_add3_u32 v6, v40, v41, v6
    v_add3_u32 v6, v42, v43, v6
    v_add3_u32 v6, v44, v45, v6
    v_add3_u32 v6, v46, v47, v6
    v_add3_u32 v7, v48, v49, v7
    v_add3_u32 v7, v50, v51, v7
    v_add3_u32 v7, v52, v53, v7
    v_add3_u32 v7, v54, v55, v7
    v_bitop3_b32 v6, v6, v7, s60 bitop3:0x7e
    v_cmp_ne_u32 vcc, 0, v6
    s_cbranch_vccnz L_spin_20
L_ok_19:
    v_mfma_f32_32x32x16_bf16 v[128:143], a[112:115], a[24:27], 0
    ds_read_b64_tr_b16 a[128:129], v12 offset:0
    ds_read_b64_tr_b16 a[130:131], v12 offset:1024
    buffer_load_dwordx2 v[56:57], v36, s[8:11], s7 offen offset:0
    v_mfma_f32_32x32x16_bf16 v[144:159], a[120:123], a[24:27], 0
    ds_read_b64_tr_b16 a[136:137], v13 offset:0
    ds_read_b64_tr_b16 a[138:139], v13 offset:1024
    v_mfma_f32_32x32x16_bf16 v[128:143], a[120:123], a[40:43], v[128:143]
    ds_read_b64_tr_b16 a[132:133], v12 offset:2048
    buffer_load_dwordx2 v[58:59], v36, s[8:11], s7 offen offset:16
    s_waitcnt vmcnt(11)
    v_add_u32 v12, 0x10000, v12
    v_add_u32 v13, 0x10000, v13
    v_add_u32 v14, 0x10000, v14
    ds_read_b128 v[40:43], v14 offset:32768
    ds_read_b128 v[44:47], v14 offset:32832
    ds_read_b128 v[48:51], v14 offset:32784
    ds_read_b128 v[52:55], v14 offset:32848
    v_mfma_f32_32x32x16_bf16 v[144:159], a[112:115], a[32:35], v[144:159]
    v_add_u32 v12, 0xffff0000, v12
    v_add_u32 v13, 0xffff0000, v13
    v_add_u32 v14, 0xffff0000, v14
    ds_read_b64_tr_b16 a[134:135], v12 offset:3072
    buffer_load_dwordx2 v[60:61], v36, s[8:11], s7 offen offset:32
    v_mfma_f32_32x32x16_bf16 v[128:143], a[116:119], a[28:31], v[128:143]
    ds_read_b64_tr_b16 a[140:141], v13 offset:2048
    v_mfma_f32_32x32x16_bf16 v[144:159], a[124:127], a[28:31], v[144:159]
    ds_read_b64_tr_b16 a[142:143], v13 offset:3072
    buffer_load_dwordx2 v[62:63], v36, s[8:11], s7 offen offset:48
    v_mfma_f32_32x32x16_bf16 v[128:143], a[124:127], a[44:47], v[128:143]
    v_mfma_f32_32x32x16_bf16 v[144:159], a[116:119], a[36:39], v[144:159]
    buffer_load_dwordx4 v[208:211], v16, s[32:35], s69 offen offset:2048 sc1
    s_waitcnt lgkmcnt(3)
    v_add3_u32 v20, v40, v41, v20
    v_add3_u32 v20, v42, v43, v20
    s_waitcnt lgkmcnt(0)
    v_mfma_f32_32x32x16_bf16 v[160:175], a[128:131], a[24:27], 0
    buffer_load_dwordx4 v[212:215], v17, s[32:35], s69 offen offset:2048 sc1
    v_add3_u32 v20, v44, v45, v20
    v_add3_u32 v20, v46, v47, v20
    v_add3_u32 v21, v48, v49, v21
    v_mfma_f32_32x32x16_bf16 v[176:191], a[136:139], a[24:27], 0
    v_add3_u32 v21, v50, v51, v21
    v_add3_u32 v21, v52, v53, v21
    v_add3_u32 v21, v54, v55, v21
    v_bitop3_b32 v20, v20, v21, s60 bitop3:0x7e
    v_cmp_ne_u32 vcc, 0, v20
    s_cbranch_vccnz L_spin_22
L_ok_21:
    v_mfma_f32_32x32x16_bf16 v[160:175], a[136:139], a[40:43], v[160:175]
    v_cvt_pk_bf16_f32 v128, v128, v129
    v_cvt_pk_bf16_f32 v129, v130, v131
    v_cvt_pk_bf16_f32 v130, v132, v133
    v_cvt_pk_bf16_f32 v131, v134, v135
    buffer_load_dwordx4 v[216:219], v16, s[32:35], s69 offen offset:3072 sc1
    v_mfma_f32_32x32x16_bf16 v[176:191], a[128:131], a[32:35], v[176:191]
    v_cvt_pk_bf16_f32 v132, v136, v137
    v_cvt_pk_bf16_f32 v133, v138, v139
    v_cvt_pk_bf16_f32 v134, v140, v141
    v_cvt_pk_bf16_f32 v135, v142, v143
    s_waitcnt vmcnt(11)
    ds_read_b128 v[40:43], v14 offset:32768
    ds_read_b128 v[44:47], v14 offset:32832
    ds_read_b128 v[48:51], v14 offset:32784
    ds_read_b128 v[52:55], v14 offset:32848
    v_mfma_f32_32x32x16_bf16 v[160:175], a[132:135], a[28:31], v[160:175]
    v_cvt_pk_bf16_f32 v144, v144, v145
    v_cvt_pk_bf16_f32 v145, v146, v147
    v_cvt_pk_bf16_f32 v146, v148, v149
    v_cvt_pk_bf16_f32 v147, v150, v151
    buffer_load_dwordx4 v[220:223], v17, s[32:35], s69 offen offset:3072 sc1
    v_mfma_f32_32x32x16_bf16 v[176:191], a[140:143], a[28:31], v[176:191]
    v_cvt_pk_bf16_f32 v148, v152, v153
    v_cvt_pk_bf16_f32 v149, v154, v155
    v_cvt_pk_bf16_f32 v150, v156, v157
    v_cvt_pk_bf16_f32 v151, v158, v159
    v_mfma_f32_32x32x16_bf16 v[160:175], a[140:143], a[44:47], v[160:175]
    v_mfma_f32_32x32x16_bf16 v[176:191], a[132:135], a[36:39], v[176:191]
    buffer_load_dword v26, v18, s[32:35], s77 offen sc1
    buffer_load_dword v27, v19, s[32:35], s77 offen sc1
    v_mfma_f32_32x32x16_bf16 a[48:63], v[64:67], v[128:131], a[48:63]
    v_add_u32 v12, 0x10000, v12
    v_add_u32 v13, 0x10000, v13
    v_add_u32 v14, 0x10000, v14
    ds_read_b64_tr_b16 a[112:113], v12 offset:32768
    ds_read_b64_tr_b16 a[114:115], v12 offset:33792
    s_waitcnt lgkmcnt(2)
    v_mfma_f32_32x32x16_bf16 a[64:79], v[68:71], v[128:131], a[64:79]
    ds_read_b64_tr_b16 a[120:121], v13 offset:32768
    ds_read_b64_tr_b16 a[122:123], v13 offset:33792
    s_add_u32 m0, s50, 16384
    s_lshl_b32 s51, s69, 4
    s_add_u32 s51, s51, s59
    buffer_load_dwordx4 v8, s[16:19], s51 offen offset:0 lds
    v_mfma_f32_32x32x16_bf16 a[48:63], v[72:75], v[132:135], a[48:63]
    ds_read_b64_tr_b16 a[116:117], v12 offset:34816
    v_add3_u32 v22, v40, v41, v22
    v_add3_u32 v22, v42, v43, v22
    v_add3_u32 v22, v44, v45, v22
    v_add3_u32 v22, v46, v47, v22
    v_add3_u32 v23, v48, v49, v23
    v_mfma_f32_32x32x16_bf16 a[64:79], v[76:79], v[132:135], a[64:79]
    ds_read_b64_tr_b16 a[118:119], v12 offset:35840
    buffer_load_dwordx4 v9, s[16:19], s51 offen offset:1024 lds
    v_add3_u32 v23, v50, v51, v23
    v_add3_u32 v23, v52, v53, v23
    v_mfma_f32_32x32x16_bf16 a[48:63], v[80:83], v[144:147], a[48:63]
    ds_read_b64_tr_b16 a[124:125], v13 offset:34816
    v_add3_u32 v23, v54, v55, v23
    v_bitop3_b32 v22, v22, v23, s60 bitop3:0x7e
    v_cmp_ne_u32 vcc, 0, v22
    s_cbranch_vccnz L_spin_24
L_ok_23:
    v_mfma_f32_32x32x16_bf16 a[64:79], v[84:87], v[144:147], a[64:79]
    ds_read_b64_tr_b16 a[126:127], v13 offset:35840
    s_add_u32 m0, s50, 16384
    s_lshl_b32 s51, s69, 4
    s_add_u32 s51, s51, s59
    buffer_load_dwordx4 v10, s[16:19], s51 offen offset:2048 lds
    v_mfma_f32_32x32x16_bf16 a[48:63], v[88:91], v[148:151], a[48:63]
    v_mfma_f32_32x32x16_bf16 a[64:79], v[92:95], v[148:151], a[64:79]
    s_waitcnt lgkmcnt(0)
    v_mfma_f32_32x32x16_bf16 v[128:143], a[112:115], a[24:27], 0
    buffer_load_dwordx4 v11, s[16:19], s51 offen offset:3072 lds
    v_mfma_f32_32x32x16_bf16 v[144:159], a[120:123], a[24:27], 0
    v_mfma_f32_32x32x16_bf16 v[128:143], a[120:123], a[40:43], v[128:143]
    v_cvt_pk_bf16_f32 v160, v160, v161
    v_cvt_pk_bf16_f32 v161, v162, v163
    v_cvt_pk_bf16_f32 v162, v164, v165
    v_cvt_pk_bf16_f32 v163, v166, v167
    s_add_u32 m0, s50, 81920
    s_lshl_b32 s51, s69, 4
    s_add_u32 s51, s51, s59
    s_add_u32 s51, s51, 32768
    buffer_load_dwordx4 v8, s[16:19], s51 offen offset:0 lds
    v_mfma_f32_32x32x16_bf16 v[144:159], a[112:115], a[32:35], v[144:159]
    v_cvt_pk_bf16_f32 v164, v168, v169
    v_cvt_pk_bf16_f32 v165, v170, v171
    v_cvt_pk_bf16_f32 v166, v172, v173
    v_cvt_pk_bf16_f32 v167, v174, v175
    v_mfma_f32_32x32x16_bf16 v[128:143], a[116:119], a[28:31], v[128:143]
    v_cvt_pk_bf16_f32 v176, v176, v177
    v_cvt_pk_bf16_f32 v177, v178, v179
    v_cvt_pk_bf16_f32 v178, v180, v181
    v_cvt_pk_bf16_f32 v179, v182, v183
    buffer_load_dwordx4 v9, s[16:19], s51 offen offset:1024 lds
    v_mfma_f32_32x32x16_bf16 v[144:159], a[124:127], a[28:31], v[144:159]
    v_cvt_pk_bf16_f32 v180, v184, v185
    v_cvt_pk_bf16_f32 v181, v186, v187
    v_cvt_pk_bf16_f32 v182, v188, v189
    v_cvt_pk_bf16_f32 v183, v190, v191
    v_mfma_f32_32x32x16_bf16 v[128:143], a[124:127], a[44:47], v[128:143]
    v_mfma_f32_32x32x16_bf16 v[144:159], a[116:119], a[36:39], v[144:159]
    buffer_load_dwordx4 v10, s[16:19], s51 offen offset:2048 lds
    v_mfma_f32_32x32x16_bf16 a[48:63], v[96:99], v[160:163], a[48:63]
    v_add_u32 v12, 0xffff0000, v12
    v_add_u32 v13, 0xffff0000, v13
    v_add_u32 v14, 0xffff0000, v14
    ds_read_b64_tr_b16 a[128:129], v12 offset:32768
    ds_read_b64_tr_b16 a[130:131], v12 offset:33792
    v_mfma_f32_32x32x16_bf16 a[64:79], v[100:103], v[160:163], a[64:79]
    ds_read_b64_tr_b16 a[136:137], v13 offset:32768
    ds_read_b64_tr_b16 a[138:139], v13 offset:33792
    buffer_load_dwordx4 v11, s[16:19], s51 offen offset:3072 lds
    v_mfma_f32_32x32x16_bf16 a[48:63], v[104:107], v[164:167], a[48:63]
    ds_read_b64_tr_b16 a[132:133], v12 offset:34816
    v_mfma_f32_32x32x16_bf16 a[64:79], v[108:111], v[164:167], a[64:79]
    ds_read_b64_tr_b16 a[134:135], v12 offset:35840
    buffer_load_dwordx4 v[224:227], v16, s[32:35], s70 offen offset:0 sc1
    v_mfma_f32_32x32x16_bf16 a[48:63], v[112:115], v[176:179], a[48:63]
    ds_read_b64_tr_b16 a[140:141], v13 offset:34816
    v_mfma_f32_32x32x16_bf16 a[64:79], v[116:119], v[176:179], a[64:79]
    ds_read_b64_tr_b16 a[142:143], v13 offset:35840
    buffer_load_dwordx4 v[228:231], v17, s[32:35], s70 offen offset:0 sc1
    v_mfma_f32_32x32x16_bf16 a[48:63], v[120:123], v[180:183], a[48:63]
    v_mfma_f32_32x32x16_bf16 a[64:79], v[124:127], v[180:183], a[64:79]
    buffer_load_dwordx4 v[232:235], v16, s[32:35], s70 offen offset:1024 sc1
    s_waitcnt lgkmcnt(0)
    v_mfma_f32_32x32x16_bf16 v[160:175], a[128:131], a[24:27], 0
    buffer_load_dwordx4 v[236:239], v17, s[32:35], s70 offen offset:1024 sc1
    v_mfma_f32_32x32x16_bf16 v[176:191], a[136:139], a[24:27], 0
    v_mfma_f32_32x32x16_bf16 v[160:175], a[136:139], a[40:43], v[160:175]
    v_cvt_pk_bf16_f32 v128, v128, v129
    v_cvt_pk_bf16_f32 v129, v130, v131
    v_cvt_pk_bf16_f32 v130, v132, v133
    v_cvt_pk_bf16_f32 v131, v134, v135
    buffer_load_dwordx4 v[240:243], v16, s[32:35], s70 offen offset:2048 sc1
    v_mfma_f32_32x32x16_bf16 v[176:191], a[128:131], a[32:35], v[176:191]
    v_cvt_pk_bf16_f32 v132, v136, v137
    v_cvt_pk_bf16_f32 v133, v138, v139
    v_cvt_pk_bf16_f32 v134, v140, v141
    v_cvt_pk_bf16_f32 v135, v142, v143
    v_mfma_f32_32x32x16_bf16 v[160:175], a[132:135], a[28:31], v[160:175]
    v_cvt_pk_bf16_f32 v144, v144, v145
    v_cvt_pk_bf16_f32 v145, v146, v147
    v_cvt_pk_bf16_f32 v146, v148, v149
    v_cvt_pk_bf16_f32 v147, v150, v151
    buffer_load_dwordx4 v[244:247], v17, s[32:35], s70 offen offset:2048 sc1
    v_mfma_f32_32x32x16_bf16 v[176:191], a[140:143], a[28:31], v[176:191]
    v_cvt_pk_bf16_f32 v148, v152, v153
    v_cvt_pk_bf16_f32 v149, v154, v155
    v_cvt_pk_bf16_f32 v150, v156, v157
    v_cvt_pk_bf16_f32 v151, v158, v159
    v_mfma_f32_32x32x16_bf16 v[160:175], a[140:143], a[44:47], v[160:175]
    v_mfma_f32_32x32x16_bf16 v[176:191], a[132:135], a[36:39], v[176:191]
    buffer_load_dwordx4 v[248:251], v16, s[32:35], s70 offen offset:3072 sc1
    v_mfma_f32_32x32x16_bf16 a[80:95], v[64:67], v[128:131], a[80:95]
    s_waitcnt vmcnt(15)
    v_add3_u32 v26, v192, v193, v26
    v_add3_u32 v26, v194, v195, v26
    v_add3_u32 v26, v200, v201, v26
    v_add3_u32 v26, v202, v203, v26
    v_add3_u32 v26, v208, v209, v26
    v_mfma_f32_32x32x16_bf16 a[96:111], v[68:71], v[128:131], a[96:111]
    buffer_load_dwordx4 v[252:255], v17, s[32:35], s70 offen offset:3072 sc1
    v_add3_u32 v26, v210, v211, v26
    v_add3_u32 v26, v216, v217, v26
    v_add3_u32 v26, v218, v219, v26
    v_mfma_f32_32x32x16_bf16 a[80:95], v[72:75], v[132:135], a[80:95]
    v_cvt_pk_bf16_f32 v160, v160, v161
    v_cvt_pk_bf16_f32 v161, v162, v163
    v_cvt_pk_bf16_f32 v162, v164, v165
    v_cvt_pk_bf16_f32 v163, v166, v167
    v_add3_u32 v27, v196, v197, v27
    v_add3_u32 v27, v198, v199, v27
    v_mfma_f32_32x32x16_bf16 a[96:111], v[76:79], v[132:135], a[96:111]
    v_cvt_pk_bf16_f32 v164, v168, v169
    v_cvt_pk_bf16_f32 v165, v170, v171
    v_cvt_pk_bf16_f32 v166, v172, v173
    v_cvt_pk_bf16_f32 v167, v174, v175
    buffer_load_dword v28, v18, s[32:35], s78 offen sc1
    buffer_load_dword v29, v19, s[32:35], s78 offen sc1
    v_mfma_f32_32x32x16_bf16 a[80:95], v[80:83], v[144:147], a[80:95]
    v_cvt_pk_bf16_f32 v176, v176, v177
    v_cvt_pk_bf16_f32 v177, v178, v179
    v_cvt_pk_bf16_f32 v178, v180, v181
    v_cvt_pk_bf16_f32 v179, v182, v183
    v_add3_u32 v27, v204, v205, v27
    v_add3_u32 v27, v206, v207, v27
    v_mfma_f32_32x32x16_bf16 a[96:111], v[84:87], v[144:147], a[96:111]
    v_cvt_pk_bf16_f32 v180, v184, v185
    v_cvt_pk_bf16_f32 v181, v186, v187
    v_cvt_pk_bf16_f32 v182, v188, v189
    v_cvt_pk_bf16_f32 v183, v190, v191
    s_add_u32 m0, s50, 49152
    s_lshl_b32 s51, s70, 4
    s_add_u32 s51, s51, s59
    buffer_load_dwordx4 v8, s[16:19], s51 offen offset:0 lds
    v_mfma_f32_32x32x16_bf16 a[80:95], v[88:91], v[148:151], a[80:95]
    v_add3_u32 v27, v212, v213, v27
    v_add3_u32 v27, v214, v215, v27
    v_add3_u32 v27, v220, v221, v27
    v_add3_u32 v27, v222, v223, v27
    v_bitop3_b32 v26, v26, v27, s60 bitop3:0x7e
    v_mfma_f32_32x32x16_bf16 a[96:111], v[92:95], v[148:151], a[96:111]
    v_cmp_ne_u32 vcc, 0, v26
    s_cbranch_vccnz L_spin_26
L_ok_25:
    v_mfma_f32_32x32x16_bf16 a[80:95], v[96:99], v[160:163], a[80:95]
    buffer_load_dwordx4 v9, s[16:19], s51 offen offset:1024 lds
    s_waitcnt vmcnt(16)
    ds_read_b64_tr_b16 a[16:17], v12 offset:16384
    ds_read_b64_tr_b16 a[18:19], v12 offset:17408
    v_mfma_f32_32x32x16_bf16 a[96:111], v[100:103], v[160:163], a[96:111]
    ds_read_b64_tr_b16 a[20:21], v13 offset:16384
    ds_read_b64_tr_b16 a[22:23], v13 offset:17408
    v_mfma_f32_32x32x16_bf16 a[80:95], v[104:107], v[164:167], a[80:95]
    ds_read_b64_tr_b16 a[0:1], v12 offset:18432
    buffer_load_dwordx4 v10, s[16:19], s51 offen offset:2048 lds
    v_mfma_f32_32x32x16_bf16 a[96:111], v[108:111], v[164:167], a[96:111]
    ds_read_b64_tr_b16 a[2:3], v12 offset:19456
    v_mfma_f32_32x32x16_bf16 a[80:95], v[112:115], v[176:179], a[80:95]
    ds_read_b64_tr_b16 a[4:5], v13 offset:18432
    buffer_load_dwordx4 v11, s[16:19], s51 offen offset:3072 lds
    v_mfma_f32_32x32x16_bf16 a[96:111], v[116:119], v[176:179], a[96:111]
    ds_read_b64_tr_b16 a[6:7], v13 offset:19456
    v_mfma_f32_32x32x16_bf16 a[80:95], v[120:123], v[180:183], a[80:95]
    s_add_u32 m0, s50, 131072
    s_lshl_b32 s51, s70, 4
    s_add_u32 s51, s51, s59
    s_add_u32 s51, s51, 32768
    buffer_load_dwordx4 v8, s[16:19], s51 offen offset:0 lds
    v_mfma_f32_32x32x16_bf16 a[96:111], v[124:127], v[180:183], a[96:111]
    s_waitcnt lgkmcnt(4)
    v_mfma_f32_32x32x16_bf16 a[48:63], a[16:19], v[192:195], a[48:63]
    s_waitcnt vmcnt(15)
    v_add_u32 v12, 0x10000, v12
    v_add_u32 v13, 0x10000, v13
    v_add_u32 v14, 0x10000, v14
    ds_read_b64_tr_b16 a[8:9], v12 offset:16384
    buffer_load_dwordx4 v9, s[16:19], s51 offen offset:1024 lds
    v_mfma_f32_32x32x16_bf16 a[64:79], a[20:23], v[192:195], a[64:79]
    ds_read_b64_tr_b16 a[10:11], v12 offset:17408
    v_mfma_f32_32x32x16_bf16 a[80:95], a[16:19], v[196:199], a[80:95]
    ds_read_b64_tr_b16 a[12:13], v13 offset:16384
    buffer_load_dwordx4 v10, s[16:19], s51 offen offset:2048 lds
    v_mfma_f32_32x32x16_bf16 a[96:111], a[20:23], v[196:199], a[96:111]
    ds_read_b64_tr_b16 a[14:15], v13 offset:17408
    s_waitcnt lgkmcnt(4)
    v_mfma_f32_32x32x16_bf16 a[48:63], a[0:3], v[200:203], a[48:63]
    ds_read_b64_tr_b16 a[16:17], v12 offset:18432
    buffer_load_dwordx4 v11, s[16:19], s51 offen offset:3072 lds
    v_mfma_f32_32x32x16_bf16 a[64:79], a[4:7], v[200:203], a[64:79]
    ds_read_b64_tr_b16 a[18:19], v12 offset:19456
    v_mfma_f32_32x32x16_bf16 a[80:95], a[0:3], v[204:207], a[80:95]
    ds_read_b64_tr_b16 a[20:21], v13 offset:18432
    v_mfma_f32_32x32x16_bf16 a[96:111], a[4:7], v[204:207], a[96:111]
    ds_read_b64_tr_b16 a[22:23], v13 offset:19456
    s_waitcnt lgkmcnt(4)
    v_mfma_f32_32x32x16_bf16 a[48:63], a[8:11], v[208:211], a[48:63]
    v_lshlrev_b32 v128, 16, v56
    v_and_b32 v129, 0xffff0000, v56
    v_lshlrev_b32 v130, 16, v57
    v_and_b32 v131, 0xffff0000, v57
    v_lshlrev_b32 v132, 16, v58
    v_and_b32 v133, 0xffff0000, v58
    v_lshlrev_b32 v134, 16, v59
    v_and_b32 v135, 0xffff0000, v59
    v_lshlrev_b32 v136, 16, v60
    v_and_b32 v137, 0xffff0000, v60
    v_lshlrev_b32 v138, 16, v61
    v_and_b32 v139, 0xffff0000, v61
    v_lshlrev_b32 v140, 16, v62
    v_and_b32 v141, 0xffff0000, v62
    v_lshlrev_b32 v142, 16, v63
    v_and_b32 v143, 0xffff0000, v63
    v_add_u32 v0, s50, v2
    s_waitcnt vmcnt(4)
    v_add_u32 v12, 0xffff0000, v12
    v_add_u32 v13, 0xffff0000, v13
    v_add_u32 v14, 0xffff0000, v14
    ds_read_b64_tr_b16 a[184:185], v12 offset:49152
    ds_read_b64_tr_b16 a[186:187], v12 offset:50176
    v_mfma_f32_32x32x16_bf16 a[64:79], a[12:15], v[208:211], a[64:79]
    ds_read_b64_tr_b16 a[188:189], v13 offset:49152
    ds_read_b64_tr_b16 a[190:191], v13 offset:50176
    v_add3_u32 v28, v224, v225, v28
    v_add3_u32 v28, v226, v227, v28
    v_add3_u32 v28, v232, v233, v28
    v_add3_u32 v28, v234, v235, v28
    v_mfma_f32_32x32x16_bf16 a[80:95], a[8:11], v[212:215], a[80:95]
    s_waitcnt vmcnt(0)
    v_add_u32 v12, 0x20000, v12
    v_add_u32 v13, 0x20000, v13
    v_add_u32 v14, 0x20000, v14
    ds_read_b64_tr_b16 a[200:201], v12 offset:0
    ds_read_b64_tr_b16 a[202:203], v12 offset:1024
    v_mfma_f32_32x32x16_bf16 a[96:111], a[12:15], v[212:215], a[96:111]
    ds_read_b64_tr_b16 a[204:205], v13 offset:0
    ds_read_b64_tr_b16 a[206:207], v13 offset:1024
    v_add3_u32 v28, v240, v241, v28
    v_add3_u32 v28, v242, v243, v28
    v_add3_u32 v28, v248, v249, v28
    v_add3_u32 v28, v250, v251, v28
    s_waitcnt lgkmcnt(8)
    v_mfma_f32_32x32x16_bf16 a[48:63], a[16:19], v[216:219], a[48:63]
    v_add_u32 v12, 0xfffe0000, v12
    v_add_u32 v13, 0xfffe0000, v13
    v_add_u32 v14, 0xfffe0000, v14
    ds_read_b64_tr_b16 a[192:193], v12 offset:51200
    ds_read_b64_tr_b16 a[194:195], v12 offset:52224
    v_add3_u32 v29, v228, v229, v29
    v_mfma_f32_32x32x16_bf16 a[64:79], a[20:23], v[216:219], a[64:79]
    ds_read_b64_tr_b16 a[196:197], v13 offset:51200
    ds_read_b64_tr_b16 a[198:199], v13 offset:52224
    v_add3_u32 v29, v230, v231, v29
    v_add3_u32 v29, v236, v237, v29
    v_add3_u32 v29, v238, v239, v29
    v_add3_u32 v29, v244, v245, v29
    v_mfma_f32_32x32x16_bf16 a[80:95], a[16:19], v[220:223], a[80:95]
    v_add_u32 v12, 0x20000, v12
    v_add_u32 v13, 0x20000, v13
    v_add_u32 v14, 0x20000, v14
    ds_read_b64_tr_b16 a[208:209], v12 offset:2048
    ds_read_b64_tr_b16 a[210:211], v12 offset:3072
    v_add3_u32 v29, v246, v247, v29
    v_mfma_f32_32x32x16_bf16 a[96:111], a[20:23], v[220:223], a[96:111]
    ds_read_b64_tr_b16 a[212:213], v13 offset:2048
    ds_read_b64_tr_b16 a[214:215], v13 offset:3072
    v_add3_u32 v29, v252, v253, v29
    v_add3_u32 v29, v254, v255, v29
    v_bitop3_b32 v28, v28, v29, s60 bitop3:0x7e
    v_cmp_ne_u32 vcc, 0, v28
    s_cbranch_vccnz L_spin_28
L_ok_27:
    s_waitcnt lgkmcnt(0)
    v_mfma_f32_32x32x16_bf16 a[96:111], a[188:191], v[228:231], a[96:111]
    v_mfma_f32_32x32x16_bf16 a[96:111], a[196:199], v[236:239], a[96:111]
    v_mfma_f32_32x32x16_bf16 a[96:111], a[204:207], v[244:247], a[96:111]
    v_mfma_f32_32x32x16_bf16 a[96:111], a[212:215], v[252:255], a[96:111]
    v_mfma_f32_32x32x16_bf16 a[80:95], a[184:187], v[228:231], a[80:95]
    v_mfma_f32_32x32x16_bf16 a[80:95], a[192:195], v[236:239], a[80:95]
    v_mfma_f32_32x32x16_bf16 a[80:95], a[200:203], v[244:247], a[80:95]
    s_nop 8
    ds_write_b128 v0, a[96:99] offset:32768
    ds_write_b128 v0, a[100:103] offset:33792
    v_mfma_f32_32x32x16_bf16 a[80:95], a[208:211], v[252:255], a[80:95]
    ds_write_b128 v0, a[104:107] offset:34816
    ds_write_b128 v0, a[108:111] offset:35840
    v_mfma_f32_32x32x16_bf16 a[64:79], a[188:191], v[224:227], a[64:79]
    v_mfma_f32_32x32x16_bf16 a[64:79], a[196:199], v[232:235], a[64:79]
    v_mfma_f32_32x32x16_bf16 a[64:79], a[204:207], v[240:243], a[64:79]
    s_nop 6
    ds_write_b128 v0, a[80:83] offset:16384
    ds_write_b128 v0, a[84:87] offset:17408
    v_mfma_f32_32x32x16_bf16 a[64:79], a[212:215], v[248:251], a[64:79]
    ds_write_b128 v0, a[88:91] offset:18432
    ds_write_b128 v0, a[92:95] offset:19456
    v_mfma_f32_32x32x16_bf16 a[48:63], a[184:187], v[224:227], a[48:63]
    v_mfma_f32_32x32x16_bf16 a[48:63], a[192:195], v[232:235], a[48:63]
    v_mfma_f32_32x32x16_bf16 a[48:63], a[200:203], v[240:243], a[48:63]
    s_nop 6
    ds_write_b128 v0, a[64:67] offset:0
    ds_write_b128 v0, a[68:71] offset:1024
    v_mfma_f32_32x32x16_bf16 a[48:63], a[208:211], v[248:251], a[48:63]
    ds_write_b128 v0, a[72:75] offset:2048
    ds_write_b128 v0, a[76:79] offset:3072
    s_nop 9
    v_accvgpr_read_b32 v144, a48
    v_accvgpr_read_b32 v145, a49
    v_accvgpr_read_b32 v146, a50
    v_accvgpr_read_b32 v147, a51
    v_accvgpr_read_b32 v148, a52
    v_accvgpr_read_b32 v149, a53
    v_accvgpr_read_b32 v150, a54
    v_accvgpr_read_b32 v151, a55
    v_accvgpr_read_b32 v152, a56
    v_accvgpr_read_b32 v153, a57
    v_accvgpr_read_b32 v154, a58
    v_accvgpr_read_b32 v155, a59
    v_accvgpr_read_b32 v156, a60
    v_accvgpr_read_b32 v157, a61
    v_accvgpr_read_b32 v158, a62
    v_accvgpr_read_b32 v159, a63
    v_pk_add_f32 v[128:129], v[128:129], v[144:145]
    v_pk_add_f32 v[130:131], v[130:131], v[146:147]
    v_pk_add_f32 v[132:133], v[132:133], v[148:149]
    v_pk_add_f32 v[134:135], v[134:135], v[150:151]
    v_pk_add_f32 v[136:137], v[136:137], v[152:153]
    v_pk_add_f32 v[138:139], v[138:139], v[154:155]
    v_pk_add_f32 v[140:141], v[140:141], v[156:157]
    v_pk_add_f32 v[142:143], v[142:143], v[158:159]
    s_waitcnt lgkmcnt(0)
    s_barrier
    v_xor_b32 v3, 4096, v0
    ds_read_b128 v[144:147], v3 offset:0
    ds_read_b128 v[148:151], v3 offset:1024
    ds_read_b128 v[152:155], v3 offset:2048
    ds_read_b128 v[156:159], v3 offset:3072
    v_xor_b32 v3, 8192, v0
    ds_read_b128 v[160:163], v3 offset:16384
    ds_read_b128 v[164:167], v3 offset:17408
    ds_read_b128 v[168:171], v3 offset:18432
    ds_read_b128 v[172:175], v3 offset:19456
    v_xor_b32 v3, 12288, v0
    ds_read_b128 v[176:179], v3 offset:32768
    ds_read_b128 v[180:183], v3 offset:33792
    ds_read_b128 v[184:187], v3 offset:34816
    ds_read_b128 v[188:191], v3 offset:35840
    s_waitcnt lgkmcnt(8)
    v_pk_add_f32 v[128:129], v[128:129], v[144:145]
    v_pk_add_f32 v[130:131], v[130:131], v[146:147]
    v_pk_add_f32 v[132:133], v[132:133], v[148:149]
    v_pk_add_f32 v[134:135], v[134:135], v[150:151]
    v_pk_add_f32 v[136:137], v[136:137], v[152:153]
    v_pk_add_f32 v[138:139], v[138:139], v[154:155]
    v_pk_add_f32 v[140:141], v[140:141], v[156:157]
    v_pk_add_f32 v[142:143], v[142:143], v[158:159]
    s_waitcnt lgkmcnt(4)
    v_pk_add_f32 v[128:129], v[128:129], v[160:161]
    v_pk_add_f32 v[130:131], v[130:131], v[162:163]
    v_pk_add_f32 v[132:133], v[132:133], v[164:165]
    v_pk_add_f32 v[134:135], v[134:135], v[166:167]
    v_pk_add_f32 v[136:137], v[136:137], v[168:169]
    v_pk_add_f32 v[138:139], v[138:139], v[170:171]
    v_pk_add_f32 v[140:141], v[140:141], v[172:173]
    v_pk_add_f32 v[142:143], v[142:143], v[174:175]
    s_waitcnt lgkmcnt(0)
    v_pk_add_f32 v[128:129], v[128:129], v[176:177]
    v_pk_add_f32 v[130:131], v[130:131], v[178:179]
    v_pk_add_f32 v[132:133], v[132:133], v[180:181]
    v_pk_add_f32 v[134:135], v[134:135], v[182:183]
    v_pk_add_f32 v[136:137], v[136:137], v[184:185]
    v_pk_add_f32 v[138:139], v[138:139], v[186:187]
    v_pk_add_f32 v[140:141], v[140:141], v[188:189]
    v_pk_add_f32 v[142:143], v[142:143], v[190:191]
    v_cvt_pk_bf16_f32 v144, v128, v129
    v_cvt_pk_bf16_f32 v145, v130, v131
    v_cvt_pk_bf16_f32 v146, v132, v133
    v_cvt_pk_bf16_f32 v147, v134, v135
    v_cvt_pk_bf16_f32 v148, v136, v137
    v_cvt_pk_bf16_f32 v149, v138, v139
    v_cvt_pk_bf16_f32 v150, v140, v141
    v_cvt_pk_bf16_f32 v151, v142, v143
    v_permlane32_swap_b32 v144, v146
    v_permlane32_swap_b32 v145, v147
    v_permlane32_swap_b32 v148, v150
    v_permlane32_swap_b32 v149, v151
    buffer_store_dwordx4 v[144:147], v37, s[28:31], s7 offen offset:0
    buffer_store_dwordx4 v[148:151], v37, s[28:31], s7 offen offset:32
    s_endpgm
L_light:
    s_nop 4
    s_add_u32 m0, s50, 0
    s_mov_b32 s51, 0
    buffer_load_dwordx4 v8, s[8:11], s51 offen offset:0 lds
    buffer_load_dwordx4 v9, s[8:11], s51 offen offset:1024 lds
    buffer_load_dwordx4 v10, s[8:11], s51 offen offset:2048 lds
    buffer_load_dwordx4 v11, s[8:11], s51 offen offset:3072 lds
    buffer_load_dwordx4 v[248:251], v35, s[8:11], 0 offen
    buffer_load_dwordx4 v[252:255], v35, s[8:11], 0 offen offset:512
    s_lshl_b32 s52, s2, 1
    s_and_b32 s93, s40, 1
    s_add_u32 s52, s52, s93
    s_mul_i32 s52, s52, 3584
    v_min_u32 v244, 27, v1
    v_lshlrev_b32 v244, 7, v244
    buffer_load_dword v245, v244, s[12:15], s52 offen
    s_lshl_b32 s52, s45, 8
    s_lshl_b32 s93, s42, 4
    s_add_u32 s52, s52, s93
    s_add_u32 s52, s52, 0xc00000
    buffer_load_dword v245, off, s[32:35], s52 sc1
    v_and_b32 v40, 31, v1
    v_lshlrev_b32 v41, 7, v40
    s_and_b32 s53, s50, 12288
    v_add_u32 v41, s53, v41
    v_bfe_u32 v42, v1, 1, 3
    v_lshrrev_b32 v43, 5, v1
    v_xor_b32 v42, v42, v43
    v_xor_b32 v43, 0, v42
    v_lshl_add_u32 v16, v43, 4, v41
    v_xor_b32 v43, 2, v42
    v_lshl_add_u32 v17, v43, 4, v41
    v_xor_b32 v43, 4, v42
    v_lshl_add_u32 v18, v43, 4, v41
    v_xor_b32 v43, 6, v42
    v_lshl_add_u32 v19, v43, 4, v41
    v_bfe_u32 v40, v1, 4, 1
    v_lshlrev_b32 v41, 13, v40
    s_and_b32 s53, s40, 0
    s_lshl_b32 s53, s53, 13
    v_add_u32 v41, s53, v41
    s_and_b32 s54, s40, 3
    v_lshrrev_b32 v42, 5, v1
    v_lshl_add_u32 v41, v42, 10, v41
    v_bfe_u32 v42, v1, 2, 2
    v_lshl_add_u32 v41, v42, 7, v41
    v_and_b32 v43, 3, v1
    v_lshl_add_u32 v41, v43, 3, v41
    v_and_b32 v42, 2, v42
    v_xor_b32 v42, v42, v40
    v_xor_b32 v42, s54, v42
    v_xor_b32 v43, 0, v42
    v_lshl_add_u32 v12, v43, 5, v41
    v_xor_b32 v43, 1, v42
    v_lshl_add_u32 v13, v43, 5, v41
    v_xor_b32 v43, 2, v42
    v_lshl_add_u32 v14, v43, 5, v41
    v_xor_b32 v43, 3, v42
    v_lshl_add_u32 v15, v43, 5, v41
    v_lshrrev_b32 v40, 2, v1
    v_lshrrev_b32 v41, 4, v1
    v_xor_b32 v40, v40, v41
    v_and_b32 v40, 1, v40
    v_subrev_u32 v40, 1, v40
    v_and_b32 v40, 0x3f803f80, v40
    v_accvgpr_write_b32 a248, v40
    v_accvgpr_write_b32 a249, v40
    v_accvgpr_write_b32 a250, v40
    v_accvgpr_write_b32 a251, v40
    s_and_b32 s55, s45, 63
    s_mul_i32 s55, s55, 114688
    s_lshl_b32 s53, s54, 10
    s_add_u32 s55, s55, s53
    s_lshl_b32 s95, s48, 5
    s_add_u32 s95, s95, s49
    s_lshl_b32 s95, s95, 2
    s_add_u32 s95, s95, s40
    s_lshl_b32 s95, s95, 7
    v_bfe_u32 v40, v1, 2, 1
    v_bfe_u32 v41, v1, 3, 2
    v_and_b32 v42, 3, v1
    v_lshl_add_u32 v42, v41, 2, v42
    v_lshl_add_u32 v42, v40, 4, v42
    s_lshl_b32 s53, s44, 6
    s_lshr_b32 s54, s40, 1
    s_add_u32 s53, s53, s54
    s_add_u32 s53, s53, 1
    v_lshl_add_u32 v42, v42, 1, s53
    v_cmp_eq_u32 vcc, 0x100, v42
    v_mov_b32 v43, 0.5
    s_nop 0
    v_cndmask_b32 v32, 1.0, v43, vcc
    v_cvt_f32_u32 v21, v42
    v_mul_f32 v21, 0x3b000000, v21
    s_and_b32 s53, s40, 1
    s_mul_i32 s53, s53, 0x3e800000
    v_lshrrev_b32 v20, 5, v1
    v_lshlrev_b32 v20, 3, v20
    v_cvt_f32_u32 v20, v20
    v_fma_f32 v20, v20, v21, s53
    s_cmp_eq_u32 s40, 1
    s_cselect_b32 s53, 0, 1
    v_and_b32 v22, 1, v1
    v_xor_b32 v22, s53, v22
    v_mul_lo_u32 v22, v22, s62
    s_lshl_b32 s53, s40, 10
    s_add_u32 s53, s53, 49152
    v_add_u32 v23, s53, v2
    s_xor_b32 s53, s40, s54
    s_xor_b32 s53, s53, 1
    s_lshl_b32 s53, s53, 10
    s_add_u32 s53, s53, 81920
    v_add_u32 v34, s53, v2
    v_mov_b32 v38, v2
    v_mov_b32 v40, v20
    v_fmamk_f32 v41, v21, 0x3f800000, v20
    v_fmamk_f32 v42, v21, 0x40000000, v20
    v_fmamk_f32 v43, v21, 0x40400000, v20
    v_fmamk_f32 v44, v21, 0x40800000, v20
    v_fmamk_f32 v45, v21, 0x40a00000, v20
    v_fmamk_f32 v46, v21, 0x40c00000, v20
    v_fmamk_f32 v47, v21, 0x40e00000, v20
    v_cos_f32 v40, v40
    v_cos_f32 v41, v41
    v_cos_f32 v42, v42
    v_cos_f32 v43, v43
    v_cos_f32 v44, v44
    v_cos_f32 v45, v45
    v_cos_f32 v46, v46
    v_cos_f32 v47, v47
    v_mul_f32 v40, v40, v32
    v_mul_f32 v41, v41, v32
    v_mul_f32 v42, v42, v32
    v_mul_f32 v43, v43, v32
    v_mul_f32 v44, v44, v32
    v_mul_f32 v45, v45, v32
    v_mul_f32 v46, v46, v32
    v_mul_f32 v47, v47, v32
    v_cvt_pk_bf16_f32 v56, v40, v41
    v_cvt_pk_bf16_f32 v57, v42, v43
    v_cvt_pk_bf16_f32 v58, v44, v45
    v_cvt_pk_bf16_f32 v59, v46, v47
    ds_write_b128 v23, v[56:59] offset:0
    v_xor_b32 v60, v22, v56
    v_xor_b32 v61, v22, v57
    v_xor_b32 v62, v22, v58
    v_xor_b32 v63, v22, v59
    ds_write_b128 v34, v[60:63] offset:0
    v_fmamk_f32 v48, v21, 0x41800000, v20
    v_fmamk_f32 v49, v21, 0x41880000, v20
    v_fmamk_f32 v50, v21, 0x41900000, v20
    v_fmamk_f32 v51, v21, 0x41980000, v20
    v_fmamk_f32 v52, v21, 0x41a00000, v20
    v_fmamk_f32 v53, v21, 0x41a80000, v20
    v_fmamk_f32 v54, v21, 0x41b00000, v20
    v_fmamk_f32 v55, v21, 0x41b80000, v20
    v_cos_f32 v48, v48
    v_cos_f32 v49, v49
    v_cos_f32 v50, v50
    v_cos_f32 v51, v51
    v_cos_f32 v52, v52
    v_cos_f32 v53, v53
    v_cos_f32 v54, v54
    v_cos_f32 v55, v55
    v_mul_f32 v48, v48, v32
    v_mul_f32 v49, v49, v32
    v_mul_f32 v50, v50, v32
    v_mul_f32 v51, v51, v32
    v_mul_f32 v52, v52, v32
    v_mul_f32 v53, v53, v32
    v_mul_f32 v54, v54, v32
    v_mul_f32 v55, v55, v32
    v_mul_f32 v20, 0x41800000, v21
    v_cos_f32 v20, v20
    s_nop 0
    v_add_f32 v20, v20, v20
    v_cvt_pk_bf16_f32 v56, v48, v49
    v_cvt_pk_bf16_f32 v57, v50, v51
    v_cvt_pk_bf16_f32 v58, v52, v53
    v_cvt_pk_bf16_f32 v59, v54, v55
    ds_write_b128 v23, v[56:59] offset:4096
    v_xor_b32 v60, v22, v56
    v_xor_b32 v61, v22, v57
    v_xor_b32 v62, v22, v58
    v_xor_b32 v63, v22, v59
    ds_write_b128 v34, v[60:63] offset:4096
    v_fma_f32 v40, v20, v48, -v40
    v_fma_f32 v41, v20, v49, -v41
    v_fma_f32 v42, v20, v50, -v42
    v_fma_f32 v43, v20, v51, -v43
    v_fma_f32 v44, v20, v52, -v44
    v_fma_f32 v45, v20, v53, -v45
    v_fma_f32 v46, v20, v54, -v46
    v_fma_f32 v47, v20, v55, -v47
    v_cvt_pk_bf16_f32 v56, v40, v41
    v_cvt_pk_bf16_f32 v57, v42, v43
    v_cvt_pk_bf16_f32 v58, v44, v45
    v_cvt_pk_bf16_f32 v59, v46, v47
    ds_write_b128 v23, v[56:59] offset:8192
    v_xor_b32 v60, v22, v56
    v_xor_b32 v61, v22, v57
    v_xor_b32 v62, v22, v58
    v_xor_b32 v63, v22, v59
    ds_write_b128 v34, v[60:63] offset:8192
    v_fma_f32 v48, v20, v40, -v48
    v_fma_f32 v49, v20, v41, -v49
    v_fma_f32 v50, v20, v42, -v50
    v_fma_f32 v51, v20, v43, -v51
    v_fma_f32 v52, v20, v44, -v52
    v_fma_f32 v53, v20, v45, -v53
    v_fma_f32 v54, v20, v46, -v54
    v_fma_f32 v55, v20, v47, -v55
    v_cvt_pk_bf16_f32 v56, v48, v49
    v_cvt_pk_bf16_f32 v57, v50, v51
    v_cvt_pk_bf16_f32 v58, v52, v53
    v_cvt_pk_bf16_f32 v59, v54, v55
    ds_write_b128 v23, v[56:59] offset:12288
    v_xor_b32 v60, v22, v56
    v_xor_b32 v61, v22, v57
    v_xor_b32 v62, v22, v58
    v_xor_b32 v63, v22, v59
    ds_write_b128 v34, v[60:63] offset:12288
    v_fma_f32 v40, v20, v48, -v40
    v_fma_f32 v41, v20, v49, -v41
    v_fma_f32 v42, v20, v50, -v42
    v_fma_f32 v43, v20, v51, -v43
    v_fma_f32 v44, v20, v52, -v44
    v_fma_f32 v45, v20, v53, -v45
    v_fma_f32 v46, v20, v54, -v46
    v_fma_f32 v47, v20, v55, -v47
    v_cvt_pk_bf16_f32 v56, v40, v41
    v_cvt_pk_bf16_f32 v57, v42, v43
    v_cvt_pk_bf16_f32 v58, v44, v45
    v_cvt_pk_bf16_f32 v59, v46, v47
    ds_write_b128 v23, v[56:59] offset:16384
    v_xor_b32 v60, v22, v56
    v_xor_b32 v61, v22, v57
    v_xor_b32 v62, v22, v58
    v_xor_b32 v63, v22, v59
    ds_write_b128 v34, v[60:63] offset:16384
    v_fma_f32 v48, v20, v40, -v48
    v_fma_f32 v49, v20, v41, -v49
    v_fma_f32 v50, v20, v42, -v50
    v_fma_f32 v51, v20, v43, -v51
    v_fma_f32 v52, v20, v44, -v52
    v_fma_f32 v53, v20, v45, -v53
    v_fma_f32 v54, v20, v46, -v54
    v_fma_f32 v55, v20, v47, -v55
    v_cvt_pk_bf16_f32 v56, v48, v49
    v_cvt_pk_bf16_f32 v57, v50, v51
    v_cvt_pk_bf16_f32 v58, v52, v53
    v_cvt_pk_bf16_f32 v59, v54, v55
    ds_write_b128 v23, v[56:59] offset:20480
    v_xor_b32 v60, v22, v56
    v_xor_b32 v61, v22, v57
    v_xor_b32 v62, v22, v58
    v_xor_b32 v63, v22, v59
    ds_write_b128 v34, v[60:63] offset:20480
    v_fma_f32 v40, v20, v48, -v40
    v_fma_f32 v41, v20, v49, -v41
    v_fma_f32 v42, v20, v50, -v42
    v_fma_f32 v43, v20, v51, -v43
    v_fma_f32 v44, v20, v52, -v44
    v_fma_f32 v45, v20, v53, -v45
    v_fma_f32 v46, v20, v54, -v46
    v_fma_f32 v47, v20, v55, -v47
    v_cvt_pk_bf16_f32 v56, v40, v41
    v_cvt_pk_bf16_f32 v57, v42, v43
    v_cvt_pk_bf16_f32 v58, v44, v45
    v_cvt_pk_bf16_f32 v59, v46, v47
    ds_write_b128 v23, v[56:59] offset:24576
    v_xor_b32 v60, v22, v56
    v_xor_b32 v61, v22, v57
    v_xor_b32 v62, v22, v58
    v_xor_b32 v63, v22, v59
    ds_write_b128 v34, v[60:63] offset:24576
    v_fma_f32 v48, v20, v40, -v48
    v_fma_f32 v49, v20, v41, -v49
    v_fma_f32 v50, v20, v42, -v50
    v_fma_f32 v51, v20, v43, -v51
    v_fma_f32 v52, v20, v44, -v52
    v_fma_f32 v53, v20, v45, -v53
    v_fma_f32 v54, v20, v46, -v54
    v_fma_f32 v55, v20, v47, -v55
    v_cvt_pk_bf16_f32 v56, v48, v49
    v_cvt_pk_bf16_f32 v57, v50, v51
    v_cvt_pk_bf16_f32 v58, v52, v53
    v_cvt_pk_bf16_f32 v59, v54, v55
    ds_write_b128 v23, v[56:59] offset:28672
    v_xor_b32 v60, v22, v56
    v_xor_b32 v61, v22, v57
    v_xor_b32 v62, v22, v58
    v_xor_b32 v63, v22, v59
    ds_write_b128 v34, v[60:63] offset:28672
    v_and_b32 v59, 1, v1
    v_mul_lo_u32 v59, v59, s62
    v_and_b32 v61, 15, v1
    s_lshl_b32 s53, s40, 4
    v_add_u32 v61, s53, v61
    v_cvt_f32_u32 v61, v61
    v_mul_f32 v61, 0x3c800000, v61
    v_lshrrev_b32 v60, 4, v1
    v_lshlrev_b32 v60, 3, v60
    v_cvt_f32_u32 v60, v60
    v_mul_f32 v60, v60, v61
    v_mov_b32 v40, v60
    v_fmamk_f32 v41, v61, 0x3f800000, v60
    v_fmamk_f32 v42, v61, 0x40000000, v60
    v_fmamk_f32 v43, v61, 0x40400000, v60
    v_cos_f32 v44, v40
    v_cos_f32 v45, v41
    v_cos_f32 v46, v42
    v_cos_f32 v47, v43
    v_sin_f32 v48, v40
    v_sin_f32 v49, v41
    v_sin_f32 v50, v42
    v_sin_f32 v51, v43
    v_cvt_pk_bf16_f32 v52, v44, v45
    v_cvt_pk_bf16_f32 v53, v48, v49
    v_xor_b32 v54, v59, v52
    v_xor_b32 v55, v59, v53
    v_xor_b32 v56, s62, v53
    v_xor_b32 v57, s62, v55
    v_accvgpr_write_b32 a112, v52
    v_accvgpr_write_b32 a120, v53
    v_accvgpr_write_b32 a116, v54
    v_accvgpr_write_b32 a124, v55
    v_accvgpr_write_b32 a128, v56
    v_accvgpr_write_b32 a132, v57
    v_cvt_pk_bf16_f32 v52, v46, v47
    v_cvt_pk_bf16_f32 v53, v50, v51
    v_xor_b32 v54, v59, v52
    v_xor_b32 v55, v59, v53
    v_xor_b32 v56, s62, v53
    v_xor_b32 v57, s62, v55
    v_accvgpr_write_b32 a113, v52
    v_accvgpr_write_b32 a121, v53
    v_accvgpr_write_b32 a117, v54
    v_accvgpr_write_b32 a125, v55
    v_accvgpr_write_b32 a129, v56
    v_accvgpr_write_b32 a133, v57
    v_fmamk_f32 v40, v61, 0x40800000, v60
    v_fmamk_f32 v41, v61, 0x40a00000, v60
    v_fmamk_f32 v42, v61, 0x40c00000, v60
    v_fmamk_f32 v43, v61, 0x40e00000, v60
    v_cos_f32 v44, v40
    v_cos_f32 v45, v41
    v_cos_f32 v46, v42
    v_cos_f32 v47, v43
    v_sin_f32 v48, v40
    v_sin_f32 v49, v41
    v_sin_f32 v50, v42
    v_sin_f32 v51, v43
    v_cvt_pk_bf16_f32 v52, v44, v45
    v_cvt_pk_bf16_f32 v53, v48, v49
    v_xor_b32 v54, v59, v52
    v_xor_b32 v55, v59, v53
    v_xor_b32 v56, s62, v53
    v_xor_b32 v57, s62, v55
    v_accvgpr_write_b32 a114, v52
    v_accvgpr_write_b32 a122, v53
    v_accvgpr_write_b32 a118, v54
    v_accvgpr_write_b32 a126, v55
    v_accvgpr_write_b32 a130, v56
    v_accvgpr_write_b32 a134, v57
    v_cvt_pk_bf16_f32 v52, v46, v47
    v_cvt_pk_bf16_f32 v53, v50, v51
    v_xor_b32 v54, v59, v52
    v_xor_b32 v55, v59, v53
    v_xor_b32 v56, s62, v53
    v_xor_b32 v57, s62, v55
    v_accvgpr_write_b32 a115, v52
    v_accvgpr_write_b32 a123, v53
    v_accvgpr_write_b32 a119, v54
    s_add_u32 m0, s50, 16384
    s_mov_b32 s51, 128
    buffer_load_dwordx4 v8, s[8:11], s51 offen offset:0 lds
    buffer_load_dwordx4 v9, s[8:11], s51 offen offset:1024 lds
    buffer_load_dwordx4 v10, s[8:11], s51 offen offset:2048 lds
    buffer_load_dwordx4 v11, s[8:11], s51 offen offset:3072 lds
    s_waitcnt vmcnt(8) lgkmcnt(0)
    s_barrier
    ds_read_b128 v[128:131], v16 offset:0
    ds_read_b128 v[132:135], v17 offset:0
    ds_read_b128 a[0:3], v38 offset:49152
    ds_read_b128 a[4:7], v38 offset:50176
    ds_read_b128 a[8:11], v38 offset:51200
    ds_read_b128 a[12:15], v38 offset:52224
    ds_read_b128 v[136:139], v18 offset:0
    ds_read_b128 a[16:19], v38 offset:53248
    ds_read_b128 a[20:23], v38 offset:54272
    ds_read_b128 a[24:27], v38 offset:55296
    ds_read_b128 a[28:31], v38 offset:56320
    s_waitcnt lgkmcnt(5)
    v_mfma_f32_32x32x16_bf16 v[96:111], v[128:131], a[8:11], 0
    ds_read_b128 v[140:143], v19 offset:0
    ds_read_b128 a[32:35], v38 offset:57344
    s_add_u32 m0, s50, 32768
    s_mov_b32 s51, 256
    buffer_load_dwordx4 v8, s[8:11], s51 offen offset:0 lds
    v_mfma_f32_32x32x16_bf16 v[112:127], v[128:131], a[12:15], 0
    ds_read_b128 a[36:39], v38 offset:58368
    v_mfma_f32_32x32x16_bf16 v[64:79], v[128:131], a[0:3], 0
    ds_read_b128 a[40:43], v38 offset:59392
    buffer_load_dwordx4 v9, s[8:11], s51 offen offset:1024 lds
    v_mfma_f32_32x32x16_bf16 v[80:95], v[128:131], a[4:7], 0
    ds_read_b128 a[44:47], v38 offset:60416
    s_waitcnt lgkmcnt(5)
    v_mfma_f32_32x32x16_bf16 v[96:111], v[132:135], a[24:27], v[96:111]
    buffer_load_dwordx4 v10, s[8:11], s51 offen offset:2048 lds
    buffer_load_dwordx4 v11, s[8:11], s51 offen offset:3072 lds
    s_add_u32 m0, s50, 114688
    s_mov_b32 s51, 384
    buffer_load_dwordx4 v8, s[8:11], s51 offen offset:0 lds
    buffer_load_dwordx4 v9, s[8:11], s51 offen offset:1024 lds
    buffer_load_dwordx4 v10, s[8:11], s51 offen offset:2048 lds
    buffer_load_dwordx4 v11, s[8:11], s51 offen offset:3072 lds
    s_add_u32 m0, s50, 131072
    s_mov_b32 s51, 512
    buffer_load_dwordx4 v8, s[8:11], s51 offen offset:0 lds
    buffer_load_dwordx4 v9, s[8:11], s51 offen offset:1024 lds
    s_waitcnt vmcnt(10)
    ds_read_b128 v[144:147], v16 offset:16384
    ds_read_b128 v[148:151], v17 offset:16384
    buffer_load_dwordx4 v10, s[8:11], s51 offen offset:2048 lds
    v_mfma_f32_32x32x16_bf16 v[112:127], v[132:135], a[28:31], v[112:127]
    buffer_load_dwordx2 v[36:37], off, s[36:39], 0 sc1
    ds_read_b128 a[0:3], v38 offset:61440
    ds_read_b128 a[4:7], v38 offset:62464
    v_mfma_f32_32x32x16_bf16 v[64:79], v[132:135], a[16:19], v[64:79]
    ds_read_b128 a[8:11], v38 offset:63488
    v_mfma_f32_32x32x16_bf16 v[80:95], v[132:135], a[20:23], v[80:95]
    ds_read_b128 a[12:15], v38 offset:64512
    s_waitcnt lgkmcnt(6)
    v_mfma_f32_32x32x16_bf16 v[96:111], v[136:139], a[40:43], v[96:111]
    ds_read_b128 v[152:155], v18 offset:16384
    v_add_u32 v38, 0x10000, v38
    ds_read_b128 a[16:19], v38 offset:0
    v_mfma_f32_32x32x16_bf16 v[112:127], v[136:139], a[44:47], v[112:127]
    ds_read_b128 a[20:23], v38 offset:1024
    v_mfma_f32_32x32x16_bf16 v[64:79], v[136:139], a[32:35], v[64:79]
    ds_read_b128 a[24:27], v38 offset:2048
    v_mfma_f32_32x32x16_bf16 v[80:95], v[136:139], a[36:39], v[80:95]
    ds_read_b128 a[28:31], v38 offset:3072
    s_waitcnt lgkmcnt(5)
    v_mfma_f32_32x32x16_bf16 v[96:111], v[140:143], a[8:11], v[96:111]
    ds_read_b128 v[156:159], v19 offset:16384
    ds_read_b128 a[32:35], v38 offset:4096
    buffer_load_dwordx4 v11, s[8:11], s51 offen offset:3072 lds
    v_lshlrev_b32 v224, 16, v248
    v_mfma_f32_32x32x16_bf16 v[112:127], v[140:143], a[12:15], v[112:127]
    ds_read_b128 a[36:39], v38 offset:5120
    v_and_b32 v225, 0xffff0000, v248
    v_lshlrev_b32 v226, 16, v249
    v_and_b32 v227, 0xffff0000, v249
    v_lshlrev_b32 v228, 16, v250
    v_and_b32 v229, 0xffff0000, v250
    v_mfma_f32_32x32x16_bf16 v[64:79], v[140:143], a[0:3], v[64:79]
    ds_read_b128 a[40:43], v38 offset:6144
    s_add_u32 m0, s50, 0
    s_mov_b32 s51, 640
    buffer_load_dwordx4 v8, s[8:11], s51 offen offset:0 lds
    v_mfma_f32_32x32x16_bf16 v[80:95], v[140:143], a[4:7], v[80:95]
    ds_read_b128 a[44:47], v38 offset:7168
    v_lshlrev_b32 v230, 16, v251
    v_and_b32 v231, 0xffff0000, v251
    v_lshlrev_b32 v232, 16, v252
    v_and_b32 v233, 0xffff0000, v252
    v_lshlrev_b32 v234, 16, v253
    s_waitcnt lgkmcnt(5)
    v_mfma_f32_32x32x16_bf16 v[96:111], v[144:147], a[24:27], v[96:111]
    buffer_load_dwordx4 v9, s[8:11], s51 offen offset:1024 lds
    s_waitcnt vmcnt(11)
    ds_read_b128 v[160:163], v16 offset:32768
    ds_read_b128 v[164:167], v17 offset:32768
    buffer_load_dwordx4 v10, s[8:11], s51 offen offset:2048 lds
    v_mfma_f32_32x32x16_bf16 v[112:127], v[144:147], a[28:31], v[112:127]
    ds_read_b128 a[0:3], v38 offset:8192
    ds_read_b128 a[4:7], v38 offset:9216
    v_and_b32 v235, 0xffff0000, v253
    v_lshlrev_b32 v236, 16, v254
    v_and_b32 v237, 0xffff0000, v254
    v_lshlrev_b32 v238, 16, v255
    v_mfma_f32_32x32x16_bf16 v[64:79], v[144:147], a[16:19], v[64:79]
    ds_read_b128 a[8:11], v38 offset:10240
    buffer_load_dwordx4 v11, s[8:11], s51 offen offset:3072 lds
    v_and_b32 v239, 0xffff0000, v255
    v_add_f32 v240, v224, v225
    v_mfma_f32_32x32x16_bf16 v[80:95], v[144:147], a[20:23], v[80:95]
    ds_read_b128 a[12:15], v38 offset:11264
    v_add_f32 v241, v226, v227
    v_add_f32 v240, v240, v228
    v_add_f32 v241, v241, v229
    v_add_f32 v240, v240, v230
    v_add_f32 v241, v241, v231
    s_waitcnt lgkmcnt(6)
    v_mfma_f32_32x32x16_bf16 v[96:111], v[148:151], a[40:43], v[96:111]
    ds_read_b128 v[168:171], v18 offset:32768
    ds_read_b128 a[16:19], v38 offset:12288
    s_add_u32 m0, s50, 16384
    s_mov_b32 s51, 768
    buffer_load_dwordx4 v8, s[8:11], s51 offen offset:0 lds
    v_mfma_f32_32x32x16_bf16 v[112:127], v[148:151], a[44:47], v[112:127]
    ds_read_b128 a[20:23], v38 offset:13312
    v_add_f32 v240, v240, v232
    v_add_f32 v241, v241, v233
    v_add_f32 v240, v240, v234
    v_add_f32 v241, v241, v235
    v_add_f32 v240, v240, v236
    v_mfma_f32_32x32x16_bf16 v[64:79], v[148:151], a[32:35], v[64:79]
    ds_read_b128 a[24:27], v38 offset:14336
    buffer_load_dwordx4 v9, s[8:11], s51 offen offset:1024 lds
    v_add_f32 v241, v241, v237
    v_add_f32 v240, v240, v238
    v_mfma_f32_32x32x16_bf16 v[80:95], v[148:151], a[36:39], v[80:95]
    ds_read_b128 a[28:31], v38 offset:15360
    v_add_f32 v241, v241, v239
    v_add_f32 v240, v240, v241
    s_nop 1
    v_add_f32_dpp v240, v240, v240 quad_perm:[1,0,3,2] row_mask:0xf bank_mask:0xf
    s_waitcnt lgkmcnt(5)
    v_mfma_f32_32x32x16_bf16 v[96:111], v[152:155], a[8:11], v[96:111]
    ds_read_b128 v[172:175], v19 offset:32768
    ds_read_b128 a[32:35], v38 offset:16384
    buffer_load_dwordx4 v10, s[8:11], s51 offen offset:2048 lds
    v_mfma_f32_32x32x16_bf16 v[112:127], v[152:155], a[12:15], v[112:127]
    ds_read_b128 a[36:39], v38 offset:17408
    v_add_f32_dpp v240, v240, v240 quad_perm:[2,3,0,1] row_mask:0xf bank_mask:0xf
    s_nop 1
    v_add_f32_dpp v240, v240, v240 row_half_mirror row_mask:0xf bank_mask:0xf
    v_mfma_f32_32x32x16_bf16 v[64:79], v[152:155], a[0:3], v[64:79]
    ds_read_b128 a[40:43], v38 offset:18432
    buffer_load_dwordx4 v11, s[8:11], s51 offen offset:3072 lds
    v_mfma_f32_32x32x16_bf16 v[80:95], v[152:155], a[4:7], v[80:95]
    ds_read_b128 a[44:47], v38 offset:19456
    v_add_f32_dpp v240, v240, v240 row_mirror row_mask:0xf bank_mask:0xf
    v_mov_b32 v241, v240
    s_nop 1
    v_permlane16_swap_b32 v240, v241
    v_add_f32 v240, v240, v241
    s_waitcnt lgkmcnt(5)
    v_mfma_f32_32x32x16_bf16 v[96:111], v[156:159], a[24:27], v[96:111]
    s_waitcnt vmcnt(13)
    v_add_u32 v16, 0x10000, v16
    v_add_u32 v17, 0x10000, v17
    v_add_u32 v18, 0x10000, v18
    v_add_u32 v19, 0x10000, v19
    ds_read_b128 v[176:179], v16 offset:49152
    ds_read_b128 v[180:183], v17 offset:49152
    v_mfma_f32_32x32x16_bf16 v[112:127], v[156:159], a[28:31], v[112:127]
    ds_read_b128 a[0:3], v38 offset:20480
    ds_read_b128 a[4:7], v38 offset:21504
    v_mul_f32 v242, 0xbb000000, v240
    v_add_f32 v224, v224, v242
    v_add_f32 v225, v225, v242
    v_add_f32 v226, v226, v242
    v_mfma_f32_32x32x16_bf16 v[64:79], v[156:159], a[16:19], v[64:79]
    ds_read_b128 a[8:11], v38 offset:22528
    v_add_f32 v227, v227, v242
    v_add_f32 v228, v228, v242
    v_add_f32 v229, v229, v242
    v_add_f32 v230, v230, v242
    v_add_f32 v231, v231, v242
    v_mfma_f32_32x32x16_bf16 v[80:95], v[156:159], a[20:23], v[80:95]
    ds_read_b128 a[12:15], v38 offset:23552
    v_add_f32 v232, v232, v242
    v_add_f32 v233, v233, v242
    v_add_f32 v234, v234, v242
    v_add_f32 v235, v235, v242
    v_add_f32 v236, v236, v242
    s_waitcnt lgkmcnt(6)
    v_mfma_f32_32x32x16_bf16 v[96:111], v[160:163], a[40:43], v[96:111]
    ds_read_b128 v[184:187], v18 offset:49152
    ds_read_b128 a[16:19], v38 offset:24576
    s_add_u32 m0, s50, 32768
    s_mov_b32 s51, 896
    buffer_load_dwordx4 v8, s[8:11], s51 offen offset:0 lds
    v_mfma_f32_32x32x16_bf16 v[112:127], v[160:163], a[44:47], v[112:127]
    ds_read_b128 a[20:23], v38 offset:25600
    v_add_f32 v237, v237, v242
    v_add_f32 v238, v238, v242
    v_add_f32 v239, v239, v242
    v_mul_f32 v240, v224, v224
    v_mul_f32 v241, v225, v225
    v_mfma_f32_32x32x16_bf16 v[64:79], v[160:163], a[32:35], v[64:79]
    ds_read_b128 a[24:27], v38 offset:26624
    buffer_load_dwordx4 v9, s[8:11], s51 offen offset:1024 lds
    v_fmac_f32 v240, v226, v226
    v_fmac_f32 v241, v227, v227
    v_mfma_f32_32x32x16_bf16 v[80:95], v[160:163], a[36:39], v[80:95]
    ds_read_b128 a[28:31], v38 offset:27648
    v_fmac_f32 v240, v228, v228
    v_fmac_f32 v241, v229, v229
    v_fmac_f32 v240, v230, v230
    v_fmac_f32 v241, v231, v231
    v_fmac_f32 v240, v232, v232
    s_waitcnt lgkmcnt(5)
    v_mfma_f32_32x32x16_bf16 v[96:111], v[164:167], a[8:11], v[96:111]
    ds_read_b128 v[188:191], v19 offset:49152
    ds_read_b128 a[32:35], v38 offset:28672
    buffer_load_dwordx4 v10, s[8:11], s51 offen offset:2048 lds
    v_fmac_f32 v241, v233, v233
    v_mfma_f32_32x32x16_bf16 v[112:127], v[164:167], a[12:15], v[112:127]
    v_fmac_f32 v240, v234, v234
    v_fmac_f32 v241, v235, v235
    v_fmac_f32 v240, v236, v236
    v_fmac_f32 v241, v237, v237
    v_fmac_f32 v240, v238, v238
    v_fmac_f32 v241, v239, v239
    v_add_f32 v240, v240, v241
    s_nop 1
    v_add_f32_dpp v240, v240, v240 quad_perm:[1,0,3,2] row_mask:0xf bank_mask:0xf
    s_nop 1
    v_add_f32_dpp v240, v240, v240 quad_perm:[2,3,0,1] row_mask:0xf bank_mask:0xf
    s_nop 1
    v_add_f32_dpp v240, v240, v240 row_half_mirror row_mask:0xf bank_mask:0xf
    s_nop 1
    v_add_f32_dpp v240, v240, v240 row_mirror row_mask:0xf bank_mask:0xf
    v_mov_b32 v241, v240
    s_nop 1
    v_permlane16_swap_b32 v240, v241
    v_add_f32 v240, v240, v241
    v_mul_f32 v240, 0x3b000000, v240
    v_cvt_pk_bf16_f32 v240, v240, v240
    v_lshlrev_b32 v240, 16, v240
    v_add_f32 v240, 0x3727c5ac, v240
    v_cvt_pk_bf16_f32 v240, v240, v240
    v_lshlrev_b32 v240, 16, v240
    v_sqrt_f32 v240, v240
    s_nop 0
    v_cvt_pk_bf16_f32 v32, v242, v240
    buffer_load_dwordx4 v11, s[8:11], s51 offen offset:3072 lds
    s_waitcnt vmcnt(13)
    v_readfirstlane_b32 s60, v36
    v_readfirstlane_b32 s61, v37
    s_cmp_eq_u32 s60, 0
    s_cbranch_scc1 L_spin_30
L_ok_29:
    s_lshl_b32 s52, s45, 8
    s_lshl_b32 s93, s42, 4
    s_add_u32 s52, s52, s93
    s_add_u32 s52, s52, 0xc00000
    v_lshrrev_b32 v35, 5, v1
    v_lshlrev_b32 v35, 3, v35
    v_mov_b32 v33, s60
    s_mov_b32 exec_lo, 1
    s_mov_b32 exec_hi, 1
    buffer_store_dwordx2 v[32:33], v35, s[32:35], s52 offen sc1
    s_mov_b64 exec, -1
    s_and_b32 s52, s45, 63
    s_lshl_b32 s52, s52, 8
    v_and_b32 v35, 31, v1
    v_lshl_add_u32 v35, v35, 3, s52
    ds_read_b128 a[36:39], v38 offset:29696
    v_mfma_f32_32x32x16_bf16 v[64:79], v[164:167], a[0:3], v[64:79]
    ds_read_b128 a[40:43], v38 offset:30720
    v_accvgpr_write_b32 a127, v55
    v_accvgpr_write_b32 a131, v56
    v_accvgpr_write_b32 a135, v57
    v_cvt_f32_u32 v40, s49
    v_mul_f32 v40, 0x3d000000, v40
    v_mfma_f32_32x32x16_bf16 v[80:95], v[164:167], a[4:7], v[80:95]
    ds_read_b128 a[44:47], v38 offset:31744
    v_fmac_f32 v60, v40, v61
    v_mov_b32 v40, v60
    v_fmamk_f32 v41, v61, 0x3f800000, v60
    v_fmamk_f32 v42, v61, 0x40000000, v60
    v_fmamk_f32 v43, v61, 0x40400000, v60
    s_waitcnt lgkmcnt(5)
    v_mfma_f32_32x32x16_bf16 v[96:111], v[168:171], a[24:27], v[96:111]
    s_waitcnt vmcnt(13)
    v_add_u32 v16, 0x10000, v16
    v_add_u32 v17, 0x10000, v17
    v_add_u32 v18, 0x10000, v18
    v_add_u32 v19, 0x10000, v19
    ds_read_b128 v[192:195], v16 offset:0
    ds_read_b128 v[196:199], v17 offset:0
    v_mfma_f32_32x32x16_bf16 v[112:127], v[168:171], a[28:31], v[112:127]
    ds_read_b128 a[0:3], v38 offset:32768
    ds_read_b128 a[4:7], v38 offset:33792
    v_cos_f32 v44, v40
    v_cos_f32 v45, v41
    v_mfma_f32_32x32x16_bf16 v[64:79], v[168:171], a[16:19], v[64:79]
    ds_read_b128 a[8:11], v38 offset:34816
    v_cos_f32 v46, v42
    v_cos_f32 v47, v43
    v_mfma_f32_32x32x16_bf16 v[80:95], v[168:171], a[20:23], v[80:95]
    ds_read_b128 a[12:15], v38 offset:35840
    v_sin_f32 v48, v40
    v_sin_f32 v49, v41
    s_waitcnt lgkmcnt(6)
    v_mfma_f32_32x32x16_bf16 v[96:111], v[172:175], a[40:43], v[96:111]
    ds_read_b128 v[200:203], v18 offset:0
    ds_read_b128 a[16:19], v38 offset:36864
    s_add_u32 m0, s50, 114688
    s_add_u32 s51, s57, 0
    buffer_load_dwordx4 v4, s[12:15], s51 offen offset:0 lds
    v_mfma_f32_32x32x16_bf16 v[112:127], v[172:175], a[44:47], v[112:127]
    ds_read_b128 a[20:23], v38 offset:37888
    v_sin_f32 v50, v42
    v_sin_f32 v51, v43
    v_cvt_pk_bf16_f32 v52, v44, v45
    v_mfma_f32_32x32x16_bf16 v[64:79], v[172:175], a[32:35], v[64:79]
    ds_read_b128 a[24:27], v38 offset:38912
    buffer_load_dwordx4 v5, s[12:15], s51 offen offset:1024 lds
    v_cvt_pk_bf16_f32 v53, v48, v49
    v_xor_b32 v54, v59, v52
    v_mfma_f32_32x32x16_bf16 v[80:95], v[172:175], a[36:39], v[80:95]
    ds_read_b128 a[28:31], v38 offset:39936
    v_xor_b32 v55, v59, v53
    v_xor_b32 v56, s62, v53
    v_xor_b32 v57, s62, v55
    v_accvgpr_write_b32 a136, v52
    v_accvgpr_write_b32 a144, v53
    s_waitcnt lgkmcnt(5)
    v_mfma_f32_32x32x16_bf16 v[96:111], v[176:179], a[8:11], v[96:111]
    ds_read_b128 v[204:207], v19 offset:0
    ds_read_b128 a[32:35], v38 offset:40960
    buffer_load_dwordx4 v6, s[12:15], s51 offen offset:2048 lds
    v_accvgpr_write_b32 a140, v54
    v_mfma_f32_32x32x16_bf16 v[112:127], v[176:179], a[12:15], v[112:127]
    ds_read_b128 a[36:39], v38 offset:41984
    v_accvgpr_write_b32 a148, v55
    v_accvgpr_write_b32 a152, v56
    v_accvgpr_write_b32 a156, v57
    v_cvt_pk_bf16_f32 v52, v46, v47
    v_cvt_pk_bf16_f32 v53, v50, v51
    v_mfma_f32_32x32x16_bf16 v[64:79], v[176:179], a[0:3], v[64:79]
    ds_read_b128 a[40:43], v38 offset:43008
    buffer_load_dwordx4 v7, s[12:15], s51 offen offset:3072 lds
    v_xor_b32 v54, v59, v52
    v_xor_b32 v55, v59, v53
    v_mfma_f32_32x32x16_bf16 v[80:95], v[176:179], a[4:7], v[80:95]
    ds_read_b128 a[44:47], v38 offset:44032
    v_xor_b32 v56, s62, v53
    v_xor_b32 v57, s62, v55
    v_accvgpr_write_b32 a137, v52
    v_accvgpr_write_b32 a145, v53
    v_accvgpr_write_b32 a141, v54
    s_waitcnt lgkmcnt(5)
    v_mfma_f32_32x32x16_bf16 v[96:111], v[180:183], a[24:27], v[96:111]
    s_waitcnt vmcnt(13)
    v_add_u32 v16, 0xfffe0000, v16
    v_add_u32 v17, 0xfffe0000, v17
    v_add_u32 v18, 0xfffe0000, v18
    v_add_u32 v19, 0xfffe0000, v19
    ds_read_b128 v[208:211], v16 offset:0
    ds_read_b128 v[212:215], v17 offset:0
    v_mfma_f32_32x32x16_bf16 v[112:127], v[180:183], a[28:31], v[112:127]
    ds_read_b128 a[0:3], v38 offset:45056
    ds_read_b128 a[4:7], v38 offset:46080
    v_accvgpr_write_b32 a149, v55
    v_accvgpr_write_b32 a153, v56
    v_accvgpr_write_b32 a157, v57
    v_fmamk_f32 v40, v61, 0x40800000, v60
    v_mfma_f32_32x32x16_bf16 v[64:79], v[180:183], a[16:19], v[64:79]
    ds_read_b128 a[8:11], v38 offset:47104
    v_fmamk_f32 v41, v61, 0x40a00000, v60
    v_fmamk_f32 v42, v61, 0x40c00000, v60
    v_fmamk_f32 v43, v61, 0x40e00000, v60
    v_cos_f32 v44, v40
    v_mfma_f32_32x32x16_bf16 v[80:95], v[180:183], a[20:23], v[80:95]
    ds_read_b128 a[12:15], v38 offset:48128
    v_cos_f32 v45, v41
    v_cos_f32 v46, v42
    s_waitcnt lgkmcnt(6)
    v_mfma_f32_32x32x16_bf16 v[96:111], v[184:187], a[40:43], v[96:111]
    ds_read_b128 v[216:219], v18 offset:0
    v_add_u32 v38, 0xffff0000, v38
    ds_read_b128 a[16:19], v38 offset:49152
    s_add_u32 m0, s50, 131072
    s_add_u32 s51, s57, 229376
    buffer_load_dwordx4 v4, s[12:15], s51 offen offset:0 lds
    v_mfma_f32_32x32x16_bf16 v[112:127], v[184:187], a[44:47], v[112:127]
    ds_read_b128 a[20:23], v38 offset:50176
    v_cos_f32 v47, v43
    v_sin_f32 v48, v40
    v_mfma_f32_32x32x16_bf16 v[64:79], v[184:187], a[32:35], v[64:79]
    ds_read_b128 a[24:27], v38 offset:51200
    buffer_load_dwordx4 v5, s[12:15], s51 offen offset:1024 lds
    v_sin_f32 v49, v41
    v_mfma_f32_32x32x16_bf16 v[80:95], v[184:187], a[36:39], v[80:95]
    ds_read_b128 a[28:31], v38 offset:52224
    v_sin_f32 v50, v42
    v_sin_f32 v51, v43
    v_cvt_pk_bf16_f32 v52, v44, v45
    s_waitcnt lgkmcnt(5)
    v_mfma_f32_32x32x16_bf16 v[96:111], v[188:191], a[8:11], v[96:111]
    ds_read_b128 v[220:223], v19 offset:0
    ds_read_b128 a[32:35], v38 offset:53248
    buffer_load_dwordx4 v6, s[12:15], s51 offen offset:2048 lds
    v_cvt_pk_bf16_f32 v53, v48, v49
    v_mfma_f32_32x32x16_bf16 v[112:127], v[188:191], a[12:15], v[112:127]
    ds_read_b128 a[36:39], v38 offset:54272
    v_xor_b32 v54, v59, v52
    v_xor_b32 v55, v59, v53
    v_xor_b32 v56, s62, v53
    v_xor_b32 v57, s62, v55
    v_accvgpr_write_b32 a138, v52
    v_mfma_f32_32x32x16_bf16 v[64:79], v[188:191], a[0:3], v[64:79]
    ds_read_b128 a[40:43], v38 offset:55296
    buffer_load_dwordx4 v7, s[12:15], s51 offen offset:3072 lds
    v_accvgpr_write_b32 a146, v53
    v_accvgpr_write_b32 a142, v54
    v_mfma_f32_32x32x16_bf16 v[80:95], v[188:191], a[4:7], v[80:95]
    ds_read_b128 a[44:47], v38 offset:56320
    v_accvgpr_write_b32 a150, v55
    v_accvgpr_write_b32 a154, v56
    v_accvgpr_write_b32 a158, v57
    v_cvt_pk_bf16_f32 v52, v46, v47
    v_cvt_pk_bf16_f32 v53, v50, v51
    s_waitcnt lgkmcnt(5)
    v_mfma_f32_32x32x16_bf16 v[96:111], v[192:195], a[24:27], v[96:111]
    v_xor_b32 v24, s62, v192
    v_xor_b32 v25, s62, v193
    v_xor_b32 v26, s62, v194
    v_xor_b32 v27, s62, v195
    s_waitcnt vmcnt(13)
    ds_read_b128 v[224:227], v16 offset:16384
    ds_read_b128 v[228:231], v17 offset:16384
    v_mfma_f32_32x32x16_bf16 v[112:127], v[192:195], a[28:31], v[112:127]
    ds_read_b128 a[0:3], v38 offset:57344
    ds_read_b128 a[4:7], v38 offset:58368
    v_xor_b32 v54, v59, v52
    v_xor_b32 v55, v59, v53
    v_xor_b32 v56, s62, v53
    v_xor_b32 v57, s62, v55
    v_mfma_f32_32x32x16_bf16 v[64:79], v[24:27], a[16:19], v[64:79]
    ds_read_b128 a[8:11], v38 offset:59392
    v_accvgpr_write_b32 a139, v52
    v_accvgpr_write_b32 a147, v53
    v_accvgpr_write_b32 a143, v54
    v_accvgpr_write_b32 a151, v55
    v_accvgpr_write_b32 a155, v56
    v_mfma_f32_32x32x16_bf16 v[80:95], v[24:27], a[20:23], v[80:95]
    ds_read_b128 a[12:15], v38 offset:60416
    v_accvgpr_write_b32 a159, v57
    v_lshrrev_b32 v40, 3, v1
    v_lshlrev_b32 v40, 10, v40
    v_bfe_u32 v41, v1, 4, 1
    v_lshlrev_b32 v41, 6, v41
    s_waitcnt lgkmcnt(6)
    v_mfma_f32_32x32x16_bf16 v[96:111], v[196:199], a[40:43], v[96:111]
    v_xor_b32 v28, s62, v196
    v_xor_b32 v29, s62, v197
    v_xor_b32 v30, s62, v198
    v_xor_b32 v31, s62, v199
    ds_read_b128 v[232:235], v18 offset:16384
    ds_read_b128 a[16:19], v38 offset:61440
    s_add_u32 m0, s50, 0
    s_add_u32 s51, s57, 458752
    buffer_load_dwordx4 v4, s[12:15], s51 offen offset:0 lds
    v_mfma_f32_32x32x16_bf16 v[112:127], v[196:199], a[44:47], v[112:127]
    ds_read_b128 a[20:23], v38 offset:62464
    v_and_b32 v42, 0x70, v2
    v_xor_b32 v41, v41, v42
    v_add_u32 v8, v40, v41
    v_add_u32 v9, 7168, v8
    v_add_u32 v10, 14336, v8
    v_mfma_f32_32x32x16_bf16 v[64:79], v[28:31], a[32:35], v[64:79]
    ds_read_b128 a[24:27], v38 offset:63488
    buffer_load_dwordx4 v5, s[12:15], s51 offen offset:1024 lds
    v_add_u32 v11, 21504, v8
    s_mul_i32 s59, s40, 458752
    v_mfma_f32_32x32x16_bf16 v[80:95], v[28:31], a[36:39], v[80:95]
    ds_read_b128 a[28:31], v38 offset:64512
    s_lshl_b32 s53, s47, 7
    s_add_u32 s59, s59, s53
    s_mov_b32 s64, 0
    s_mov_b32 s72, 0
    s_mov_b32 s65, 4096
    s_waitcnt lgkmcnt(5)
    v_mfma_f32_32x32x16_bf16 v[96:111], v[200:203], a[8:11], v[96:111]
    v_xor_b32 v24, s62, v200
    v_xor_b32 v25, s62, v201
    v_xor_b32 v26, s62, v202
    v_xor_b32 v27, s62, v203
    ds_read_b128 v[236:239], v19 offset:16384
    v_add_u32 v38, 0x10000, v38
    ds_read_b128 a[32:35], v38 offset:0
    buffer_load_dwordx4 v6, s[12:15], s51 offen offset:2048 lds
    v_mfma_f32_32x32x16_bf16 v[112:127], v[200:203], a[12:15], v[112:127]
    ds_read_b128 a[36:39], v38 offset:1024
    s_mov_b32 s73, 256
    s_mov_b32 s66, 8192
    s_mov_b32 s74, 512
    s_mov_b32 s67, 12288
    s_mov_b32 s75, 768
    v_mfma_f32_32x32x16_bf16 v[64:79], v[24:27], a[0:3], v[64:79]
    ds_read_b128 a[40:43], v38 offset:2048
    buffer_load_dwordx4 v7, s[12:15], s51 offen offset:3072 lds
    s_mov_b32 s68, 16384
    s_mov_b32 s76, 1024
    v_mfma_f32_32x32x16_bf16 v[80:95], v[24:27], a[4:7], v[80:95]
    ds_read_b128 a[44:47], v38 offset:3072
    s_mov_b32 s69, 20480
    s_mov_b32 s77, 1280
    s_mov_b32 s70, 24576
    s_mov_b32 s78, 1536
    v_lshrrev_b32 v40, 5, v1
    s_waitcnt lgkmcnt(5)
    v_mfma_f32_32x32x16_bf16 v[96:111], v[204:207], a[24:27], v[96:111]
    v_xor_b32 v28, s62, v204
    v_xor_b32 v29, s62, v205
    v_xor_b32 v30, s62, v206
    v_xor_b32 v31, s62, v207
    s_waitcnt vmcnt(13)
    ds_read_b128 v[240:243], v16 offset:32768
    ds_read_b128 v[244:247], v17 offset:32768
    v_mfma_f32_32x32x16_bf16 v[112:127], v[204:207], a[28:31], v[112:127]
    ds_read_b128 a[0:3], v38 offset:4096
    ds_read_b128 a[4:7], v38 offset:5120
    v_bfe_u32 v41, v1, 2, 2
    v_lshlrev_b32 v42, 9, v40
    v_lshl_add_u32 v42, v41, 7, v42
    v_and_b32 v43, 3, v1
    v_mfma_f32_32x32x16_bf16 v[64:79], v[28:31], a[16:19], v[64:79]
    ds_read_b128 a[8:11], v38 offset:6144
    v_lshl_add_u32 v42, v43, 3, v42
    v_add_u32 v42, s50, v42
    v_and_b32 v41, 2, v41
    v_bfe_u32 v43, v1, 4, 1
    v_or_b32 v41, v41, v43
    v_mfma_f32_32x32x16_bf16 v[80:95], v[28:31], a[20:23], v[80:95]
    ds_read_b128 a[12:15], v38 offset:7168
    s_and_b32 s53, s40, 1
    s_lshl_b32 s53, s53, 1
    v_xor_b32 v41, s53, v41
    v_lshl_add_u32 v62, v41, 5, v42
    v_xor_b32 v63, 64, v62
    s_waitcnt lgkmcnt(6)
    v_mfma_f32_32x32x16_bf16 v[96:111], v[208:211], a[40:43], v[96:111]
    v_xor_b32 v24, s62, v208
    v_xor_b32 v25, s62, v209
    v_xor_b32 v26, s62, v210
    v_xor_b32 v27, s62, v211
    ds_read_b128 v[248:251], v18 offset:32768
    ds_read_b128 a[16:19], v38 offset:8192
    s_add_u32 m0, s50, 16384
    s_lshl_b32 s51, s64, 4
    s_add_u32 s51, s51, s59
    buffer_load_dwordx4 v8, s[16:19], s51 offen offset:0 lds
    v_mfma_f32_32x32x16_bf16 v[112:127], v[208:211], a[44:47], v[112:127]
    ds_read_b128 a[20:23], v38 offset:9216
    v_and_b32 v59, 1, v1
    v_mul_lo_u32 v59, v59, s62
    v_and_b32 v61, 31, v1
    v_lshrrev_b32 v60, 5, v1
    v_cvt_f32_u32 v61, v61
    v_mfma_f32_32x32x16_bf16 v[64:79], v[24:27], a[32:35], v[64:79]
    ds_read_b128 a[24:27], v38 offset:10240
    buffer_load_dwordx4 v9, s[16:19], s51 offen offset:1024 lds
    v_mul_f32 v61, 0x3d000000, v61
    v_lshlrev_b32 v60, 8, v60
    v_mfma_f32_32x32x16_bf16 v[80:95], v[24:27], a[36:39], v[80:95]
    ds_read_b128 a[28:31], v38 offset:11264
    v_add_u32 v60, s45, v60
    v_cvt_f32_u32 v60, v60
    v_mul_f32 v60, 0x3c800000, v60
    v_mul_f32 v60, v60, v61
    v_mov_b32 v40, v60
    s_waitcnt lgkmcnt(5)
    v_mfma_f32_32x32x16_bf16 v[96:111], v[212:215], a[8:11], v[96:111]
    v_xor_b32 v28, s62, v212
    v_xor_b32 v29, s62, v213
    v_xor_b32 v30, s62, v214
    v_xor_b32 v31, s62, v215
    ds_read_b128 v[252:255], v19 offset:32768
    ds_read_b128 a[32:35], v38 offset:12288
    buffer_load_dwordx4 v10, s[16:19], s51 offen offset:2048 lds
    v_mfma_f32_32x32x16_bf16 v[112:127], v[212:215], a[12:15], v[112:127]
    ds_read_b128 a[36:39], v38 offset:13312
    v_fmamk_f32 v41, v61, 0x3f800000, v60
    v_fmamk_f32 v42, v61, 0x40000000, v60
    v_fmamk_f32 v43, v61, 0x40400000, v60
    v_cos_f32 v44, v40
    v_mfma_f32_32x32x16_bf16 v[64:79], v[28:31], a[0:3], v[64:79]
    ds_read_b128 a[40:43], v38 offset:14336
    buffer_load_dwordx4 v11, s[16:19], s51 offen offset:3072 lds
    v_cos_f32 v45, v41
    v_mfma_f32_32x32x16_bf16 v[80:95], v[28:31], a[4:7], v[80:95]
    ds_read_b128 a[44:47], v38 offset:15360
    v_cos_f32 v46, v42
    v_cos_f32 v47, v43
    s_waitcnt lgkmcnt(5)
    v_mfma_f32_32x32x16_bf16 v[96:111], v[216:219], a[24:27], v[96:111]
    v_xor_b32 v24, s62, v216
    v_xor_b32 v25, s62, v217
    v_xor_b32 v26, s62, v218
    v_xor_b32 v27, s62, v219
    ds_read_b128 a[0:3], v38 offset:16384
    v_mfma_f32_32x32x16_bf16 v[112:127], v[216:219], a[28:31], v[112:127]
    ds_read_b128 a[4:7], v38 offset:17408
    v_sin_f32 v48, v40
    v_sin_f32 v49, v41
    v_mfma_f32_32x32x16_bf16 v[64:79], v[24:27], a[16:19], v[64:79]
    ds_read_b128 a[8:11], v38 offset:18432
    v_sin_f32 v50, v42
    v_sin_f32 v51, v43
    v_cvt_pk_bf16_f32 v52, v44, v45
    v_mfma_f32_32x32x16_bf16 v[80:95], v[24:27], a[20:23], v[80:95]
    ds_read_b128 a[12:15], v38 offset:19456
    v_cvt_pk_bf16_f32 v53, v48, v49
    v_xor_b32 v54, v59, v52
    v_xor_b32 v55, v59, v53
    v_xor_b32 v56, s62, v53
    v_xor_b32 v57, s62, v55
    s_waitcnt lgkmcnt(4)
    v_mfma_f32_32x32x16_bf16 v[96:111], v[220:223], a[40:43], v[96:111]
    v_xor_b32 v28, s62, v220
    v_xor_b32 v29, s62, v221
    v_xor_b32 v30, s62, v222
    v_xor_b32 v31, s62, v223
    ds_read_b128 a[16:19], v38 offset:20480
    s_add_u32 m0, s50, 32768
    s_lshl_b32 s51, s64, 4
    s_add_u32 s51, s51, s59
    s_add_u32 s51, s51, 32768
    buffer_load_dwordx4 v8, s[16:19], s51 offen offset:0 lds
    v_mfma_f32_32x32x16_bf16 v[112:127], v[220:223], a[44:47], v[112:127]
    s_mov_b32 s52, 0xc00000
    buffer_load_dwordx2 v[36:37], v35, s[32:35], s52 offen sc1
    ds_read_b128 a[20:23], v38 offset:21504
    v_accvgpr_write_b32 a160, v52
    v_mfma_f32_32x32x16_bf16 v[64:79], v[28:31], a[32:35], v[64:79]
    ds_read_b128 a[24:27], v38 offset:22528
    v_accvgpr_write_b32 a168, v53
    v_accvgpr_write_b32 a164, v54
    v_accvgpr_write_b32 a172, v55
    v_accvgpr_write_b32 a176, v56
    v_accvgpr_write_b32 a180, v57
    v_mfma_f32_32x32x16_bf16 v[80:95], v[28:31], a[36:39], v[80:95]
    ds_read_b128 a[28:31], v38 offset:23552
    buffer_load_dwordx4 v9, s[16:19], s51 offen offset:1024 lds
    v_cvt_pk_bf16_f32 v52, v46, v47
    v_cvt_pk_bf16_f32 v53, v50, v51
    s_waitcnt lgkmcnt(4)
    v_mfma_f32_32x32x16_bf16 v[96:111], v[224:227], a[8:11], v[96:111]
    v_xor_b32 v24, s62, v224
    v_xor_b32 v25, s62, v225
    v_xor_b32 v26, s62, v226
    v_xor_b32 v27, s62, v227
    ds_read_b128 a[32:35], v38 offset:24576
    v_xor_b32 v54, v59, v52
    v_mfma_f32_32x32x16_bf16 v[112:127], v[224:227], a[12:15], v[112:127]
    ds_read_b128 a[36:39], v38 offset:25600
    buffer_load_dwordx4 v10, s[16:19], s51 offen offset:2048 lds
    v_xor_b32 v55, v59, v53
    v_xor_b32 v56, s62, v53
    v_mfma_f32_32x32x16_bf16 v[64:79], v[24:27], a[0:3], v[64:79]
    ds_read_b128 a[40:43], v38 offset:26624
    v_xor_b32 v57, s62, v55
    v_accvgpr_write_b32 a161, v52
    v_accvgpr_write_b32 a169, v53
    v_accvgpr_write_b32 a165, v54
    v_accvgpr_write_b32 a173, v55
    v_mfma_f32_32x32x16_bf16 v[80:95], v[24:27], a[4:7], v[80:95]
    ds_read_b128 a[44:47], v38 offset:27648
    buffer_load_dwordx4 v11, s[16:19], s51 offen offset:3072 lds
    v_accvgpr_write_b32 a177, v56
    v_accvgpr_write_b32 a181, v57
    s_waitcnt lgkmcnt(4)
    v_mfma_f32_32x32x16_bf16 v[96:111], v[228:231], a[24:27], v[96:111]
    v_xor_b32 v28, s62, v228
    v_xor_b32 v29, s62, v229
    v_xor_b32 v30, s62, v230
    v_xor_b32 v31, s62, v231
    ds_read_b128 a[0:3], v38 offset:28672
    v_fmamk_f32 v40, v61, 0x41000000, v60
    v_mfma_f32_32x32x16_bf16 v[112:127], v[228:231], a[28:31], v[112:127]
    ds_read_b128 a[4:7], v38 offset:29696
    v_fmamk_f32 v41, v61, 0x41100000, v60
    v_fmamk_f32 v42, v61, 0x41200000, v60
    v_fmamk_f32 v43, v61, 0x41300000, v60
    v_cos_f32 v44, v40
    v_mfma_f32_32x32x16_bf16 v[64:79], v[28:31], a[16:19], v[64:79]
    ds_read_b128 a[8:11], v38 offset:30720
    v_cos_f32 v45, v41
    v_cos_f32 v46, v42
    v_mfma_f32_32x32x16_bf16 v[80:95], v[28:31], a[20:23], v[80:95]
    ds_read_b128 a[12:15], v38 offset:31744
    v_cos_f32 v47, v43
    v_sin_f32 v48, v40
    s_waitcnt lgkmcnt(4)
    v_mfma_f32_32x32x16_bf16 v[96:111], v[232:235], a[40:43], v[96:111]
    v_xor_b32 v24, s62, v232
    v_xor_b32 v25, s62, v233
    v_xor_b32 v26, s62, v234
    v_xor_b32 v27, s62, v235
    ds_read_b128 a[16:19], v38 offset:32768
    v_mfma_f32_32x32x16_bf16 v[112:127], v[232:235], a[44:47], v[112:127]
    ds_read_b128 a[20:23], v38 offset:33792
    v_sin_f32 v49, v41
    v_sin_f32 v50, v42
    v_mfma_f32_32x32x16_bf16 v[64:79], v[24:27], a[32:35], v[64:79]
    ds_read_b128 a[24:27], v38 offset:34816
    v_sin_f32 v51, v43
    v_cvt_pk_bf16_f32 v52, v44, v45
    v_cvt_pk_bf16_f32 v53, v48, v49
    v_xor_b32 v54, v59, v52
    v_mfma_f32_32x32x16_bf16 v[80:95], v[24:27], a[36:39], v[80:95]
    ds_read_b128 a[28:31], v38 offset:35840
    v_xor_b32 v55, v59, v53
    v_xor_b32 v56, s62, v53
    v_xor_b32 v57, s62, v55
    v_accvgpr_write_b32 a162, v52
    v_accvgpr_write_b32 a170, v53
    s_waitcnt lgkmcnt(4)
    v_mfma_f32_32x32x16_bf16 v[96:111], v[236:239], a[8:11], v[96:111]
    v_xor_b32 v28, s62, v236
    v_xor_b32 v29, s62, v237
    v_xor_b32 v30, s62, v238
    v_xor_b32 v31, s62, v239
    ds_read_b128 a[32:35], v38 offset:36864
    v_accvgpr_write_b32 a166, v54
    v_mfma_f32_32x32x16_bf16 v[112:127], v[236:239], a[12:15], v[112:127]
    ds_read_b128 a[36:39], v38 offset:37888
    v_accvgpr_write_b32 a174, v55
    v_accvgpr_write_b32 a178, v56
    v_accvgpr_write_b32 a182, v57
    v_cvt_pk_bf16_f32 v52, v46, v47
    v_cvt_pk_bf16_f32 v53, v50, v51
    v_mfma_f32_32x32x16_bf16 v[64:79], v[28:31], a[0:3], v[64:79]
    ds_read_b128 a[40:43], v38 offset:38912
    v_xor_b32 v54, v59, v52
    v_xor_b32 v55, v59, v53
    v_xor_b32 v56, s62, v53
    v_xor_b32 v57, s62, v55
    v_accvgpr_write_b32 a163, v52
    v_mfma_f32_32x32x16_bf16 v[80:95], v[28:31], a[4:7], v[80:95]
    ds_read_b128 a[44:47], v38 offset:39936
    v_accvgpr_write_b32 a171, v53
    v_accvgpr_write_b32 a167, v54
    v_accvgpr_write_b32 a175, v55
    v_accvgpr_write_b32 a179, v56
    v_accvgpr_write_b32 a183, v57
    s_waitcnt lgkmcnt(4)
    v_mfma_f32_32x32x16_bf16 v[96:111], v[240:243], a[24:27], v[96:111]
    v_xor_b32 v24, s62, v240
    v_xor_b32 v25, s62, v241
    v_xor_b32 v26, s62, v242
    v_xor_b32 v27, s62, v243
    ds_read_b128 a[0:3], v38 offset:40960
    v_mfma_f32_32x32x16_bf16 v[112:127], v[240:243], a[28:31], v[112:127]
    s_waitcnt vmcnt(3)
    v_cmp_ne_u32 vcc, s60, v37
    s_cbranch_vccnz L_spin_32
L_ok_31:
    v_cmp_gt_u32 vcc, 32, v1
    v_and_b32 v34, 0xffff0000, v36
    v_and_b32 v33, 0xffff, v36
    v_rcp_f32 v37, v34
    v_cndmask_b32 v33, 0, v33, vcc
    v_mul_f32 v34, v37, v37
    v_lshl_or_b32 v32, v33, 16, v33
    ds_read_b128 a[4:7], v38 offset:41984
    v_mfma_f32_32x32x16_bf16 v[64:79], v[24:27], a[16:19], v[64:79]
    ds_read_b128 a[8:11], v38 offset:43008
    v_mfma_f32_32x32x16_bf16 v[80:95], v[24:27], a[20:23], v[80:95]
    ds_read_b128 a[12:15], v38 offset:44032
    ds_read_b64_tr_b16 a[184:185], v62 offset:16384
    s_waitcnt lgkmcnt(5)
    v_mfma_f32_32x32x16_bf16 v[96:111], v[244:247], a[40:43], v[96:111]
    v_xor_b32 v28, s62, v244
    v_xor_b32 v29, s62, v245
    v_xor_b32 v30, s62, v246
    v_xor_b32 v31, s62, v247
    ds_read_b128 a[16:19], v38 offset:45056
    ds_read_b64_tr_b16 a[186:187], v62 offset:17408
    v_mfma_f32_32x32x16_bf16 v[112:127], v[244:247], a[44:47], v[112:127]
    ds_read_b128 a[20:23], v38 offset:46080
    ds_read_b64_tr_b16 a[188:189], v63 offset:16384
    v_mul_f32 v37, 0x36000000, v37
    s_lshl_b32 s53, s40, 7
    s_add_u32 s53, s53, 159744
    v_and_b32 v3, 31, v1
    v_mfma_f32_32x32x16_bf16 v[64:79], v[28:31], a[32:35], v[64:79]
    ds_read_b128 a[24:27], v38 offset:47104
    ds_read_b64_tr_b16 a[190:191], v63 offset:17408
    v_lshl_add_u32 v3, v3, 2, s53
    ds_write_b32 v3, v37
    v_lshrrev_b32 v0, 5, v1
    v_mfma_f32_32x32x16_bf16 v[80:95], v[28:31], a[36:39], v[80:95]
    ds_read_b128 a[28:31], v38 offset:48128
    ds_read_b64_tr_b16 a[192:193], v62 offset:18432
    v_lshl_add_u32 v0, v0, 4, s53
    s_waitcnt lgkmcnt(10)
    v_mfma_f32_32x32x16_bf16 v[96:111], v[248:251], a[8:11], v[96:111]
    s_barrier
    v_xor_b32 v24, s62, v248
    v_xor_b32 v25, s62, v249
    v_xor_b32 v26, s62, v250
    v_xor_b32 v27, s62, v251
    v_add_u32 v12, 0x10000, v12
    v_add_u32 v13, 0x10000, v13
    v_add_u32 v14, 0x10000, v14
    v_add_u32 v15, 0x10000, v15
    ds_read_b64_tr_b16 a[32:33], v12 offset:49152
    ds_read_b64_tr_b16 a[34:35], v12 offset:49664
    v_mfma_f32_32x32x16_bf16 v[112:127], v[248:251], a[12:15], v[112:127]
    ds_read_b64_tr_b16 a[36:37], v13 offset:49152
    ds_read_b64_tr_b16 a[38:39], v13 offset:49664
    ds_read_b64_tr_b16 a[194:195], v62 offset:19456
    v_mfma_f32_32x32x16_bf16 v[64:79], v[24:27], a[0:3], v[64:79]
    ds_read_b64_tr_b16 a[40:41], v14 offset:49152
    ds_read_b64_tr_b16 a[42:43], v14 offset:49664
    ds_read_b64_tr_b16 a[196:197], v63 offset:18432
    s_waitcnt lgkmcnt(10)
    ds_read_b128 v[40:43], v0 offset:0
    ds_read_b128 v[44:47], v0 offset:32
    v_mfma_f32_32x32x16_bf16 v[80:95], v[24:27], a[4:7], v[80:95]
    ds_read_b64_tr_b16 a[44:45], v15 offset:49152
    ds_read_b64_tr_b16 a[46:47], v15 offset:49664
    ds_read_b64_tr_b16 a[198:199], v63 offset:19456
    ds_read_b128 v[48:51], v0 offset:64
    ds_read_b128 v[52:55], v0 offset:96
    s_waitcnt lgkmcnt(14)
    v_mfma_f32_32x32x16_bf16 v[96:111], v[252:255], a[24:27], v[96:111]
    v_xor_b32 v28, s62, v252
    v_xor_b32 v29, s62, v253
    v_xor_b32 v30, s62, v254
    v_xor_b32 v31, s62, v255
    ds_read_b64_tr_b16 a[0:1], v12 offset:51200
    ds_read_b64_tr_b16 a[2:3], v12 offset:51712
    v_mfma_f32_32x32x16_bf16 v[112:127], v[252:255], a[28:31], v[112:127]
    ds_read_b64_tr_b16 a[4:5], v13 offset:51200
    ds_read_b64_tr_b16 a[6:7], v13 offset:51712
    v_mfma_f32_32x32x16_bf16 v[64:79], v[28:31], a[16:19], v[64:79]
    ds_read_b64_tr_b16 a[8:9], v14 offset:51200
    ds_read_b64_tr_b16 a[10:11], v14 offset:51712
    v_mfma_f32_32x32x16_bf16 v[80:95], v[28:31], a[20:23], v[80:95]
    ds_read_b64_tr_b16 a[12:13], v15 offset:51200
    ds_read_b64_tr_b16 a[14:15], v15 offset:51712
    s_waitcnt lgkmcnt(8)
    v_mul_f32 v96, v96, v40
    v_mul_f32 v97, v97, v41
    v_cvt_pk_bf16_f32 v96, v96, v97
    v_mul_f32 v98, v98, v42
    v_mul_f32 v99, v99, v43
    v_cvt_pk_bf16_f32 v97, v98, v99
    v_mul_f32 v100, v100, v44
    v_mul_f32 v101, v101, v45
    v_cvt_pk_bf16_f32 v98, v100, v101
    v_mul_f32 v102, v102, v46
    v_mul_f32 v103, v103, v47
    v_cvt_pk_bf16_f32 v99, v102, v103
    v_mul_f32 v104, v104, v48
    v_mul_f32 v105, v105, v49
    v_cvt_pk_bf16_f32 v100, v104, v105
    v_mul_f32 v106, v106, v50
    v_mul_f32 v107, v107, v51
    v_cvt_pk_bf16_f32 v101, v106, v107
    v_mul_f32 v108, v108, v52
    v_mul_f32 v109, v109, v53
    v_cvt_pk_bf16_f32 v102, v108, v109
    v_mul_f32 v110, v110, v54
    v_mul_f32 v111, v111, v55
    v_cvt_pk_bf16_f32 v103, v110, v111
    v_mul_f32 v112, v112, v40
    v_mul_f32 v113, v113, v41
    v_cvt_pk_bf16_f32 v112, v112, v113
    v_mul_f32 v114, v114, v42
    v_mul_f32 v115, v115, v43
    v_cvt_pk_bf16_f32 v113, v114, v115
    v_mul_f32 v116, v116, v44
    v_mul_f32 v117, v117, v45
    v_cvt_pk_bf16_f32 v114, v116, v117
    v_mul_f32 v118, v118, v46
    v_mul_f32 v119, v119, v47
    v_cvt_pk_bf16_f32 v115, v118, v119
    v_mul_f32 v120, v120, v48
    v_mul_f32 v121, v121, v49
    v_cvt_pk_bf16_f32 v116, v120, v121
    v_mul_f32 v122, v122, v50
    v_mul_f32 v123, v123, v51
    v_cvt_pk_bf16_f32 v117, v122, v123
    v_mul_f32 v124, v124, v52
    v_mul_f32 v125, v125, v53
    v_cvt_pk_bf16_f32 v118, v124, v125
    v_mul_f32 v126, v126, v54
    v_mul_f32 v127, v127, v55
    v_cvt_pk_bf16_f32 v119, v126, v127
    v_mfma_f32_32x32x16_bf16 a[80:95], v[96:99], a[160:163], 0
    v_mul_f32 v64, v64, v40
    v_mul_f32 v65, v65, v41
    v_cvt_pk_bf16_f32 v64, v64, v65
    v_mul_f32 v66, v66, v42
    v_mul_f32 v67, v67, v43
    v_cvt_pk_bf16_f32 v65, v66, v67
    v_mfma_f32_32x32x16_bf16 a[96:111], v[112:115], a[160:163], 0
    v_mul_f32 v68, v68, v44
    v_mul_f32 v69, v69, v45
    v_cvt_pk_bf16_f32 v66, v68, v69
    v_mul_f32 v70, v70, v46
    v_mul_f32 v71, v71, v47
    v_cvt_pk_bf16_f32 v67, v70, v71
    v_mfma_f32_32x32x16_bf16 a[80:95], v[112:115], a[168:171], a[80:95]
    v_mul_f32 v72, v72, v48
    v_mul_f32 v73, v73, v49
    v_cvt_pk_bf16_f32 v68, v72, v73
    v_mul_f32 v74, v74, v50
    v_mul_f32 v75, v75, v51
    v_cvt_pk_bf16_f32 v69, v74, v75
    v_mfma_f32_32x32x16_bf16 a[96:111], v[96:99], a[176:179], a[96:111]
    v_mul_f32 v76, v76, v52
    v_mul_f32 v77, v77, v53
    v_cvt_pk_bf16_f32 v70, v76, v77
    v_mul_f32 v78, v78, v54
    v_mul_f32 v79, v79, v55
    v_cvt_pk_bf16_f32 v71, v78, v79
    v_mfma_f32_32x32x16_bf16 a[80:95], v[100:103], a[164:167], a[80:95]
    v_mul_f32 v80, v80, v40
    v_mul_f32 v81, v81, v41
    v_cvt_pk_bf16_f32 v80, v80, v81
    v_mul_f32 v82, v82, v42
    v_mul_f32 v83, v83, v43
    v_cvt_pk_bf16_f32 v81, v82, v83
    v_mfma_f32_32x32x16_bf16 a[96:111], v[116:119], a[164:167], a[96:111]
    v_mul_f32 v84, v84, v44
    v_mul_f32 v85, v85, v45
    v_cvt_pk_bf16_f32 v82, v84, v85
    v_mul_f32 v86, v86, v46
    v_mul_f32 v87, v87, v47
    v_cvt_pk_bf16_f32 v83, v86, v87
    v_mfma_f32_32x32x16_bf16 a[80:95], v[116:119], a[172:175], a[80:95]
    v_mul_f32 v88, v88, v48
    v_mul_f32 v89, v89, v49
    v_cvt_pk_bf16_f32 v84, v88, v89
    v_mul_f32 v90, v90, v50
    v_mul_f32 v91, v91, v51
    v_cvt_pk_bf16_f32 v85, v90, v91
    v_mfma_f32_32x32x16_bf16 a[96:111], v[100:103], a[180:183], a[96:111]
    v_mul_f32 v92, v92, v52
    v_mul_f32 v93, v93, v53
    v_cvt_pk_bf16_f32 v86, v92, v93
    v_mul_f32 v94, v94, v54
    v_mul_f32 v95, v95, v55
    v_cvt_pk_bf16_f32 v87, v94, v95
    s_barrier
    v_mfma_f32_32x32x16_bf16 a[48:63], v[64:67], a[160:163], 0
    s_add_u32 m0, s50, 49152
    s_add_u32 s51, s57, 688128
    buffer_load_dwordx4 v4, s[12:15], s51 offen offset:0 lds
    v_mfma_f32_32x32x16_bf16 a[64:79], v[80:83], a[160:163], 0
    v_mfma_f32_32x32x16_bf16 a[48:63], v[80:83], a[168:171], a[48:63]
    buffer_load_dwordx4 v5, s[12:15], s51 offen offset:1024 lds
    s_lshl_b32 s5, s40, 13
    s_add_u32 s5, s5, 81920
    v_lshlrev_b32 v0, 7, v1
    v_mfma_f32_32x32x16_bf16 a[64:79], v[64:67], a[176:179], a[64:79]
    v_and_b32 v3, 0x70, v2
    v_add3_u32 v0, v0, v3, s5
    v_accvgpr_read_b32 v40, a80
    v_accvgpr_read_b32 v41, a81
    v_accvgpr_read_b32 v42, a82
    v_accvgpr_read_b32 v43, a83
    v_mfma_f32_32x32x16_bf16 a[48:63], v[68:71], a[164:167], a[48:63]
    buffer_load_dwordx4 v6, s[12:15], s51 offen offset:2048 lds
    v_accvgpr_read_b32 v44, a84
    v_accvgpr_read_b32 v45, a85
    v_accvgpr_read_b32 v46, a86
    v_mfma_f32_32x32x16_bf16 a[64:79], v[84:87], a[164:167], a[64:79]
    v_accvgpr_read_b32 v47, a87
    v_cvt_pk_bf16_f32 v48, v40, v41
    v_cvt_pk_bf16_f32 v49, v42, v43
    v_cvt_pk_bf16_f32 v50, v44, v45
    v_cvt_pk_bf16_f32 v51, v46, v47
    v_xor_b32 v3, 32, v0
    v_mfma_f32_32x32x16_bf16 a[48:63], v[84:87], a[172:175], a[48:63]
    buffer_load_dwordx4 v7, s[12:15], s51 offen offset:3072 lds
    ds_write_b128 v3, v[48:51]
    v_add3_u32 v56, v48, v49, 0
    v_mfma_f32_32x32x16_bf16 a[64:79], v[68:71], a[180:183], a[64:79]
    v_add3_u32 v56, v50, v51, v56
    v_accvgpr_read_b32 v40, a88
    v_accvgpr_read_b32 v41, a89
    v_accvgpr_read_b32 v42, a90
    v_accvgpr_read_b32 v43, a91
    v_accvgpr_read_b32 v44, a92
    v_mfma_f32_16x16x32_bf16 v[20:23], a[248:251], a[32:35], 0
    v_accvgpr_read_b32 v45, a93
    v_accvgpr_read_b32 v46, a94
    v_mfma_f32_32x32x16_bf16 v[64:79], a[32:35], v[128:131], 0
    ds_read_b64_tr_b16 a[16:17], v12 offset:53248
    ds_read_b64_tr_b16 a[18:19], v12 offset:53760
    v_accvgpr_read_b32 v47, a95
    v_cvt_pk_bf16_f32 v52, v40, v41
    v_cvt_pk_bf16_f32 v53, v42, v43
    v_cvt_pk_bf16_f32 v54, v44, v45
    v_cvt_pk_bf16_f32 v55, v46, v47
    v_xor_b32 v3, 48, v0
    ds_write_b128 v3, v[52:55]
    v_add3_u32 v56, v52, v53, v56
    v_add3_u32 v56, v54, v55, v56
    v_mfma_f32_32x32x16_bf16 v[80:95], a[36:39], v[128:131], 0
    ds_read_b64_tr_b16 a[20:21], v13 offset:53248
    ds_read_b64_tr_b16 a[22:23], v13 offset:53760
    v_accvgpr_read_b32 v40, a96
    v_accvgpr_read_b32 v41, a97
    v_accvgpr_read_b32 v42, a98
    v_accvgpr_read_b32 v43, a99
    v_accvgpr_read_b32 v44, a100
    v_accvgpr_read_b32 v45, a101
    v_accvgpr_read_b32 v46, a102
    v_accvgpr_read_b32 v47, a103
    v_cvt_pk_bf16_f32 v48, v40, v41
    v_cvt_pk_bf16_f32 v49, v42, v43
    v_mfma_f32_32x32x16_bf16 v[96:111], a[40:43], v[128:131], 0
    ds_read_b64_tr_b16 a[24:25], v14 offset:53248
    ds_read_b64_tr_b16 a[26:27], v14 offset:53760
    v_cvt_pk_bf16_f32 v50, v44, v45
    v_cvt_pk_bf16_f32 v51, v46, v47
    v_xor_b32 v3, 96, v0
    ds_write_b128 v3, v[48:51]
    v_add3_u32 v56, v48, v49, v56
    v_add3_u32 v56, v50, v51, v56
    v_accvgpr_read_b32 v40, a104
    v_accvgpr_read_b32 v41, a105
    v_accvgpr_read_b32 v42, a106
    v_mfma_f32_32x32x16_bf16 v[112:127], a[44:47], v[128:131], 0
    ds_read_b64_tr_b16 a[28:29], v15 offset:53248
    ds_read_b64_tr_b16 a[30:31], v15 offset:53760
    v_accvgpr_read_b32 v43, a107
    v_accvgpr_read_b32 v44, a108
    v_accvgpr_read_b32 v45, a109
    v_accvgpr_read_b32 v46, a110
    v_accvgpr_read_b32 v47, a111
    v_cvt_pk_bf16_f32 v52, v40, v41
    v_cvt_pk_bf16_f32 v53, v42, v43
    v_cvt_pk_bf16_f32 v54, v44, v45
    v_cvt_pk_bf16_f32 v55, v46, v47
    v_xor_b32 v3, 112, v0
    s_waitcnt lgkmcnt(14)
    v_mfma_f32_16x16x32_bf16 v[20:23], a[248:251], a[0:3], v[20:23]
    ds_write_b128 v3, v[52:55]
    v_add3_u32 v56, v52, v53, v56
    v_add3_u32 v56, v54, v55, v56
    v_accvgpr_read_b32 v40, a48
    v_accvgpr_read_b32 v41, a49
    v_accvgpr_read_b32 v42, a50
    v_accvgpr_read_b32 v43, a51
    s_waitcnt lgkmcnt(12)
    v_mfma_f32_32x32x16_bf16 v[64:79], a[0:3], v[132:135], v[64:79]
    ds_read_b64_tr_b16 a[32:33], v12 offset:55296
    ds_read_b64_tr_b16 a[34:35], v12 offset:55808
    v_accvgpr_read_b32 v44, a52
    v_accvgpr_read_b32 v45, a53
    v_accvgpr_read_b32 v46, a54
    v_accvgpr_read_b32 v47, a55
    v_cvt_pk_bf16_f32 v48, v40, v41
    v_cvt_pk_bf16_f32 v49, v42, v43
    v_cvt_pk_bf16_f32 v50, v44, v45
    v_cvt_pk_bf16_f32 v51, v46, v47
    v_xor_b32 v3, 0, v0
    v_mfma_f32_32x32x16_bf16 v[80:95], a[4:7], v[132:135], v[80:95]
    ds_read_b64_tr_b16 a[36:37], v13 offset:55296
    ds_read_b64_tr_b16 a[38:39], v13 offset:55808
    ds_write_b128 v3, v[48:51]
    v_add3_u32 v56, v48, v49, v56
    v_add3_u32 v56, v50, v51, v56
    v_accvgpr_read_b32 v40, a56
    v_accvgpr_read_b32 v41, a57
    v_accvgpr_read_b32 v42, a58
    v_accvgpr_read_b32 v43, a59
    v_accvgpr_read_b32 v44, a60
    v_accvgpr_read_b32 v45, a61
    v_mfma_f32_32x32x16_bf16 v[96:111], a[8:11], v[132:135], v[96:111]
    ds_read_b64_tr_b16 a[40:41], v14 offset:55296
    ds_read_b64_tr_b16 a[42:43], v14 offset:55808
    v_accvgpr_read_b32 v46, a62
    v_accvgpr_read_b32 v47, a63
    v_cvt_pk_bf16_f32 v52, v40, v41
    v_cvt_pk_bf16_f32 v53, v42, v43
    v_cvt_pk_bf16_f32 v54, v44, v45
    v_cvt_pk_bf16_f32 v55, v46, v47
    v_xor_b32 v3, 16, v0
    ds_write_b128 v3, v[52:55]
    v_add3_u32 v56, v52, v53, v56
    v_mfma_f32_32x32x16_bf16 v[112:127], a[12:15], v[132:135], v[112:127]
    ds_read_b64_tr_b16 a[44:45], v15 offset:55296
    ds_read_b64_tr_b16 a[46:47], v15 offset:55808
    v_add3_u32 v56, v54, v55, v56
    v_accvgpr_read_b32 v40, a64
    v_accvgpr_read_b32 v41, a65
    v_accvgpr_read_b32 v42, a66
    v_accvgpr_read_b32 v43, a67
    v_accvgpr_read_b32 v44, a68
    v_accvgpr_read_b32 v45, a69
    v_accvgpr_read_b32 v46, a70
    v_accvgpr_read_b32 v47, a71
    v_cvt_pk_bf16_f32 v48, v40, v41
    s_waitcnt lgkmcnt(14)
    v_mfma_f32_16x16x32_bf16 v[20:23], a[248:251], a[16:19], v[20:23]
    v_cvt_pk_bf16_f32 v49, v42, v43
    v_cvt_pk_bf16_f32 v50, v44, v45
    v_cvt_pk_bf16_f32 v51, v46, v47
    v_xor_b32 v3, 64, v0
    ds_write_b128 v3, v[48:51]
    v_add3_u32 v56, v48, v49, v56
    v_add3_u32 v56, v50, v51, v56
    s_waitcnt lgkmcnt(12)
    v_mfma_f32_32x32x16_bf16 v[64:79], a[16:19], v[136:139], v[64:79]
    s_barrier
    v_add_u32 v12, 0x10000, v12
    v_add_u32 v13, 0x10000, v13
    v_add_u32 v14, 0x10000, v14
    v_add_u32 v15, 0x10000, v15
    ds_read_b64_tr_b16 a[0:1], v12 offset:0
    ds_read_b64_tr_b16 a[2:3], v12 offset:512
    v_accvgpr_read_b32 v40, a72
    v_accvgpr_read_b32 v41, a73
    v_accvgpr_read_b32 v42, a74
    v_accvgpr_read_b32 v43, a75
    v_accvgpr_read_b32 v44, a76
    v_mfma_f32_32x32x16_bf16 v[80:95], a[20:23], v[136:139], v[80:95]
    ds_read_b64_tr_b16 a[4:5], v13 offset:0
    ds_read_b64_tr_b16 a[6:7], v13 offset:512
    v_accvgpr_read_b32 v45, a77
    v_accvgpr_read_b32 v46, a78
    v_accvgpr_read_b32 v47, a79
    v_cvt_pk_bf16_f32 v52, v40, v41
    v_cvt_pk_bf16_f32 v53, v42, v43
    v_cvt_pk_bf16_f32 v54, v44, v45
    v_cvt_pk_bf16_f32 v55, v46, v47
    v_xor_b32 v3, 80, v0
    ds_write_b128 v3, v[52:55]
    v_mfma_f32_32x32x16_bf16 v[96:111], a[24:27], v[136:139], v[96:111]
    ds_read_b64_tr_b16 a[8:9], v14 offset:0
    ds_read_b64_tr_b16 a[10:11], v14 offset:512
    v_add3_u32 v56, v52, v53, v56
    v_add3_u32 v56, v54, v55, v56
    v_lshrrev_b32 v3, 3, v1
    v_xor_b32 v0, v3, v1
    v_and_b32 v0, 7, v0
    v_lshlrev_b32 v0, 4, v0
    v_lshl_add_u32 v0, v3, 7, v0
    v_add_u32 v0, s5, v0
    v_lshlrev_b32 v3, 13, v3
    v_and_b32 v40, 0x70, v2
    v_mfma_f32_32x32x16_bf16 v[112:127], a[28:31], v[136:139], v[112:127]
    ds_read_b64_tr_b16 a[12:13], v15 offset:0
    ds_read_b64_tr_b16 a[14:15], v15 offset:512
    v_add_u32 v3, v3, v40
    s_lshl_b32 s5, s44, 19
    s_lshl_b32 s53, s45, 7
    s_add_u32 s5, s5, s53
    s_waitcnt lgkmcnt(14)
    v_mfma_f32_16x16x32_bf16 v[20:23], a[248:251], a[32:35], v[20:23]
    s_waitcnt lgkmcnt(10)
    v_mfma_f32_32x32x16_bf16 v[64:79], a[32:35], v[140:143], v[64:79]
    ds_read_b64_tr_b16 a[16:17], v12 offset:2048
    ds_read_b64_tr_b16 a[18:19], v12 offset:2560
    s_waitcnt lgkmcnt(6)
    ds_read_b128 a[48:51], v0 offset:0
    ds_read_b128 a[52:55], v0 offset:1024
    ds_read_b128 a[56:59], v0 offset:2048
    ds_read_b128 a[60:63], v0 offset:3072
    ds_read_b128 a[64:67], v0 offset:4096
    ds_read_b128 a[68:71], v0 offset:5120
    ds_read_b128 a[72:75], v0 offset:6144
    ds_read_b128 a[76:79], v0 offset:7168
    v_mfma_f32_32x32x16_bf16 v[80:95], a[36:39], v[140:143], v[80:95]
    ds_read_b64_tr_b16 a[20:21], v13 offset:2048
    ds_read_b64_tr_b16 a[22:23], v13 offset:2560
    v_mfma_f32_32x32x16_bf16 v[96:111], a[40:43], v[140:143], v[96:111]
    ds_read_b64_tr_b16 a[24:25], v14 offset:2048
    ds_read_b64_tr_b16 a[26:27], v14 offset:2560
    v_mfma_f32_32x32x16_bf16 v[112:127], a[44:47], v[140:143], v[112:127]
    ds_read_b64_tr_b16 a[28:29], v15 offset:2048
    ds_read_b64_tr_b16 a[30:31], v15 offset:2560
    v_mfma_f32_16x16x32_bf16 v[20:23], a[248:251], a[0:3], v[20:23]
    s_waitcnt lgkmcnt(14)
    v_mfma_f32_32x32x16_bf16 v[64:79], a[0:3], v[144:147], v[64:79]
    ds_read_b64_tr_b16 a[32:33], v12 offset:4096
    ds_read_b64_tr_b16 a[34:35], v12 offset:4608
    s_add_u32 m0, s50, 65536
    s_add_u32 s51, s57, 917504
    buffer_load_dwordx4 v4, s[12:15], s51 offen offset:0 lds
    s_lshl_b32 s52, s44, 6
    s_add_u32 s52, s52, s45
    s_lshl_b32 s52, s52, 8
    s_add_u32 s52, s52, 0xd00000
    v_lshlrev_b32 v40, 2, v1
    v_mov_b32 v24, v3
    v_sub_u32 v56, s60, v56
    buffer_store_dword v56, v40, s[32:35], s52 offen sc1
    s_waitcnt lgkmcnt(8)
    s_add_u32 s52, s5, 0x800000
    buffer_store_dwordx4 a[48:51], v24, s[32:35], s52 offen sc1
    s_add_u32 s52, s5, 0x810000
    buffer_store_dwordx4 a[52:55], v24, s[32:35], s52 offen sc1
    v_mfma_f32_32x32x16_bf16 v[80:95], a[4:7], v[144:147], v[80:95]
    ds_read_b64_tr_b16 a[36:37], v13 offset:4096
    ds_read_b64_tr_b16 a[38:39], v13 offset:4608
    v_lshrrev_b32 v40, 4, v1
    s_lshl_b32 s53, s40, 2
    v_add_u32 v40, s53, v40
    v_lshlrev_b32 v40, 7, v40
    v_mfma_f32_32x32x16_bf16 v[96:111], a[8:11], v[144:147], v[96:111]
    ds_read_b64_tr_b16 a[40:41], v14 offset:4096
    ds_read_b64_tr_b16 a[42:43], v14 offset:4608
    buffer_load_dwordx4 v5, s[12:15], s51 offen offset:1024 lds
    v_add_u32 v40, s49, v40
    v_mfma_f32_32x32x16_bf16 v[112:127], a[12:15], v[144:147], v[112:127]
    ds_read_b64_tr_b16 a[44:45], v15 offset:4096
    ds_read_b64_tr_b16 a[46:47], v15 offset:4608
    s_waitcnt vmcnt(9)
    ds_read_b64_tr_b16 a[200:201], v62 offset:32768
    v_mul_u32_u24 v40, 514, v40
    v_and_b32 v41, 15, v1
    v_mfma_f32_16x16x32_bf16 v[20:23], a[248:251], a[16:19], v[20:23]
    v_lshl_add_u32 v40, v41, 2, v40
    s_lshl_b32 s53, s48, 6
    s_waitcnt lgkmcnt(9)
    v_mfma_f32_32x32x16_bf16 v[64:79], a[16:19], v[148:151], v[64:79]
    ds_read_b64_tr_b16 a[0:1], v12 offset:6144
    ds_read_b64_tr_b16 a[2:3], v12 offset:6656
    buffer_load_dwordx4 v6, s[12:15], s51 offen offset:2048 lds
    ds_read_b64_tr_b16 a[202:203], v62 offset:33792
    v_mfma_f32_32x32x16_bf16 v[80:95], a[20:23], v[148:151], v[80:95]
    ds_read_b64_tr_b16 a[4:5], v13 offset:6144
    ds_read_b64_tr_b16 a[6:7], v13 offset:6656
    ds_read_b64_tr_b16 a[204:205], v63 offset:32768
    v_add_u32 v57, s53, v40
    s_mov_b32 s90, 16448
    s_mov_b32 s91, 32896
    v_mfma_f32_32x32x16_bf16 v[96:111], a[24:27], v[148:151], v[96:111]
    ds_read_b64_tr_b16 a[8:9], v14 offset:6144
    ds_read_b64_tr_b16 a[10:11], v14 offset:6656
    buffer_load_dwordx4 v7, s[12:15], s51 offen offset:3072 lds
    ds_read_b64_tr_b16 a[206:207], v63 offset:33792
    v_mfma_f32_32x32x16_bf16 v[112:127], a[28:31], v[148:151], v[112:127]
    ds_read_b64_tr_b16 a[12:13], v15 offset:6144
    ds_read_b64_tr_b16 a[14:15], v15 offset:6656
    ds_read_b64_tr_b16 a[208:209], v62 offset:34816
    s_mov_b32 s92, 49344
    buffer_load_dword v128, v57, s[20:23], 0 offen offset:2
    s_waitcnt lgkmcnt(14)
    v_mfma_f32_16x16x32_bf16 v[20:23], a[248:251], a[32:35], v[20:23]
    buffer_load_dword v129, v57, s[24:27], 0 offen offset:2
    s_waitcnt lgkmcnt(13)
    v_mfma_f32_32x32x16_bf16 v[64:79], a[32:35], v[152:155], v[64:79]
    s_barrier
    v_add_u32 v12, 0xfffe0000, v12
    v_add_u32 v13, 0xfffe0000, v13
    v_add_u32 v14, 0xfffe0000, v14
    v_add_u32 v15, 0xfffe0000, v15
    ds_read_b64_tr_b16 a[16:17], v12 offset:0
    ds_read_b64_tr_b16 a[18:19], v12 offset:512
    s_add_u32 s52, s5, 0x820000
    buffer_store_dwordx4 a[56:59], v24, s[32:35], s52 offen sc1
    v_mfma_f32_32x32x16_bf16 v[80:95], a[36:39], v[152:155], v[80:95]
    ds_read_b64_tr_b16 a[20:21], v13 offset:0
    ds_read_b64_tr_b16 a[22:23], v13 offset:512
    ds_read_b64_tr_b16 a[210:211], v62 offset:35840
    buffer_load_dword v130, v57, s[20:23], s90 offen offset:2
    v_mfma_f32_32x32x16_bf16 v[96:111], a[40:43], v[152:155], v[96:111]
    ds_read_b64_tr_b16 a[24:25], v14 offset:0
    ds_read_b64_tr_b16 a[26:27], v14 offset:512
    s_add_u32 s52, s5, 0x830000
    buffer_store_dwordx4 a[60:63], v24, s[32:35], s52 offen sc1
    v_mfma_f32_32x32x16_bf16 v[112:127], a[44:47], v[152:155], v[112:127]
    ds_read_b64_tr_b16 a[28:29], v15 offset:0
    ds_read_b64_tr_b16 a[30:31], v15 offset:512
    ds_read_b64_tr_b16 a[212:213], v63 offset:34816
    buffer_load_dword v131, v57, s[24:27], s90 offen offset:2
    s_waitcnt lgkmcnt(14)
    v_mfma_f32_16x16x32_bf16 v[20:23], a[248:251], a[0:3], v[20:23]
    buffer_load_dword v132, v57, s[20:23], s91 offen offset:2
    s_waitcnt lgkmcnt(11)
    v_mfma_f32_32x32x16_bf16 v[64:79], a[0:3], v[156:159], v[64:79]
    ds_read_b64_tr_b16 a[32:33], v12 offset:2048
    ds_read_b64_tr_b16 a[34:35], v12 offset:2560
    ds_read_b64_tr_b16 a[214:215], v63 offset:35840
    buffer_load_dword v133, v57, s[24:27], s91 offen offset:2
    v_mfma_f32_32x32x16_bf16 v[80:95], a[4:7], v[156:159], v[80:95]
    ds_read_b64_tr_b16 a[36:37], v13 offset:2048
    ds_read_b64_tr_b16 a[38:39], v13 offset:2560
    buffer_load_dword v134, v57, s[20:23], s92 offen offset:2
    v_mfma_f32_32x32x16_bf16 v[96:111], a[8:11], v[156:159], v[96:111]
    ds_read_b64_tr_b16 a[40:41], v14 offset:2048
    ds_read_b64_tr_b16 a[42:43], v14 offset:2560
    buffer_load_dword v135, v57, s[24:27], s92 offen offset:2
    s_lshl_b32 s53, s46, 1
    v_mfma_f32_32x32x16_bf16 v[112:127], a[12:15], v[156:159], v[112:127]
    ds_read_b64_tr_b16 a[44:45], v15 offset:2048
    ds_read_b64_tr_b16 a[46:47], v15 offset:2560
    s_lshr_b32 s54, s40, 1
    s_add_u32 s53, s53, s54
    s_lshl_b32 s63, s53, 15
    s_add_u32 s63, s63, s50
    s_waitcnt lgkmcnt(14)
    v_mfma_f32_16x16x32_bf16 v[20:23], a[248:251], a[16:19], v[20:23]
    v_lshlrev_b32 v40, 2, v1
    s_lshr_b32 s53, s63, 15
    s_waitcnt lgkmcnt(10)
    v_mfma_f32_32x32x16_bf16 v[64:79], a[16:19], v[160:163], v[64:79]
    ds_read_b64_tr_b16 a[0:1], v12 offset:4096
    ds_read_b64_tr_b16 a[2:3], v12 offset:4608
    s_waitcnt lgkmcnt(8)
    s_xor_b32 s53, s53, 0
    s_lshl_b32 s53, s53, 2
    s_add_u32 s53, s53, s40
    v_mfma_f32_32x32x16_bf16 v[80:95], a[20:23], v[160:163], v[80:95]
    ds_read_b64_tr_b16 a[4:5], v13 offset:4096
    ds_read_b64_tr_b16 a[6:7], v13 offset:4608
    s_mul_i32 s54, s53, 28672
    v_add_u32 v16, s54, v2
    s_mul_i32 s54, s53, 1792
    s_add_u32 s54, s54, 0xc80000
    v_mfma_f32_32x32x16_bf16 v[96:111], a[24:27], v[160:163], v[96:111]
    ds_read_b64_tr_b16 a[8:9], v14 offset:4096
    ds_read_b64_tr_b16 a[10:11], v14 offset:4608
    s_add_u32 s52, s5, 0x840000
    buffer_store_dwordx4 a[64:67], v24, s[32:35], s52 offen sc1
    v_mfma_f32_32x32x16_bf16 v[112:127], a[28:31], v[160:163], v[112:127]
    ds_read_b64_tr_b16 a[12:13], v15 offset:4096
    ds_read_b64_tr_b16 a[14:15], v15 offset:4608
    v_add_u32 v18, s54, v40
    s_lshr_b32 s53, s63, 15
    s_xor_b32 s53, s53, 1
    s_lshl_b32 s53, s53, 2
    v_mfma_f32_16x16x32_bf16 v[20:23], a[248:251], a[32:35], v[20:23]
    s_add_u32 s53, s53, s40
    s_mul_i32 s54, s53, 28672
    s_waitcnt lgkmcnt(8)
    v_mfma_f32_32x32x16_bf16 v[64:79], a[32:35], v[164:167], v[64:79]
    ds_read_b64_tr_b16 a[16:17], v12 offset:6144
    ds_read_b64_tr_b16 a[18:19], v12 offset:6656
    s_add_u32 s52, s5, 0x850000
    buffer_store_dwordx4 a[68:71], v24, s[32:35], s52 offen sc1
    v_mfma_f32_32x32x16_bf16 v[80:95], a[36:39], v[164:167], v[80:95]
    ds_read_b64_tr_b16 a[20:21], v13 offset:6144
    ds_read_b64_tr_b16 a[22:23], v13 offset:6656
    v_add_u32 v17, s54, v2
    s_mul_i32 s54, s53, 1792
    s_add_u32 s54, s54, 0xc80000
    v_add_u32 v19, s54, v40
    v_mfma_f32_32x32x16_bf16 v[96:111], a[40:43], v[164:167], v[96:111]
    ds_read_b64_tr_b16 a[24:25], v14 offset:6144
    ds_read_b64_tr_b16 a[26:27], v14 offset:6656
    s_add_u32 s52, s5, 0x860000
    buffer_store_dwordx4 a[72:75], v24, s[32:35], s52 offen sc1
    v_mfma_f32_32x32x16_bf16 v[112:127], a[44:47], v[164:167], v[112:127]
    ds_read_b64_tr_b16 a[28:29], v15 offset:6144
    ds_read_b64_tr_b16 a[30:31], v15 offset:6656
    v_lshrrev_b32 v40, 3, v1
    v_lshlrev_b32 v40, 7, v40
    v_bfe_u32 v41, v1, 4, 1
    v_lshlrev_b32 v41, 5, v41
    s_waitcnt lgkmcnt(14)
    v_mfma_f32_16x16x32_bf16 v[20:23], a[248:251], a[0:3], v[20:23]
    v_and_b32 v42, 0x70, v2
    v_xor_b32 v41, v41, v42
    s_waitcnt lgkmcnt(8)
    v_mfma_f32_32x32x16_bf16 v[64:79], a[0:3], v[168:171], v[64:79]
    s_add_u32 s52, s5, 0x870000
    buffer_store_dwordx4 a[76:79], v24, s[32:35], s52 offen sc1
    s_waitcnt vmcnt(21)
    s_barrier
    ds_read_b64_tr_b16 a[32:33], v12 offset:49152
    ds_read_b64_tr_b16 a[34:35], v12 offset:49664
    v_mfma_f32_32x32x16_bf16 v[80:95], a[4:7], v[168:171], v[80:95]
    ds_read_b64_tr_b16 a[36:37], v13 offset:49152
    ds_read_b64_tr_b16 a[38:39], v13 offset:49664
    v_add_u32 v36, v40, v41
    v_xor_b32 v37, 64, v36
    v_and_b32 v35, 0x3c, v1
    v_lshlrev_b32 v35, 6, v35
    v_mfma_f32_32x32x16_bf16 v[96:111], a[8:11], v[168:171], v[96:111]
    ds_read_b64_tr_b16 a[40:41], v14 offset:49152
    ds_read_b64_tr_b16 a[42:43], v14 offset:49664
    s_add_u32 m0, s50, 16384
    s_add_u32 s51, s57, 1146880
    buffer_load_dwordx4 v4, s[12:15], s51 offen offset:0 lds
    v_mfma_f32_32x32x16_bf16 v[112:127], a[12:15], v[168:171], v[112:127]
    ds_read_b64_tr_b16 a[44:45], v15 offset:49152
    ds_read_b64_tr_b16 a[46:47], v15 offset:49664
    s_lshr_b32 s53, s48, 1
    s_lshl_b32 s53, s53, 14
    s_add_u32 s53, s53, s50
    s_and_b32 s54, s48, 1
    s_waitcnt lgkmcnt(14)
    v_mfma_f32_16x16x32_bf16 v[20:23], a[248:251], a[16:19], v[20:23]
    s_lshl_b32 s54, s54, 5
    s_add_u32 s54, s54, s49
    s_waitcnt lgkmcnt(8)
    v_mfma_f32_32x32x16_bf16 v[64:79], a[16:19], v[172:175], v[64:79]
    ds_read_b64_tr_b16 a[0:1], v12 offset:51200
    ds_read_b64_tr_b16 a[2:3], v12 offset:51712
    s_lshl_b32 s54, s54, 2
    s_add_u32 s53, s53, s54
    s_add_u32 s53, s53, 0xd00000
    v_add_u32 v35, s53, v35
    v_mfma_f32_32x32x16_bf16 v[80:95], a[20:23], v[172:175], v[80:95]
    ds_read_b64_tr_b16 a[4:5], v13 offset:51200
    ds_read_b64_tr_b16 a[6:7], v13 offset:51712
    v_mfma_f32_32x32x16_bf16 v[96:111], a[24:27], v[172:175], v[96:111]
    ds_read_b64_tr_b16 a[8:9], v14 offset:51200
    ds_read_b64_tr_b16 a[10:11], v14 offset:51712
    v_mfma_f32_32x32x16_bf16 v[112:127], a[28:31], v[172:175], v[112:127]
    ds_read_b64_tr_b16 a[12:13], v15 offset:51200
    ds_read_b64_tr_b16 a[14:15], v15 offset:51712
    buffer_load_dwordx4 v5, s[12:15], s51 offen offset:1024 lds
    s_waitcnt lgkmcnt(14)
    v_mfma_f32_16x16x32_bf16 v[20:23], a[248:251], a[32:35], v[20:23]
    s_waitcnt lgkmcnt(8)
    v_mfma_f32_32x32x16_bf16 v[64:79], a[32:35], v[176:179], v[64:79]
    ds_read_b64_tr_b16 a[16:17], v12 offset:53248
    ds_read_b64_tr_b16 a[18:19], v12 offset:53760
    v_mfma_f32_32x32x16_bf16 v[80:95], a[36:39], v[176:179], v[80:95]
    ds_read_b64_tr_b16 a[20:21], v13 offset:53248
    ds_read_b64_tr_b16 a[22:23], v13 offset:53760
    buffer_load_dwordx4 v6, s[12:15], s51 offen offset:2048 lds
    v_mfma_f32_32x32x16_bf16 v[96:111], a[40:43], v[176:179], v[96:111]
    ds_read_b64_tr_b16 a[24:25], v14 offset:53248
    ds_read_b64_tr_b16 a[26:27], v14 offset:53760
    v_mfma_f32_32x32x16_bf16 v[112:127], a[44:47], v[176:179], v[112:127]
    ds_read_b64_tr_b16 a[28:29], v15 offset:53248
    ds_read_b64_tr_b16 a[30:31], v15 offset:53760
    s_waitcnt lgkmcnt(14)
    v_mfma_f32_16x16x32_bf16 v[20:23], a[248:251], a[0:3], v[20:23]
    s_waitcnt lgkmcnt(8)
    v_mfma_f32_32x32x16_bf16 v[64:79], a[0:3], v[180:183], v[64:79]
    ds_read_b64_tr_b16 a[32:33], v12 offset:55296
    ds_read_b64_tr_b16 a[34:35], v12 offset:55808
    v_mfma_f32_32x32x16_bf16 v[80:95], a[4:7], v[180:183], v[80:95]
    ds_read_b64_tr_b16 a[36:37], v13 offset:55296
    ds_read_b64_tr_b16 a[38:39], v13 offset:55808
    buffer_load_dwordx4 v7, s[12:15], s51 offen offset:3072 lds
    v_mfma_f32_32x32x16_bf16 v[96:111], a[8:11], v[180:183], v[96:111]
    ds_read_b64_tr_b16 a[40:41], v14 offset:55296
    ds_read_b64_tr_b16 a[42:43], v14 offset:55808
    v_mfma_f32_32x32x16_bf16 v[112:127], a[12:15], v[180:183], v[112:127]
    ds_read_b64_tr_b16 a[44:45], v15 offset:55296
    ds_read_b64_tr_b16 a[46:47], v15 offset:55808
    s_add_u32 m0, s50, 114688
    s_add_u32 s51, s57, 1376256
    buffer_load_dwordx4 v4, s[12:15], s51 offen offset:0 lds
    s_waitcnt lgkmcnt(14)
    v_mfma_f32_16x16x32_bf16 v[20:23], a[248:251], a[16:19], v[20:23]
    s_waitcnt lgkmcnt(8)
    v_mfma_f32_32x32x16_bf16 v[64:79], a[16:19], v[184:187], v[64:79]
    s_waitcnt vmcnt(19)
    s_barrier
    v_add_u32 v12, 0x10000, v12
    v_add_u32 v13, 0x10000, v13
    v_add_u32 v14, 0x10000, v14
    v_add_u32 v15, 0x10000, v15
    ds_read_b64_tr_b16 a[0:1], v12 offset:0
    ds_read_b64_tr_b16 a[2:3], v12 offset:512
    buffer_load_dwordx4 v5, s[12:15], s51 offen offset:1024 lds
    v_mfma_f32_32x32x16_bf16 v[80:95], a[20:23], v[184:187], v[80:95]
    ds_read_b64_tr_b16 a[4:5], v13 offset:0
    ds_read_b64_tr_b16 a[6:7], v13 offset:512
    v_mfma_f32_32x32x16_bf16 v[96:111], a[24:27], v[184:187], v[96:111]
    ds_read_b64_tr_b16 a[8:9], v14 offset:0
    ds_read_b64_tr_b16 a[10:11], v14 offset:512
    buffer_load_dwordx4 v6, s[12:15], s51 offen offset:2048 lds
    v_mfma_f32_32x32x16_bf16 v[112:127], a[28:31], v[184:187], v[112:127]
    ds_read_b64_tr_b16 a[12:13], v15 offset:0
    ds_read_b64_tr_b16 a[14:15], v15 offset:512
    s_waitcnt lgkmcnt(14)
    v_mfma_f32_16x16x32_bf16 v[20:23], a[248:251], a[32:35], v[20:23]
    s_waitcnt lgkmcnt(8)
    v_mfma_f32_32x32x16_bf16 v[64:79], a[32:35], v[188:191], v[64:79]
    ds_read_b64_tr_b16 a[16:17], v12 offset:2048
    ds_read_b64_tr_b16 a[18:19], v12 offset:2560
    buffer_load_dwordx4 v7, s[12:15], s51 offen offset:3072 lds
    v_mfma_f32_32x32x16_bf16 v[80:95], a[36:39], v[188:191], v[80:95]
    ds_read_b64_tr_b16 a[20:21], v13 offset:2048
    ds_read_b64_tr_b16 a[22:23], v13 offset:2560
    v_mfma_f32_32x32x16_bf16 v[96:111], a[40:43], v[188:191], v[96:111]
    ds_read_b64_tr_b16 a[24:25], v14 offset:2048
    ds_read_b64_tr_b16 a[26:27], v14 offset:2560
    v_mfma_f32_32x32x16_bf16 v[112:127], a[44:47], v[188:191], v[112:127]
    ds_read_b64_tr_b16 a[28:29], v15 offset:2048
    ds_read_b64_tr_b16 a[30:31], v15 offset:2560
    s_waitcnt lgkmcnt(14)
    v_mfma_f32_16x16x32_bf16 v[20:23], a[248:251], a[0:3], v[20:23]
    s_waitcnt lgkmcnt(8)
    v_mfma_f32_32x32x16_bf16 v[64:79], a[0:3], v[192:195], v[64:79]
    ds_read_b64_tr_b16 a[32:33], v12 offset:4096
    ds_read_b64_tr_b16 a[34:35], v12 offset:4608
    s_add_u32 m0, s50, 81920
    s_add_u32 s51, s57, 1605632
    buffer_load_dwordx4 v4, s[12:15], s51 offen offset:0 lds
    v_mfma_f32_32x32x16_bf16 v[80:95], a[4:7], v[192:195], v[80:95]
    ds_read_b64_tr_b16 a[36:37], v13 offset:4096
    ds_read_b64_tr_b16 a[38:39], v13 offset:4608
    v_mfma_f32_32x32x16_bf16 v[96:111], a[8:11], v[192:195], v[96:111]
    ds_read_b64_tr_b16 a[40:41], v14 offset:4096
    ds_read_b64_tr_b16 a[42:43], v14 offset:4608
    v_mfma_f32_32x32x16_bf16 v[112:127], a[12:15], v[192:195], v[112:127]
    ds_read_b64_tr_b16 a[44:45], v15 offset:4096
    ds_read_b64_tr_b16 a[46:47], v15 offset:4608
    s_waitcnt lgkmcnt(14)
    v_mfma_f32_16x16x32_bf16 v[20:23], a[248:251], a[16:19], v[20:23]
    s_waitcnt lgkmcnt(8)
    v_mfma_f32_32x32x16_bf16 v[64:79], a[16:19], v[196:199], v[64:79]
    ds_read_b64_tr_b16 a[0:1], v12 offset:6144
    ds_read_b64_tr_b16 a[2:3], v12 offset:6656
    v_mfma_f32_32x32x16_bf16 v[80:95], a[20:23], v[196:199], v[80:95]
    ds_read_b64_tr_b16 a[4:5], v13 offset:6144
    ds_read_b64_tr_b16 a[6:7], v13 offset:6656
    buffer_load_dwordx4 v5, s[12:15], s51 offen offset:1024 lds
    v_mfma_f32_32x32x16_bf16 v[96:111], a[24:27], v[196:199], v[96:111]
    ds_read_b64_tr_b16 a[8:9], v14 offset:6144
    ds_read_b64_tr_b16 a[10:11], v14 offset:6656
    v_mfma_f32_32x32x16_bf16 v[112:127], a[28:31], v[196:199], v[112:127]
    ds_read_b64_tr_b16 a[12:13], v15 offset:6144
    ds_read_b64_tr_b16 a[14:15], v15 offset:6656
    s_waitcnt lgkmcnt(14)
    v_mfma_f32_16x16x32_bf16 v[20:23], a[248:251], a[32:35], v[20:23]
    s_waitcnt lgkmcnt(8)
    v_mfma_f32_32x32x16_bf16 v[64:79], a[32:35], v[200:203], v[64:79]
    buffer_load_dwordx4 v6, s[12:15], s51 offen offset:2048 lds
    buffer_load_dwordx4 v7, s[12:15], s51 offen offset:3072 lds
    s_add_u32 m0, s50, 98304
    s_lshl_b32 s51, s65, 4
    s_add_u32 s51, s51, s59
    buffer_load_dwordx4 v8, s[16:19], s51 offen offset:0 lds
    buffer_load_dwordx4 v9, s[16:19], s51 offen offset:1024 lds
    s_waitcnt vmcnt(10)
    s_barrier
    v_add_u32 v12, 0xffff0000, v12
    v_add_u32 v13, 0xffff0000, v13
    v_add_u32 v14, 0xffff0000, v14
    v_add_u32 v15, 0xffff0000, v15
    ds_read_b64_tr_b16 a[16:17], v12 offset:16384
    ds_read_b64_tr_b16 a[18:19], v12 offset:16896
    buffer_load_dwordx4 v10, s[16:19], s51 offen offset:2048 lds
    v_mfma_f32_32x32x16_bf16 v[80:95], a[36:39], v[200:203], v[80:95]
    ds_read_b64_tr_b16 a[20:21], v13 offset:16384
    ds_read_b64_tr_b16 a[22:23], v13 offset:16896
    v_mfma_f32_32x32x16_bf16 v[96:111], a[40:43], v[200:203], v[96:111]
    ds_read_b64_tr_b16 a[24:25], v14 offset:16384
    ds_read_b64_tr_b16 a[26:27], v14 offset:16896
    buffer_load_dwordx4 v11, s[16:19], s51 offen offset:3072 lds
    v_mfma_f32_32x32x16_bf16 v[112:127], a[44:47], v[200:203], v[112:127]
    ds_read_b64_tr_b16 a[28:29], v15 offset:16384
    ds_read_b64_tr_b16 a[30:31], v15 offset:16896
    s_waitcnt lgkmcnt(14)
    v_mfma_f32_16x16x32_bf16 v[20:23], a[248:251], a[0:3], v[20:23]
    s_waitcnt lgkmcnt(8)
    v_mfma_f32_32x32x16_bf16 v[64:79], a[0:3], v[204:207], v[64:79]
    ds_read_b64_tr_b16 a[32:33], v12 offset:18432
    ds_read_b64_tr_b16 a[34:35], v12 offset:18944
    s_add_u32 m0, s50, 32768
    s_lshl_b32 s51, s65, 4
    s_add_u32 s51, s51, s59
    s_add_u32 s51, s51, 32768
    buffer_load_dwordx4 v8, s[16:19], s51 offen offset:0 lds
    v_mfma_f32_32x32x16_bf16 v[80:95], a[4:7], v[204:207], v[80:95]
    ds_read_b64_tr_b16 a[36:37], v13 offset:18432
    ds_read_b64_tr_b16 a[38:39], v13 offset:18944
    v_mfma_f32_32x32x16_bf16 v[96:111], a[8:11], v[204:207], v[96:111]
    ds_read_b64_tr_b16 a[40:41], v14 offset:18432
    ds_read_b64_tr_b16 a[42:43], v14 offset:18944
    buffer_load_dwordx4 v9, s[16:19], s51 offen offset:1024 lds
    v_mfma_f32_32x32x16_bf16 v[112:127], a[12:15], v[204:207], v[112:127]
    ds_read_b64_tr_b16 a[44:45], v15 offset:18432
    ds_read_b64_tr_b16 a[46:47], v15 offset:18944
    s_waitcnt lgkmcnt(14)
    v_mfma_f32_16x16x32_bf16 v[20:23], a[248:251], a[16:19], v[20:23]
    s_waitcnt lgkmcnt(8)
    v_mfma_f32_32x32x16_bf16 v[64:79], a[16:19], v[208:211], v[64:79]
    ds_read_b64_tr_b16 a[0:1], v12 offset:20480
    ds_read_b64_tr_b16 a[2:3], v12 offset:20992
    buffer_load_dwordx4 v10, s[16:19], s51 offen offset:2048 lds
    v_mfma_f32_32x32x16_bf16 v[80:95], a[20:23], v[208:211], v[80:95]
    ds_read_b64_tr_b16 a[4:5], v13 offset:20480
    ds_read_b64_tr_b16 a[6:7], v13 offset:20992
    v_mfma_f32_32x32x16_bf16 v[96:111], a[24:27], v[208:211], v[96:111]
    ds_read_b64_tr_b16 a[8:9], v14 offset:20480
    ds_read_b64_tr_b16 a[10:11], v14 offset:20992
    buffer_load_dwordx4 v11, s[16:19], s51 offen offset:3072 lds
    v_mfma_f32_32x32x16_bf16 v[112:127], a[28:31], v[208:211], v[112:127]
    ds_read_b64_tr_b16 a[12:13], v15 offset:20480
    ds_read_b64_tr_b16 a[14:15], v15 offset:20992
    s_waitcnt lgkmcnt(14)
    v_mfma_f32_16x16x32_bf16 v[20:23], a[248:251], a[32:35], v[20:23]
    s_waitcnt lgkmcnt(8)
    v_mfma_f32_32x32x16_bf16 v[64:79], a[32:35], v[212:215], v[64:79]
    ds_read_b64_tr_b16 a[16:17], v12 offset:22528
    ds_read_b64_tr_b16 a[18:19], v12 offset:23040
    s_add_u32 m0, s50, 131072
    s_lshl_b32 s51, s66, 4
    s_add_u32 s51, s51, s59
    buffer_load_dwordx4 v8, s[16:19], s51 offen offset:0 lds
    v_mfma_f32_32x32x16_bf16 v[80:95], a[36:39], v[212:215], v[80:95]
    ds_read_b64_tr_b16 a[20:21], v13 offset:22528
    ds_read_b64_tr_b16 a[22:23], v13 offset:23040
    v_mfma_f32_32x32x16_bf16 v[96:111], a[40:43], v[212:215], v[96:111]
    ds_read_b64_tr_b16 a[24:25], v14 offset:22528
    ds_read_b64_tr_b16 a[26:27], v14 offset:23040
    buffer_load_dwordx4 v9, s[16:19], s51 offen offset:1024 lds
    v_mfma_f32_32x32x16_bf16 v[112:127], a[44:47], v[212:215], v[112:127]
    ds_read_b64_tr_b16 a[28:29], v15 offset:22528
    ds_read_b64_tr_b16 a[30:31], v15 offset:23040
    s_waitcnt lgkmcnt(14)
    v_mfma_f32_16x16x32_bf16 v[20:23], a[248:251], a[0:3], v[20:23]
    s_waitcnt lgkmcnt(8)
    v_mfma_f32_32x32x16_bf16 v[64:79], a[0:3], v[216:219], v[64:79]
    buffer_load_dwordx4 v10, s[16:19], s51 offen offset:2048 lds
    s_waitcnt vmcnt(15)
    s_barrier
    v_add_u32 v12, 0x10000, v12
    v_add_u32 v13, 0x10000, v13
    v_add_u32 v14, 0x10000, v14
    v_add_u32 v15, 0x10000, v15
    ds_read_b64_tr_b16 a[32:33], v12 offset:49152
    ds_read_b64_tr_b16 a[34:35], v12 offset:49664
    v_mfma_f32_32x32x16_bf16 v[80:95], a[4:7], v[216:219], v[80:95]
    ds_read_b64_tr_b16 a[36:37], v13 offset:49152
    ds_read_b64_tr_b16 a[38:39], v13 offset:49664
    buffer_load_dwordx4 v11, s[16:19], s51 offen offset:3072 lds
    v_mfma_f32_32x32x16_bf16 v[96:111], a[8:11], v[216:219], v[96:111]
    ds_read_b64_tr_b16 a[40:41], v14 offset:49152
    ds_read_b64_tr_b16 a[42:43], v14 offset:49664
    v_mfma_f32_32x32x16_bf16 v[112:127], a[12:15], v[216:219], v[112:127]
    ds_read_b64_tr_b16 a[44:45], v15 offset:49152
    ds_read_b64_tr_b16 a[46:47], v15 offset:49664
    s_add_u32 m0, s50, 0
    s_lshl_b32 s51, s66, 4
    s_add_u32 s51, s51, s59
    s_add_u32 s51, s51, 32768
    buffer_load_dwordx4 v8, s[16:19], s51 offen offset:0 lds
    s_waitcnt lgkmcnt(14)
    v_mfma_f32_16x16x32_bf16 v[20:23], a[248:251], a[16:19], v[20:23]
    s_waitcnt lgkmcnt(8)
    v_mfma_f32_32x32x16_bf16 v[64:79], a[16:19], v[220:223], v[64:79]
    ds_read_b64_tr_b16 a[0:1], v12 offset:51200
    ds_read_b64_tr_b16 a[2:3], v12 offset:51712
    v_mfma_f32_32x32x16_bf16 v[80:95], a[20:23], v[220:223], v[80:95]
    ds_read_b64_tr_b16 a[4:5], v13 offset:51200
    ds_read_b64_tr_b16 a[6:7], v13 offset:51712
    buffer_load_dwordx4 v9, s[16:19], s51 offen offset:1024 lds
    v_mfma_f32_32x32x16_bf16 v[96:111], a[24:27], v[220:223], v[96:111]
    ds_read_b64_tr_b16 a[8:9], v14 offset:51200
    ds_read_b64_tr_b16 a[10:11], v14 offset:51712
    v_mfma_f32_32x32x16_bf16 v[112:127], a[28:31], v[220:223], v[112:127]
    ds_read_b64_tr_b16 a[12:13], v15 offset:51200
    ds_read_b64_tr_b16 a[14:15], v15 offset:51712
    buffer_load_dwordx4 v10, s[16:19], s51 offen offset:2048 lds
    s_waitcnt lgkmcnt(14)
    v_mfma_f32_16x16x32_bf16 v[20:23], a[248:251], a[32:35], v[20:23]
    s_waitcnt lgkmcnt(8)
    v_mfma_f32_32x32x16_bf16 v[64:79], a[32:35], v[224:227], v[64:79]
    ds_read_b64_tr_b16 a[16:17], v12 offset:53248
    ds_read_b64_tr_b16 a[18:19], v12 offset:53760
    v_mfma_f32_32x32x16_bf16 v[80:95], a[36:39], v[224:227], v[80:95]
    ds_read_b64_tr_b16 a[20:21], v13 offset:53248
    ds_read_b64_tr_b16 a[22:23], v13 offset:53760
    buffer_load_dwordx4 v11, s[16:19], s51 offen offset:3072 lds
    v_mfma_f32_32x32x16_bf16 v[96:111], a[40:43], v[224:227], v[96:111]
    ds_read_b64_tr_b16 a[24:25], v14 offset:53248
    ds_read_b64_tr_b16 a[26:27], v14 offset:53760
    v_mfma_f32_32x32x16_bf16 v[112:127], a[44:47], v[224:227], v[112:127]
    ds_read_b64_tr_b16 a[28:29], v15 offset:53248
    ds_read_b64_tr_b16 a[30:31], v15 offset:53760
    s_add_u32 m0, s50, 49152
    s_lshl_b32 s51, s67, 4
    s_add_u32 s51, s51, s59
    buffer_load_dwordx4 v8, s[16:19], s51 offen offset:0 lds
    s_waitcnt lgkmcnt(14)
    v_mfma_f32_16x16x32_bf16 v[20:23], a[248:251], a[0:3], v[20:23]
    s_waitcnt lgkmcnt(8)
    v_mfma_f32_32x32x16_bf16 v[64:79], a[0:3], v[228:231], v[64:79]
    ds_read_b64_tr_b16 a[32:33], v12 offset:55296
    ds_read_b64_tr_b16 a[34:35], v12 offset:55808
    s_waitcnt vmcnt(13)
    v_add_u32 v62, 0x10000, v62
    v_add_u32 v63, 0x10000, v63
    ds_read_b64_tr_b16 a[216:217], v62 offset:32768
    v_mfma_f32_32x32x16_bf16 v[80:95], a[4:7], v[228:231], v[80:95]
    ds_read_b64_tr_b16 a[36:37], v13 offset:55296
    ds_read_b64_tr_b16 a[38:39], v13 offset:55808
    buffer_load_dwordx4 v9, s[16:19], s51 offen offset:1024 lds
    ds_read_b64_tr_b16 a[218:219], v62 offset:33792
    v_mfma_f32_32x32x16_bf16 v[96:111], a[8:11], v[228:231], v[96:111]
    ds_read_b64_tr_b16 a[40:41], v14 offset:55296
    ds_read_b64_tr_b16 a[42:43], v14 offset:55808
    ds_read_b64_tr_b16 a[220:221], v63 offset:32768
    v_mfma_f32_32x32x16_bf16 v[112:127], a[12:15], v[228:231], v[112:127]
    ds_read_b64_tr_b16 a[44:45], v15 offset:55296
    ds_read_b64_tr_b16 a[46:47], v15 offset:55808
    buffer_load_dwordx4 v10, s[16:19], s51 offen offset:2048 lds
    ds_read_b64_tr_b16 a[222:223], v63 offset:33792
    s_waitcnt lgkmcnt(14)
    v_mfma_f32_16x16x32_bf16 v[20:23], a[248:251], a[16:19], v[20:23]
    s_waitcnt lgkmcnt(12)
    v_mfma_f32_32x32x16_bf16 v[64:79], a[16:19], v[232:235], v[64:79]
    s_barrier
    ds_read_b64_tr_b16 a[0:1], v12 offset:16384
    ds_read_b64_tr_b16 a[2:3], v12 offset:16896
    buffer_load_dwordx4 v11, s[16:19], s51 offen offset:3072 lds
    v_mfma_f32_32x32x16_bf16 v[80:95], a[20:23], v[232:235], v[80:95]
    s_lshr_b32 s51, s50, 1
    s_add_u32 m0, s51, 147456
    s_lshl_b32 s93, s95, 4
    s_add_u32 s51, s93, 0x800000
    buffer_load_dwordx4 v36, s[32:35], s51 offen offset:0 sc1 lds
    buffer_load_dwordx4 v37, s[32:35], s51 offen offset:1024 sc1 lds
    buffer_load_dword v38, v35, s[32:35], 0 offen sc1
    ds_read_b64_tr_b16 a[4:5], v13 offset:16384
    ds_read_b64_tr_b16 a[6:7], v13 offset:16896
    v_mfma_f32_32x32x16_bf16 v[96:111], a[24:27], v[232:235], v[96:111]
    ds_read_b64_tr_b16 a[8:9], v14 offset:16384
    ds_read_b64_tr_b16 a[10:11], v14 offset:16896
    ds_read_b64_tr_b16 a[224:225], v62 offset:34816
    v_mfma_f32_32x32x16_bf16 v[112:127], a[28:31], v[232:235], v[112:127]
    ds_read_b64_tr_b16 a[12:13], v15 offset:16384
    ds_read_b64_tr_b16 a[14:15], v15 offset:16896
    ds_read_b64_tr_b16 a[226:227], v62 offset:35840
    s_waitcnt lgkmcnt(14)
    v_mfma_f32_16x16x32_bf16 v[20:23], a[248:251], a[32:35], v[20:23]
    s_waitcnt lgkmcnt(11)
    v_mfma_f32_32x32x16_bf16 v[64:79], a[32:35], v[236:239], v[64:79]
    ds_read_b64_tr_b16 a[16:17], v12 offset:18432
    ds_read_b64_tr_b16 a[18:19], v12 offset:18944
    s_add_u32 m0, s50, 65536
    s_lshl_b32 s51, s67, 4
    s_add_u32 s51, s51, s59
    s_add_u32 s51, s51, 32768
    buffer_load_dwordx4 v8, s[16:19], s51 offen offset:0 lds
    v_mfma_f32_32x32x16_bf16 v[80:95], a[36:39], v[236:239], v[80:95]
    ds_read_b64_tr_b16 a[20:21], v13 offset:18432
    ds_read_b64_tr_b16 a[22:23], v13 offset:18944
    ds_read_b64_tr_b16 a[228:229], v63 offset:34816
    v_mfma_f32_32x32x16_bf16 v[96:111], a[40:43], v[236:239], v[96:111]
    ds_read_b64_tr_b16 a[24:25], v14 offset:18432
    ds_read_b64_tr_b16 a[26:27], v14 offset:18944
    buffer_load_dwordx4 v9, s[16:19], s51 offen offset:1024 lds
    ds_read_b64_tr_b16 a[230:231], v63 offset:35840
    v_mfma_f32_32x32x16_bf16 v[112:127], a[44:47], v[236:239], v[112:127]
    ds_read_b64_tr_b16 a[28:29], v15 offset:18432
    ds_read_b64_tr_b16 a[30:31], v15 offset:18944
    s_waitcnt lgkmcnt(14)
    v_mfma_f32_16x16x32_bf16 v[20:23], a[248:251], a[0:3], v[20:23]
    s_waitcnt lgkmcnt(11)
    v_mfma_f32_32x32x16_bf16 v[64:79], a[0:3], v[240:243], v[64:79]
    ds_read_b64_tr_b16 a[32:33], v12 offset:20480
    ds_read_b64_tr_b16 a[34:35], v12 offset:20992
    buffer_load_dwordx4 v10, s[16:19], s51 offen offset:2048 lds
    v_mfma_f32_32x32x16_bf16 v[80:95], a[4:7], v[240:243], v[80:95]
    ds_read_b64_tr_b16 a[36:37], v13 offset:20480
    ds_read_b64_tr_b16 a[38:39], v13 offset:20992
    v_mfma_f32_32x32x16_bf16 v[96:111], a[8:11], v[240:243], v[96:111]
    ds_read_b64_tr_b16 a[40:41], v14 offset:20480
    ds_read_b64_tr_b16 a[42:43], v14 offset:20992
    buffer_load_dwordx4 v11, s[16:19], s51 offen offset:3072 lds
    s_waitcnt lgkmcnt(8)
    v_mfma_f32_32x32x16_bf16 v[112:127], a[12:15], v[240:243], v[112:127]
    ds_read_b64_tr_b16 a[44:45], v15 offset:20480
    ds_read_b64_tr_b16 a[46:47], v15 offset:20992
    v_mfma_f32_16x16x32_bf16 v[20:23], a[248:251], a[16:19], v[20:23]
    s_waitcnt lgkmcnt(8)
    v_mfma_f32_32x32x16_bf16 v[64:79], a[16:19], v[244:247], v[64:79]
    ds_read_b64_tr_b16 a[0:1], v12 offset:22528
    ds_read_b64_tr_b16 a[2:3], v12 offset:23040
    s_add_u32 m0, s50, 16384
    s_lshl_b32 s51, s68, 4
    s_add_u32 s51, s51, s59
    buffer_load_dwordx4 v8, s[16:19], s51 offen offset:0 lds
    v_mfma_f32_32x32x16_bf16 v[80:95], a[20:23], v[244:247], v[80:95]
    ds_read_b64_tr_b16 a[4:5], v13 offset:22528
    ds_read_b64_tr_b16 a[6:7], v13 offset:23040
    v_mfma_f32_32x32x16_bf16 v[96:111], a[24:27], v[244:247], v[96:111]
    ds_read_b64_tr_b16 a[8:9], v14 offset:22528
    ds_read_b64_tr_b16 a[10:11], v14 offset:23040
    buffer_load_dwordx4 v9, s[16:19], s51 offen offset:1024 lds
    v_mfma_f32_32x32x16_bf16 v[112:127], a[28:31], v[244:247], v[112:127]
    ds_read_b64_tr_b16 a[12:13], v15 offset:22528
    ds_read_b64_tr_b16 a[14:15], v15 offset:23040
    s_waitcnt lgkmcnt(14)
    v_mfma_f32_16x16x32_bf16 v[20:23], a[248:251], a[32:35], v[20:23]
    s_waitcnt lgkmcnt(8)
    v_mfma_f32_32x32x16_bf16 v[64:79], a[32:35], v[248:251], v[64:79]
    s_barrier
    buffer_load_dwordx4 v10, s[16:19], s51 offen offset:2048 lds
    v_mfma_f32_32x32x16_bf16 v[80:95], a[36:39], v[248:251], v[80:95]
    v_mfma_f32_32x32x16_bf16 v[96:111], a[40:43], v[248:251], v[96:111]
    buffer_load_dwordx4 v11, s[16:19], s51 offen offset:3072 lds
    v_mfma_f32_32x32x16_bf16 v[112:127], a[44:47], v[248:251], v[112:127]
    s_waitcnt lgkmcnt(6)
    v_mfma_f32_16x16x32_bf16 v[20:23], a[248:251], a[0:3], v[20:23]
    s_waitcnt lgkmcnt(0)
    v_mfma_f32_32x32x16_bf16 v[64:79], a[0:3], v[252:255], v[64:79]
    s_add_u32 m0, s50, 98304
    s_lshl_b32 s51, s68, 4
    s_add_u32 s51, s51, s59
    s_add_u32 s51, s51, 32768
    buffer_load_dwordx4 v8, s[16:19], s51 offen offset:0 lds
    v_mfma_f32_32x32x16_bf16 v[80:95], a[4:7], v[252:255], v[80:95]
    v_mfma_f32_32x32x16_bf16 v[96:111], a[8:11], v[252:255], v[96:111]
    v_cvt_pk_bf16_f32 v56, v20, v20
    v_lshlrev_b32 v56, 16, v56
    v_sub_f32 v57, v20, v56
    v_cvt_pk_bf16_f32 v58, v20, v57
    v_and_b32 v56, 0xffff0000, v58
    v_sub_f32 v57, v57, v56
    v_cvt_pk_bf16_f32 v59, v57, 0
    s_lshl_b32 s93, s40, 9
    s_add_u32 s93, s93, 155648
    v_lshl_add_u32 v0, v1, 3, s93
    ds_write_b64 v0, v[58:59] offset:0
    buffer_load_dwordx4 v9, s[16:19], s51 offen offset:1024 lds
    v_mfma_f32_32x32x16_bf16 v[112:127], a[12:15], v[252:255], v[112:127]
    s_waitcnt lgkmcnt(0)
    s_barrier
    ds_read_b64 v[56:57], v0
    v_xor_b32 v3, 512, v0
    ds_read_b64 v[58:59], v3
    v_xor_b32 v3, 1024, v0
    ds_read_b64 v[60:61], v3
    v_xor_b32 v3, 1536, v0
    ds_read_b64 v[62:63], v3
    s_waitcnt lgkmcnt(0)
    v_mfma_f32_32x32x8_bf16 v[64:79], v[56:57], v[32:33], v[64:79]
    v_mfma_f32_32x32x8_bf16 v[80:95], v[58:59], v[32:33], v[80:95]
    v_mfma_f32_32x32x8_bf16 v[96:111], v[60:61], v[32:33], v[96:111]
    v_mfma_f32_32x32x8_bf16 v[112:127], v[62:63], v[32:33], v[112:127]
    v_lshrrev_b32 v40, 5, v1
    v_bfe_u32 v41, v1, 2, 2
    v_lshlrev_b32 v42, 9, v40
    v_lshl_add_u32 v42, v41, 7, v42
    v_and_b32 v43, 3, v1
    v_lshl_add_u32 v42, v43, 3, v42
    v_add_u32 v42, s50, v42
    v_and_b32 v41, 2, v41
    v_bfe_u32 v43, v1, 4, 1
    v_or_b32 v41, v41, v43
    s_and_b32 s53, s40, 1
    s_lshl_b32 s53, s53, 1
    v_xor_b32 v41, s53, v41
    v_lshl_add_u32 v12, v41, 5, v42
    v_xor_b32 v13, 64, v12
    v_lshrrev_b32 v40, 1, v1
    v_lshlrev_b32 v40, 7, v40
    v_and_b32 v41, 1, v1
    v_lshl_add_u32 v40, v41, 5, v40
    v_add_u32 v14, s50, v40
    s_lshl_b32 s5, s57, 5
    s_add_u32 s5, s5, s55
    v_lshlrev_b32 v22, 2, v1
    v_mul_f32 v64, v64, v34
    v_mul_f32 v65, v65, v34
    v_mul_f32 v66, v66, v34
    v_mul_f32 v67, v67, v34
    v_mul_f32 v68, v68, v34
    v_mul_f32 v69, v69, v34
    v_mul_f32 v70, v70, v34
    v_mul_f32 v71, v71, v34
    v_mul_f32 v72, v64, v72
    v_mul_f32 v73, v65, v73
    v_mul_f32 v74, v66, v74
    v_mul_f32 v75, v67, v75
    v_mul_f32 v76, v68, v76
    v_mul_f32 v77, v69, v77
    v_mul_f32 v78, v70, v78
    v_mul_f32 v79, v71, v79
    v_cvt_pk_bf16_f32 v192, v72, v73
    v_cvt_pk_bf16_f32 v193, v74, v75
    v_cvt_pk_bf16_f32 v194, v76, v77
    buffer_load_dwordx4 v10, s[16:19], s51 offen offset:2048 lds
    v_cvt_pk_bf16_f32 v195, v78, v79
    s_xor_b32 s52, s5, 0
    buffer_store_dwordx4 v[192:195], v2, s[32:35], s52 offen sc1
    v_add3_u32 v20, v192, v193, 0
    v_add3_u32 v20, v194, v195, v20
    v_mul_f32 v80, v80, v34
    v_mul_f32 v81, v81, v34
    v_mul_f32 v82, v82, v34
    v_mul_f32 v83, v83, v34
    v_mul_f32 v84, v84, v34
    v_mul_f32 v85, v85, v34
    v_mul_f32 v86, v86, v34
    v_mul_f32 v87, v87, v34
    v_mul_f32 v88, v80, v88
    v_mul_f32 v89, v81, v89
    v_mul_f32 v90, v82, v90
    v_mul_f32 v91, v83, v91
    v_mul_f32 v92, v84, v92
    v_mul_f32 v93, v85, v93
    v_mul_f32 v94, v86, v94
    v_mul_f32 v95, v87, v95
    v_cvt_pk_bf16_f32 v196, v88, v89
    v_cvt_pk_bf16_f32 v197, v90, v91
    v_cvt_pk_bf16_f32 v198, v92, v93
    buffer_load_dwordx4 v11, s[16:19], s51 offen offset:3072 lds
    v_cvt_pk_bf16_f32 v199, v94, v95
    s_xor_b32 s52, s5, 1024
    buffer_store_dwordx4 v[196:199], v2, s[32:35], s52 offen sc1
    v_add3_u32 v20, v196, v197, v20
    v_add3_u32 v20, v198, v199, v20
    v_mul_f32 v96, v96, v34
    v_mul_f32 v97, v97, v34
    v_mul_f32 v98, v98, v34
    v_mul_f32 v99, v99, v34
    v_mul_f32 v100, v100, v34
    v_mul_f32 v101, v101, v34
    v_mul_f32 v102, v102, v34
    v_mul_f32 v103, v103, v34
    v_mul_f32 v104, v96, v104
    v_mul_f32 v105, v97, v105
    v_mul_f32 v106, v98, v106
    v_mul_f32 v107, v99, v107
    v_mul_f32 v108, v100, v108
    v_mul_f32 v109, v101, v109
    v_mul_f32 v110, v102, v110
    v_mul_f32 v111, v103, v111
    v_cvt_pk_bf16_f32 v200, v104, v105
    v_cvt_pk_bf16_f32 v201, v106, v107
    v_cvt_pk_bf16_f32 v202, v108, v109
    v_cvt_pk_bf16_f32 v203, v110, v111
    s_xor_b32 s52, s5, 2048
    buffer_store_dwordx4 v[200:203], v2, s[32:35], s52 offen sc1
    v_add3_u32 v20, v200, v201, v20
    v_add3_u32 v20, v202, v203, v20
    v_mul_f32 v112, v112, v34
    v_mul_f32 v113, v113, v34
    v_mul_f32 v114, v114, v34
    v_mul_f32 v115, v115, v34
    v_mul_f32 v116, v116, v34
    v_mul_f32 v117, v117, v34
    v_mul_f32 v118, v118, v34
    v_mul_f32 v119, v119, v34
    v_mul_f32 v120, v112, v120
    v_mul_f32 v121, v113, v121
    v_mul_f32 v122, v114, v122
    v_mul_f32 v123, v115, v123
    v_mul_f32 v124, v116, v124
    v_mul_f32 v125, v117, v125
    v_mul_f32 v126, v118, v126
    v_mul_f32 v127, v119, v127
    v_cvt_pk_bf16_f32 v204, v120, v121
    v_cvt_pk_bf16_f32 v205, v122, v123
    v_cvt_pk_bf16_f32 v206, v124, v125
    v_cvt_pk_bf16_f32 v207, v126, v127
    s_xor_b32 s52, s5, 3072
    buffer_store_dwordx4 v[204:207], v2, s[32:35], s52 offen sc1
    v_add3_u32 v20, v204, v205, v20
    v_add3_u32 v20, v206, v207, v20
    v_sub_u32 v20, s60, v20
    s_lshr_b32 s52, s5, 12
    s_lshl_b32 s52, s52, 8
    s_add_u32 s52, s52, 0xc80000
    buffer_store_dword v20, v22, s[32:35], s52 offen sc1
    v_lshrrev_b32 v60, 4, v1
    v_bfe_u32 v57, v1, 2, 2
    v_lshlrev_b32 v58, 10, v60
    v_lshl_add_u32 v58, v57, 7, v58
    v_and_b32 v59, 3, v1
    v_lshl_add_u32 v58, v59, 3, v58
    v_add_u32 v58, 147456, v58
    v_lshrrev_b32 v57, 1, v57
    v_and_b32 v56, 1, v60
    v_lshl_or_b32 v57, v56, 1, v57
    v_xor_b32 v59, 0, v57
    v_lshl_add_u32 v52, v59, 5, v58
    v_xor_b32 v59, 1, v57
    v_lshl_add_u32 v53, v59, 5, v58
    v_xor_b32 v59, 2, v57
    v_lshl_add_u32 v54, v59, 5, v58
    v_xor_b32 v59, 3, v57
    v_lshl_add_u32 v55, v59, 5, v58
    v_lshrrev_b32 v56, 1, v60
    s_lshl_b32 s53, s40, 1
    v_add_u32 v56, s53, v56
    v_lshlrev_b32 v58, 1, v1
    v_xor_b32 v56, v56, v58
    v_and_b32 v56, 7, v56
    v_and_b32 v57, 15, v1
    v_lshlrev_b32 v61, 9, v57
    v_lshl_add_u32 v61, v56, 4, v61
    v_and_b32 v56, 1, v60
    v_lshl_add_u32 v61, v56, 3, v61
    v_add_u32 v61, 155648, v61
    v_bfe_u32 v56, v1, 2, 2
    v_and_b32 v58, 3, v1
    v_lshl_add_u32 v56, v56, 3, v58
    v_xor_b32 v58, v58, v60
    v_lshlrev_b32 v62, 8, v56
    v_lshl_add_u32 v62, v58, 4, v62
    v_add_u32 v62, 155648, v62
    s_lshr_b32 s53, s50, 1
    s_add_u32 s53, s53, 147456
    v_and_b32 v56, 7, v1
    v_xor_b32 v63, v56, v60
    v_lshlrev_b32 v63, 4, v63
    v_lshl_add_u32 v63, v57, 7, v63
    v_add_u32 v63, s53, v63
    v_lshrrev_b32 v58, 3, v1
    v_xor_b32 v59, v56, v58
    v_lshlrev_b32 v59, 4, v59
    v_lshl_add_u32 v59, v58, 7, v59
    v_add_u32 v59, s53, v59
    v_lshlrev_b32 v32, 15, v58
    v_lshl_add_u32 v32, v56, 4, v32
    v_lshrrev_b32 v58, 2, v1
    v_and_b32 v56, 3, v1
    v_lshlrev_b32 v33, 12, v58
    v_lshl_add_u32 v33, v56, 2, v33
    v_lshl_add_u32 v56, v56, 4, v58
    v_lshlrev_b32 v56, 2, v56
    v_xor_b32 v57, 64, v63
    s_lshl_b32 s6, s40, 19
    s_lshl_b32 s53, s48, 12
    s_add_u32 s6, s6, s53
    s_lshl_b32 s53, s49, 7
    s_add_u32 s6, s6, s53
    s_lshr_b32 s53, s50, 1
    s_add_u32 s53, s53, 147456
    v_lshl_add_u32 v48, v1, 5, s53
    s_waitcnt vmcnt(17)
    ds_read_b128 v[40:43], v48
    ds_read_b128 v[44:47], v48 offset:16
    s_waitcnt lgkmcnt(0)
    v_add3_u32 v40, v40, v41, v42
    v_add3_u32 v44, v44, v45, v46
    v_add3_u32 v40, v40, v43, v47
    v_add_u32 v40, v40, v44
    s_nop 1
    v_add_u32_dpp v40, v40, v40 quad_perm:[1,0,3,2] row_mask:0xf bank_mask:0xf
    s_nop 1
    v_add_u32_dpp v40, v40, v40 quad_perm:[2,3,0,1] row_mask:0xf bank_mask:0xf
    v_add_u32 v40, v40, v38
    v_cmp_ne_u32 vcc, s60, v40
    s_cbranch_vccnz L_spin_34
L_ok_33:
    s_barrier
    ds_read_b64_tr_b16 a[24:25], v52 offset:0
    ds_read_b64_tr_b16 a[26:27], v52 offset:512
    ds_read_b64_tr_b16 a[28:29], v53 offset:0
    ds_read_b64_tr_b16 a[30:31], v53 offset:512
    ds_read_b64_tr_b16 a[32:33], v54 offset:0
    ds_read_b64_tr_b16 a[34:35], v54 offset:512
    ds_read_b64_tr_b16 a[36:37], v55 offset:0
    ds_read_b64_tr_b16 a[38:39], v55 offset:512
    ds_read_b64_tr_b16 a[40:41], v52 offset:4096
    ds_read_b64_tr_b16 a[42:43], v52 offset:4608
    ds_read_b64_tr_b16 a[44:45], v53 offset:4096
    ds_read_b64_tr_b16 a[46:47], v53 offset:4608
    ds_read_b64_tr_b16 a[248:249], v54 offset:4096
    ds_read_b64_tr_b16 a[250:251], v54 offset:4608
    ds_read_b64_tr_b16 a[252:253], v55 offset:4096
    ds_read_b64_tr_b16 a[254:255], v55 offset:4608
    s_waitcnt lgkmcnt(8)
    v_mfma_f32_16x16x32_bf16 v[64:67], a[112:115], a[24:27], 0
    v_mfma_f32_16x16x32_bf16 v[68:71], a[112:115], a[32:35], 0
    v_mfma_f32_16x16x32_bf16 v[64:67], a[120:123], a[32:35], v[64:67]
    v_mfma_f32_16x16x32_bf16 v[68:71], a[128:131], a[24:27], v[68:71]
    v_mfma_f32_16x16x32_bf16 v[72:75], a[112:115], a[28:31], 0
    v_mfma_f32_16x16x32_bf16 v[76:79], a[112:115], a[36:39], 0
    v_mfma_f32_16x16x32_bf16 v[72:75], a[120:123], a[36:39], v[72:75]
    v_mfma_f32_16x16x32_bf16 v[76:79], a[128:131], a[28:31], v[76:79]
    s_waitcnt lgkmcnt(0)
    v_mfma_f32_16x16x32_bf16 v[64:67], a[116:119], a[40:43], v[64:67]
    v_mfma_f32_16x16x32_bf16 v[68:71], a[116:119], a[248:251], v[68:71]
    v_mfma_f32_16x16x32_bf16 v[64:67], a[124:127], a[248:251], v[64:67]
    v_mfma_f32_16x16x32_bf16 v[68:71], a[132:135], a[40:43], v[68:71]
    v_mfma_f32_16x16x32_bf16 v[72:75], a[116:119], a[44:47], v[72:75]
    v_mfma_f32_16x16x32_bf16 v[76:79], a[116:119], a[252:255], v[76:79]
    v_mfma_f32_16x16x32_bf16 v[72:75], a[124:127], a[252:255], v[72:75]
    v_mfma_f32_16x16x32_bf16 v[76:79], a[132:135], a[44:47], v[76:79]
    v_lshlrev_b32 v48, 16, v128
    v_lshlrev_b32 v49, 16, v129
    s_nop 0
    v_mul_f32 v40, v64, v48
    v_mul_f32 v44, v64, v49
    v_fma_f32 v40, -v68, v49, v40
    v_fmac_f32 v44, v68, v48
    v_lshlrev_b32 v50, 16, v130
    v_lshlrev_b32 v51, 16, v131
    v_mul_f32 v41, v65, v50
    v_mul_f32 v45, v65, v51
    v_fma_f32 v41, -v69, v51, v41
    v_fmac_f32 v45, v69, v50
    v_lshlrev_b32 v48, 16, v132
    v_lshlrev_b32 v49, 16, v133
    v_mul_f32 v42, v66, v48
    v_mul_f32 v46, v66, v49
    v_fma_f32 v42, -v70, v49, v42
    v_fmac_f32 v46, v70, v48
    v_lshlrev_b32 v50, 16, v134
    v_lshlrev_b32 v51, 16, v135
    v_mul_f32 v43, v67, v50
    v_mul_f32 v47, v67, v51
    v_fma_f32 v43, -v71, v51, v43
    v_fmac_f32 v47, v71, v50
    v_cvt_pk_bf16_f32 v64, v40, v41
    v_cvt_pk_bf16_f32 v65, v42, v43
    ds_write_b64 v61, v[64:65] offset:0
    v_cvt_pk_bf16_f32 v66, v44, v45
    v_cvt_pk_bf16_f32 v67, v46, v47
    ds_write_b64 v61, v[66:67] offset:128
    v_and_b32 v48, 0xffff0000, v128
    v_and_b32 v49, 0xffff0000, v129
    v_mul_f32 v40, v72, v48
    v_mul_f32 v44, v72, v49
    v_fma_f32 v40, -v76, v49, v40
    v_fmac_f32 v44, v76, v48
    v_and_b32 v50, 0xffff0000, v130
    v_and_b32 v51, 0xffff0000, v131
    v_mul_f32 v41, v73, v50
    v_mul_f32 v45, v73, v51
    v_fma_f32 v41, -v77, v51, v41
    v_fmac_f32 v45, v77, v50
    v_and_b32 v48, 0xffff0000, v132
    v_and_b32 v49, 0xffff0000, v133
    v_mul_f32 v42, v74, v48
    v_mul_f32 v46, v74, v49
    v_fma_f32 v42, -v78, v49, v42
    v_fmac_f32 v46, v78, v48
    v_and_b32 v50, 0xffff0000, v134
    v_and_b32 v51, 0xffff0000, v135
    v_mul_f32 v43, v75, v50
    v_mul_f32 v47, v75, v51
    v_fma_f32 v43, -v79, v51, v43
    v_fmac_f32 v47, v79, v50
    v_xor_b32 v61, 16, v61
    v_cvt_pk_bf16_f32 v72, v40, v41
    v_cvt_pk_bf16_f32 v73, v42, v43
    ds_write_b64 v61, v[72:73] offset:256
    v_cvt_pk_bf16_f32 v74, v44, v45
    v_cvt_pk_bf16_f32 v75, v46, v47
    ds_write_b64 v61, v[74:75] offset:384
    s_waitcnt lgkmcnt(0)
    s_barrier
    ds_read_b128 a[24:27], v62 offset:0
    ds_read_b128 a[28:31], v62 offset:1088
    ds_read_b128 a[32:35], v62 offset:128
    ds_read_b128 a[36:39], v62 offset:1216
    ds_read_b128 a[40:43], v62 offset:64
    ds_read_b128 a[44:47], v62 offset:1024
    ds_read_b128 a[248:251], v62 offset:192
    ds_read_b128 a[252:255], v62 offset:1152
    s_waitcnt lgkmcnt(4)
    buffer_load_dwordx4 v[160:163], v16, s[32:35], s64 offen offset:0 sc1
    v_mfma_f32_16x16x32_bf16 v[64:67], a[24:27], a[136:139], 0
    v_mfma_f32_16x16x32_bf16 v[68:71], a[32:35], a[136:139], 0
    v_mfma_f32_16x16x32_bf16 v[64:67], a[32:35], a[152:155], v[64:67]
    v_mfma_f32_16x16x32_bf16 v[68:71], a[24:27], a[144:147], v[68:71]
    buffer_load_dwordx4 v[164:167], v17, s[32:35], s64 offen offset:0 sc1
    v_mfma_f32_16x16x32_bf16 v[72:75], a[28:31], a[136:139], 0
    v_mfma_f32_16x16x32_bf16 v[76:79], a[36:39], a[136:139], 0
    v_mfma_f32_16x16x32_bf16 v[72:75], a[36:39], a[152:155], v[72:75]
    v_mfma_f32_16x16x32_bf16 v[76:79], a[28:31], a[144:147], v[76:79]
    buffer_load_dwordx4 v[168:171], v16, s[32:35], s64 offen offset:1024 sc1
    s_waitcnt lgkmcnt(0)
    v_mfma_f32_16x16x32_bf16 v[64:67], a[40:43], a[140:143], v[64:67]
    v_mfma_f32_16x16x32_bf16 v[68:71], a[248:251], a[140:143], v[68:71]
    v_mfma_f32_16x16x32_bf16 v[64:67], a[248:251], a[156:159], v[64:67]
    buffer_load_dwordx4 v[172:175], v17, s[32:35], s64 offen offset:1024 sc1
    v_mfma_f32_16x16x32_bf16 v[68:71], a[40:43], a[148:151], v[68:71]
    v_mfma_f32_16x16x32_bf16 v[72:75], a[44:47], a[140:143], v[72:75]
    v_mfma_f32_16x16x32_bf16 v[76:79], a[252:255], a[140:143], v[76:79]
    v_mfma_f32_16x16x32_bf16 v[72:75], a[252:255], a[156:159], v[72:75]
    buffer_load_dwordx4 v[176:179], v16, s[32:35], s64 offen offset:2048 sc1
    v_mfma_f32_16x16x32_bf16 v[76:79], a[44:47], a[148:151], v[76:79]
    s_nop 0
    v_cvt_pk_bf16_f32 v40, v64, v65
    v_cvt_pk_bf16_f32 v41, v66, v67
    s_nop 2
    v_cvt_pk_bf16_f32 v42, v72, v73
    v_cvt_pk_bf16_f32 v43, v74, v75
    v_cvt_pk_bf16_f32 v44, v68, v69
    buffer_load_dwordx4 v[180:183], v17, s[32:35], s64 offen offset:2048 sc1
    v_cvt_pk_bf16_f32 v45, v70, v71
    v_cvt_pk_bf16_f32 v46, v76, v77
    v_cvt_pk_bf16_f32 v47, v78, v79
    ds_write_b128 v63, v[40:43]
    ds_write_b128 v57, v[44:47]
    v_add3_u32 v48, v40, v41, 0
    v_add3_u32 v49, v42, v43, v44
    v_add3_u32 v48, v48, v45, v46
    v_add3_u32 v48, v48, v49, v47
    buffer_load_dwordx4 v[184:187], v16, s[32:35], s64 offen offset:3072 sc1
    v_sub_u32 v48, s60, v48
    ds_read_b128 a[144:147], v59 offset:0
    ds_read_b128 a[148:151], v59 offset:1024
    ds_bpermute_b32 v34, v56, v48
    buffer_load_dwordx4 v[188:191], v17, s[32:35], s64 offen offset:3072 sc1
    buffer_load_dword v24, v18, s[32:35], s72 offen sc1
    buffer_load_dword v25, v19, s[32:35], s72 offen sc1
    v_lshrrev_b32 v40, 3, v1
    v_lshlrev_b32 v40, 7, v40
    v_bfe_u32 v41, v1, 4, 1
    v_xor_b32 v41, s40, v41
    v_and_b32 v41, 1, v41
    v_lshlrev_b32 v41, 6, v41
    s_waitcnt lgkmcnt(0)
    s_add_u32 s52, s6, 0xa00000
    buffer_store_dwordx4 a[144:147], v32, s[32:35], s52 offen sc1
    s_add_u32 s52, s6, 0xa40000
    buffer_store_dwordx4 a[148:151], v32, s[32:35], s52 offen sc1
    v_and_b32 v42, 0x70, v2
    v_xor_b32 v41, v41, v42
    v_add_u32 v38, v40, v41
    v_lshlrev_b32 v35, 3, v1
    v_and_b32 v43, 31, v1
    v_lshlrev_b32 v43, 16, v43
    v_lshrrev_b32 v44, 5, v1
    v_lshl_add_u32 v36, v44, 3, v43
    v_lshl_add_u32 v37, v44, 4, v43
    s_lshr_b32 s54, s63, 15
    s_lshl_b32 s54, s54, 10
    s_lshr_b32 s52, s6, 3
    s_add_u32 s52, s52, 0xd40000
    buffer_store_dword v34, v33, s[32:35], s52 offen sc1
    s_lshl_b32 s53, s47, 7
    s_add_u32 s54, s54, s53
    s_and_b32 s53, s40, 1
    s_lshl_b32 s53, s53, 6
    s_add_u32 s7, s54, s53
    v_and_b32 v59, 1, v1
    v_mul_lo_u32 v59, v59, s62
    v_and_b32 v61, 31, v1
    v_cvt_f32_u32 v61, v61
    v_mul_f32 v61, 0x3d000000, v61
    v_lshrrev_b32 v60, 5, v1
    buffer_load_dwordx4 v[192:195], v16, s[32:35], s65 offen offset:0 sc1
    v_lshlrev_b32 v60, 2, v60
    v_cvt_f32_u32 v60, v60
    v_mul_f32 v60, v60, v61
    v_mov_b32 v40, v60
    v_fmamk_f32 v41, v61, 0x3f800000, v60
    v_fmamk_f32 v42, v61, 0x40000000, v60
    v_fmamk_f32 v43, v61, 0x40400000, v60
    v_cos_f32 v44, v40
    v_cos_f32 v45, v41
    buffer_load_dwordx4 v[196:199], v17, s[32:35], s65 offen offset:0 sc1
    v_cos_f32 v46, v42
    v_cos_f32 v47, v43
    v_sin_f32 v48, v40
    v_sin_f32 v49, v41
    v_sin_f32 v50, v42
    v_sin_f32 v51, v43
    buffer_load_dwordx4 v[200:203], v16, s[32:35], s65 offen offset:1024 sc1
    v_cvt_pk_bf16_f32 v52, v44, v45
    v_cvt_pk_bf16_f32 v53, v48, v49
    v_xor_b32 v54, v59, v52
    v_xor_b32 v55, v59, v53
    v_xor_b32 v56, s62, v53
    v_xor_b32 v57, s62, v55
    v_accvgpr_write_b32 a24, v52
    v_accvgpr_write_b32 a32, v53
    v_accvgpr_write_b32 a28, v54
    v_accvgpr_write_b32 a36, v55
    v_accvgpr_write_b32 a40, v56
    v_accvgpr_write_b32 a44, v57
    v_cvt_pk_bf16_f32 v52, v46, v47
    v_cvt_pk_bf16_f32 v53, v50, v51
    buffer_load_dwordx4 v[204:207], v17, s[32:35], s65 offen offset:1024 sc1
    v_xor_b32 v54, v59, v52
    v_xor_b32 v55, v59, v53
    v_xor_b32 v56, s62, v53
    v_xor_b32 v57, s62, v55
    v_accvgpr_write_b32 a25, v52
    v_accvgpr_write_b32 a33, v53
    v_accvgpr_write_b32 a29, v54
    v_accvgpr_write_b32 a37, v55
    v_accvgpr_write_b32 a41, v56
    v_accvgpr_write_b32 a45, v57
    v_fmamk_f32 v40, v61, 0x41000000, v60
    v_fmamk_f32 v41, v61, 0x41100000, v60
    v_fmamk_f32 v42, v61, 0x41200000, v60
    buffer_load_dwordx4 v[208:211], v16, s[32:35], s65 offen offset:2048 sc1
    v_fmamk_f32 v43, v61, 0x41300000, v60
    v_cos_f32 v44, v40
    v_cos_f32 v45, v41
    v_cos_f32 v46, v42
    v_cos_f32 v47, v43
    v_sin_f32 v48, v40
    v_sin_f32 v49, v41
    v_sin_f32 v50, v42
    buffer_load_dwordx4 v[212:215], v17, s[32:35], s65 offen offset:2048 sc1
    v_sin_f32 v51, v43
    v_cvt_pk_bf16_f32 v52, v44, v45
    v_cvt_pk_bf16_f32 v53, v48, v49
    v_xor_b32 v54, v59, v52
    v_xor_b32 v55, v59, v53
    v_xor_b32 v56, s62, v53
    v_xor_b32 v57, s62, v55
    v_accvgpr_write_b32 a26, v52
    v_accvgpr_write_b32 a34, v53
    v_accvgpr_write_b32 a30, v54
    v_accvgpr_write_b32 a38, v55
    buffer_load_dwordx4 v[216:219], v16, s[32:35], s65 offen offset:3072 sc1
    v_accvgpr_write_b32 a42, v56
    v_accvgpr_write_b32 a46, v57
    v_cvt_pk_bf16_f32 v52, v46, v47
    v_cvt_pk_bf16_f32 v53, v50, v51
    v_xor_b32 v54, v59, v52
    v_xor_b32 v55, v59, v53
    v_xor_b32 v56, s62, v53
    v_xor_b32 v57, s62, v55
    v_accvgpr_write_b32 a27, v52
    v_accvgpr_write_b32 a35, v53
    v_accvgpr_write_b32 a31, v54
    v_accvgpr_write_b32 a39, v55
    v_accvgpr_write_b32 a43, v56
    v_accvgpr_write_b32 a47, v57
    buffer_load_dwordx4 v[220:223], v17, s[32:35], s65 offen offset:3072 sc1
    v_and_b32 v40, 1, v1
    v_cmp_eq_u32 s[84:85], 1, v40
    v_bfe_u32 v41, v1, 1, 1
    v_mul_lo_u32 v58, v41, s62
    v_xor_b32 v41, v41, v40
    v_mul_lo_u32 v59, v41, s62
    s_and_b32 s53, s40, 1
    s_waitcnt vmcnt(11)
    v_add3_u32 v24, v160, v161, v24
    v_add3_u32 v24, v162, v163, v24
    v_add3_u32 v24, v168, v169, v24
    v_add3_u32 v24, v170, v171, v24
    v_add3_u32 v24, v176, v177, v24
    v_add3_u32 v24, v178, v179, v24
    v_add3_u32 v24, v184, v185, v24
    v_add3_u32 v24, v186, v187, v24
    v_add3_u32 v25, v164, v165, v25
    v_add3_u32 v25, v166, v167, v25
    v_add3_u32 v25, v172, v173, v25
    v_add3_u32 v25, v174, v175, v25
    v_add3_u32 v25, v180, v181, v25
    v_add3_u32 v25, v182, v183, v25
    v_add3_u32 v25, v188, v189, v25
    v_add3_u32 v25, v190, v191, v25
    v_bitop3_b32 v24, v24, v25, s60 bitop3:0x7e
    v_cmp_ne_u32 vcc, 0, v24
    s_cbranch_vccnz L_spin_36
L_ok_35:
    v_mfma_f32_32x32x16_bf16 a[48:63], a[184:187], v[160:163], 0
    buffer_load_dword v26, v18, s[32:35], s73 offen sc1
    buffer_load_dword v27, v19, s[32:35], s73 offen sc1
    v_mfma_f32_32x32x16_bf16 a[64:79], a[188:191], v[160:163], 0
    s_xor_b32 s53, s53, 0
    s_lshl_b32 s53, s53, 5
    s_lshl_b32 s54, s47, 6
    s_add_u32 s53, s53, s54
    v_and_b32 v61, 31, v1
    v_add_u32 v61, s53, v61
    v_mfma_f32_32x32x16_bf16 a[80:95], a[184:187], v[164:167], 0
    v_cvt_f32_u32 v61, v61
    v_mul_f32 v61, 0x3b000000, v61
    s_lshl_b32 s53, s40, 5
    v_lshrrev_b32 v60, 5, v1
    v_lshl_add_u32 v60, v60, 2, s53
    v_cvt_f32_u32 v60, v60
    v_mfma_f32_32x32x16_bf16 a[96:111], a[188:191], v[164:167], 0
    buffer_load_dwordx4 v[224:227], v16, s[32:35], s66 offen offset:0 sc1
    v_mul_f32 v60, v60, v61
    v_fmamk_f32 v40, v61, 0x3f800000, v60
    v_fmamk_f32 v41, v61, 0x40000000, v60
    v_mfma_f32_32x32x16_bf16 a[48:63], a[192:195], v[168:171], a[48:63]
    v_fmamk_f32 v42, v61, 0x40400000, v60
    v_fmamk_f32 v43, v61, 0x40800000, v60
    v_cos_f32 v44, v40
    v_cos_f32 v45, v41
    v_mfma_f32_32x32x16_bf16 a[64:79], a[196:199], v[168:171], a[64:79]
    buffer_load_dwordx4 v[228:231], v17, s[32:35], s66 offen offset:0 sc1
    v_cos_f32 v46, v42
    v_mfma_f32_32x32x16_bf16 a[80:95], a[192:195], v[172:175], a[80:95]
    v_cos_f32 v47, v43
    v_sin_f32_e64 v48, -v40
    v_sin_f32_e64 v49, -v41
    v_mfma_f32_32x32x16_bf16 a[96:111], a[196:199], v[172:175], a[96:111]
    v_sin_f32_e64 v50, -v42
    v_sin_f32_e64 v51, -v43
    v_cvt_pk_bf16_f32 v64, v44, v45
    v_cvt_pk_bf16_f32 v80, v48, v49
    v_mfma_f32_32x32x16_bf16 a[48:63], a[200:203], v[176:179], a[48:63]
    v_cndmask_b32 v96, v64, v80, s[84:85]
    v_cndmask_b32 v112, v80, v64, s[84:85]
    v_xor_b32 v96, v58, v96
    v_xor_b32 v112, v59, v112
    v_cvt_pk_bf16_f32 v65, v46, v47
    v_cvt_pk_bf16_f32 v81, v50, v51
    v_cndmask_b32 v97, v65, v81, s[84:85]
    v_cndmask_b32 v113, v81, v65, s[84:85]
    v_xor_b32 v97, v58, v97
    v_xor_b32 v113, v59, v113
    v_fmamk_f32 v40, v61, 0x41100000, v60
    v_fmamk_f32 v41, v61, 0x41200000, v60
    v_fmamk_f32 v42, v61, 0x41300000, v60
    v_fmamk_f32 v43, v61, 0x41400000, v60
    buffer_load_dwordx4 v[232:235], v16, s[32:35], s66 offen offset:1024 sc1
    v_cos_f32 v44, v40
    v_cos_f32 v45, v41
    v_cos_f32 v46, v42
    v_cos_f32 v47, v43
    v_sin_f32_e64 v48, -v40
    v_sin_f32_e64 v49, -v41
    v_sin_f32_e64 v50, -v42
    v_sin_f32_e64 v51, -v43
    v_cvt_pk_bf16_f32 v66, v44, v45
    v_cvt_pk_bf16_f32 v82, v48, v49
    v_cndmask_b32 v98, v66, v82, s[84:85]
    v_cndmask_b32 v114, v82, v66, s[84:85]
    v_xor_b32 v98, v58, v98
    v_xor_b32 v114, v59, v114
    v_cvt_pk_bf16_f32 v67, v46, v47
    v_cvt_pk_bf16_f32 v83, v50, v51
    v_cndmask_b32 v99, v67, v83, s[84:85]
    v_cndmask_b32 v115, v83, v67, s[84:85]
    v_xor_b32 v99, v58, v99
    v_xor_b32 v115, v59, v115
    v_fmamk_f32 v40, v61, 0x41880000, v60
    v_fmamk_f32 v41, v61, 0x41900000, v60
    v_fmamk_f32 v42, v61, 0x41980000, v60
    v_fmamk_f32 v43, v61, 0x41a00000, v60
    v_cos_f32 v44, v40
    v_cos_f32 v45, v41
    buffer_load_dwordx4 v[236:239], v17, s[32:35], s66 offen offset:1024 sc1
    v_cos_f32 v46, v42
    v_cos_f32 v47, v43
    v_sin_f32_e64 v48, -v40
    v_sin_f32_e64 v49, -v41
    v_sin_f32_e64 v50, -v42
    v_sin_f32_e64 v51, -v43
    v_cvt_pk_bf16_f32 v72, v44, v45
    v_cvt_pk_bf16_f32 v88, v48, v49
    buffer_load_dwordx4 v[240:243], v16, s[32:35], s66 offen offset:2048 sc1
    v_cndmask_b32 v104, v72, v88, s[84:85]
    v_cndmask_b32 v120, v88, v72, s[84:85]
    v_xor_b32 v104, v58, v104
    v_xor_b32 v120, v59, v120
    v_cvt_pk_bf16_f32 v73, v46, v47
    v_cvt_pk_bf16_f32 v89, v50, v51
    v_cndmask_b32 v105, v73, v89, s[84:85]
    v_cndmask_b32 v121, v89, v73, s[84:85]
    v_xor_b32 v105, v58, v105
    v_xor_b32 v121, v59, v121
    v_fmamk_f32 v40, v61, 0x41c80000, v60
    v_fmamk_f32 v41, v61, 0x41d00000, v60
    v_fmamk_f32 v42, v61, 0x41d80000, v60
    buffer_load_dwordx4 v[244:247], v17, s[32:35], s66 offen offset:2048 sc1
    v_fmamk_f32 v43, v61, 0x41e00000, v60
    v_cos_f32 v44, v40
    v_cos_f32 v45, v41
    v_cos_f32 v46, v42
    v_cos_f32 v47, v43
    v_sin_f32_e64 v48, -v40
    v_sin_f32_e64 v49, -v41
    v_sin_f32_e64 v50, -v42
    buffer_load_dwordx4 v[248:251], v16, s[32:35], s66 offen offset:3072 sc1
    v_sin_f32_e64 v51, -v43
    v_cvt_pk_bf16_f32 v74, v44, v45
    v_cvt_pk_bf16_f32 v90, v48, v49
    v_cndmask_b32 v106, v74, v90, s[84:85]
    v_cndmask_b32 v122, v90, v74, s[84:85]
    v_xor_b32 v106, v58, v106
    v_xor_b32 v122, v59, v122
    v_cvt_pk_bf16_f32 v75, v46, v47
    v_cvt_pk_bf16_f32 v91, v50, v51
    v_cndmask_b32 v107, v75, v91, s[84:85]
    v_cndmask_b32 v123, v91, v75, s[84:85]
    buffer_load_dwordx4 v[252:255], v17, s[32:35], s66 offen offset:3072 sc1
    v_xor_b32 v107, v58, v107
    v_xor_b32 v123, v59, v123
    s_and_b32 s53, s40, 1
    s_xor_b32 s53, s53, 1
    s_lshl_b32 s53, s53, 5
    s_lshl_b32 s54, s47, 6
    s_add_u32 s53, s53, s54
    v_and_b32 v61, 31, v1
    v_add_u32 v61, s53, v61
    v_cvt_f32_u32 v61, v61
    v_mul_f32 v61, 0x3b000000, v61
    s_lshl_b32 s53, s40, 5
    v_lshrrev_b32 v60, 5, v1
    v_lshl_add_u32 v60, v60, 2, s53
    buffer_load_dword v28, v18, s[32:35], s74 offen sc1
    buffer_load_dword v29, v19, s[32:35], s74 offen sc1
    v_cvt_f32_u32 v60, v60
    v_mul_f32 v60, v60, v61
    v_fmamk_f32 v40, v61, 0x3f800000, v60
    v_fmamk_f32 v41, v61, 0x40000000, v60
    v_fmamk_f32 v42, v61, 0x40400000, v60
    v_fmamk_f32 v43, v61, 0x40800000, v60
    v_cos_f32 v44, v40
    v_cos_f32 v45, v41
    v_cos_f32 v46, v42
    buffer_load_dwordx4 v[128:131], v16, s[32:35], s67 offen offset:0 sc1
    v_cos_f32 v47, v43
    v_sin_f32_e64 v48, -v40
    v_sin_f32_e64 v49, -v41
    s_waitcnt vmcnt(11)
    v_mfma_f32_32x32x16_bf16 a[64:79], a[204:207], v[176:179], a[64:79]
    buffer_load_dwordx4 v[132:135], v17, s[32:35], s67 offen offset:0 sc1
    v_add3_u32 v26, v192, v193, v26
    v_add3_u32 v26, v194, v195, v26
    v_add3_u32 v26, v200, v201, v26
    v_mfma_f32_32x32x16_bf16 a[80:95], a[200:203], v[180:183], a[80:95]
    v_add3_u32 v26, v202, v203, v26
    v_add3_u32 v26, v208, v209, v26
    v_add3_u32 v26, v210, v211, v26
    v_add3_u32 v26, v216, v217, v26
    v_add3_u32 v26, v218, v219, v26
    v_add3_u32 v27, v196, v197, v27
    v_mfma_f32_32x32x16_bf16 a[96:111], a[204:207], v[180:183], a[96:111]
    buffer_load_dwordx4 v[136:139], v16, s[32:35], s67 offen offset:1024 sc1
    v_add3_u32 v27, v198, v199, v27
    v_add3_u32 v27, v204, v205, v27
    v_add3_u32 v27, v206, v207, v27
    v_mfma_f32_32x32x16_bf16 a[48:63], a[208:211], v[184:187], a[48:63]
    v_add3_u32 v27, v212, v213, v27
    v_add3_u32 v27, v214, v215, v27
    v_add3_u32 v27, v220, v221, v27
    v_add3_u32 v27, v222, v223, v27
    v_bitop3_b32 v26, v26, v27, s60 bitop3:0x7e
    v_mfma_f32_32x32x16_bf16 a[64:79], a[212:215], v[184:187], a[64:79]
    buffer_load_dwordx4 v[140:143], v17, s[32:35], s67 offen offset:1024 sc1
    v_cmp_ne_u32 vcc, 0, v26
    s_cbranch_vccnz L_spin_38
L_ok_37:
    v_mfma_f32_32x32x16_bf16 a[80:95], a[208:211], v[188:191], a[80:95]
    v_sin_f32_e64 v50, -v42
    v_sin_f32_e64 v51, -v43
    v_cvt_pk_bf16_f32 v68, v44, v45
    v_cvt_pk_bf16_f32 v84, v48, v49
    v_mfma_f32_32x32x16_bf16 a[96:111], a[212:215], v[188:191], a[96:111]
    buffer_load_dwordx4 v[144:147], v16, s[32:35], s67 offen offset:2048 sc1
    v_cndmask_b32 v100, v68, v84, s[84:85]
    v_cndmask_b32 v116, v84, v68, s[84:85]
    v_xor_b32 v100, v58, v100
    v_mfma_f32_32x32x16_bf16 a[48:63], a[216:219], v[192:195], a[48:63]
    ds_read_b64_tr_b16 a[0:1], v12 offset:32768
    v_xor_b32 v116, v59, v116
    v_cvt_pk_bf16_f32 v69, v46, v47
    v_cvt_pk_bf16_f32 v85, v50, v51
    v_cndmask_b32 v101, v69, v85, s[84:85]
    v_cndmask_b32 v117, v85, v69, s[84:85]
    v_mfma_f32_32x32x16_bf16 a[64:79], a[220:223], v[192:195], a[64:79]
    ds_read_b64_tr_b16 a[2:3], v12 offset:33792
    buffer_load_dwordx4 v[148:151], v17, s[32:35], s67 offen offset:2048 sc1
    v_xor_b32 v101, v58, v101
    v_xor_b32 v117, v59, v117
    v_mfma_f32_32x32x16_bf16 a[80:95], a[216:219], v[196:199], a[80:95]
    ds_read_b64_tr_b16 a[4:5], v13 offset:32768
    v_fmamk_f32 v40, v61, 0x41100000, v60
    v_fmamk_f32 v41, v61, 0x41200000, v60
    v_fmamk_f32 v42, v61, 0x41300000, v60
    v_fmamk_f32 v43, v61, 0x41400000, v60
    v_mfma_f32_32x32x16_bf16 a[96:111], a[220:223], v[196:199], a[96:111]
    ds_read_b64_tr_b16 a[6:7], v13 offset:33792
    buffer_load_dwordx4 v[152:155], v16, s[32:35], s67 offen offset:3072 sc1
    v_cos_f32 v44, v40
    v_mfma_f32_32x32x16_bf16 a[48:63], a[224:227], v[200:203], a[48:63]
    ds_read_b64_tr_b16 a[8:9], v12 offset:34816
    v_cos_f32 v45, v41
    v_cos_f32 v46, v42
    v_mfma_f32_32x32x16_bf16 a[64:79], a[228:231], v[200:203], a[64:79]
    ds_read_b64_tr_b16 a[10:11], v12 offset:35840
    buffer_load_dwordx4 v[156:159], v17, s[32:35], s67 offen offset:3072 sc1
    v_cos_f32 v47, v43
    v_mfma_f32_32x32x16_bf16 a[80:95], a[224:227], v[204:207], a[80:95]
    ds_read_b64_tr_b16 a[12:13], v13 offset:34816
    v_sin_f32_e64 v48, -v40
    v_sin_f32_e64 v49, -v41
    v_mfma_f32_32x32x16_bf16 a[96:111], a[228:231], v[204:207], a[96:111]
    ds_read_b64_tr_b16 a[14:15], v13 offset:35840
    buffer_load_dword v30, v18, s[32:35], s75 offen sc1
    buffer_load_dword v31, v19, s[32:35], s75 offen sc1
    s_waitcnt lgkmcnt(4)
    v_mfma_f32_32x32x16_bf16 a[48:63], a[0:3], v[208:211], a[48:63]
    v_add_u32 v12, 0x20000, v12
    v_add_u32 v13, 0x20000, v13
    v_add_u32 v14, 0x20000, v14
    ds_read_b64_tr_b16 a[16:17], v12 offset:0
    s_waitcnt vmcnt(10)
    v_mfma_f32_32x32x16_bf16 a[64:79], a[4:7], v[208:211], a[64:79]
    ds_read_b64_tr_b16 a[18:19], v12 offset:1024
    buffer_load_dwordx4 v[160:163], v16, s[32:35], s68 offen offset:0 sc1
    v_add3_u32 v28, v224, v225, v28
    v_add3_u32 v28, v226, v227, v28
    v_mfma_f32_32x32x16_bf16 a[80:95], a[0:3], v[212:215], a[80:95]
    ds_read_b64_tr_b16 a[20:21], v13 offset:0
    v_add3_u32 v28, v232, v233, v28
    v_add3_u32 v28, v234, v235, v28
    v_add3_u32 v28, v240, v241, v28
    v_add3_u32 v28, v242, v243, v28
    v_add3_u32 v28, v248, v249, v28
    v_mfma_f32_32x32x16_bf16 a[96:111], a[4:7], v[212:215], a[96:111]
    ds_read_b64_tr_b16 a[22:23], v13 offset:1024
    buffer_load_dwordx4 v[164:167], v17, s[32:35], s68 offen offset:0 sc1
    v_add3_u32 v28, v250, v251, v28
    v_add3_u32 v29, v228, v229, v29
    s_waitcnt lgkmcnt(4)
    v_mfma_f32_32x32x16_bf16 a[48:63], a[8:11], v[216:219], a[48:63]
    ds_read_b64_tr_b16 a[0:1], v12 offset:2048
    v_add3_u32 v29, v230, v231, v29
    v_add3_u32 v29, v236, v237, v29
    v_add3_u32 v29, v238, v239, v29
    v_add3_u32 v29, v244, v245, v29
    v_add3_u32 v29, v246, v247, v29
    v_mfma_f32_32x32x16_bf16 a[64:79], a[12:15], v[216:219], a[64:79]
    ds_read_b64_tr_b16 a[2:3], v12 offset:3072
    buffer_load_dwordx4 v[168:171], v16, s[32:35], s68 offen offset:1024 sc1
    v_add3_u32 v29, v252, v253, v29
    v_add3_u32 v29, v254, v255, v29
    v_mfma_f32_32x32x16_bf16 a[80:95], a[8:11], v[220:223], a[80:95]
    ds_read_b64_tr_b16 a[4:5], v13 offset:2048
    v_bitop3_b32 v28, v28, v29, s60 bitop3:0x7e
    v_cmp_ne_u32 vcc, 0, v28
    s_cbranch_vccnz L_spin_40
L_ok_39:
    v_sin_f32_e64 v50, -v42
    v_mfma_f32_32x32x16_bf16 a[96:111], a[12:15], v[220:223], a[96:111]
    ds_read_b64_tr_b16 a[6:7], v13 offset:3072
    buffer_load_dwordx4 v[172:175], v17, s[32:35], s68 offen offset:1024 sc1
    v_sin_f32_e64 v51, -v43
    s_waitcnt lgkmcnt(4)
    v_mfma_f32_32x32x16_bf16 a[48:63], a[16:19], v[224:227], a[48:63]
    v_add_u32 v12, 0xfffe0000, v12
    v_add_u32 v13, 0xfffe0000, v13
    v_add_u32 v14, 0xfffe0000, v14
    ds_read_b64_tr_b16 a[8:9], v12 offset:0
    v_cvt_pk_bf16_f32 v70, v44, v45
    v_cvt_pk_bf16_f32 v86, v48, v49
    v_mfma_f32_32x32x16_bf16 a[64:79], a[20:23], v[224:227], a[64:79]
    ds_read_b64_tr_b16 a[10:11], v12 offset:1024
    buffer_load_dwordx4 v[176:179], v16, s[32:35], s68 offen offset:2048 sc1
    v_cndmask_b32 v102, v70, v86, s[84:85]
    v_cndmask_b32 v118, v86, v70, s[84:85]
    v_mfma_f32_32x32x16_bf16 a[80:95], a[16:19], v[228:231], a[80:95]
    ds_read_b64_tr_b16 a[12:13], v13 offset:0
    v_xor_b32 v102, v58, v102
    v_xor_b32 v118, v59, v118
    v_cvt_pk_bf16_f32 v71, v46, v47
    v_cvt_pk_bf16_f32 v87, v50, v51
    v_cndmask_b32 v103, v71, v87, s[84:85]
    v_mfma_f32_32x32x16_bf16 a[96:111], a[20:23], v[228:231], a[96:111]
    ds_read_b64_tr_b16 a[14:15], v13 offset:1024
    buffer_load_dwordx4 v[180:183], v17, s[32:35], s68 offen offset:2048 sc1
    v_cndmask_b32 v119, v87, v71, s[84:85]
    v_xor_b32 v103, v58, v103
    s_waitcnt lgkmcnt(4)
    v_mfma_f32_32x32x16_bf16 a[48:63], a[0:3], v[232:235], a[48:63]
    ds_read_b64_tr_b16 a[16:17], v12 offset:2048
    v_xor_b32 v119, v59, v119
    v_fmamk_f32 v40, v61, 0x41880000, v60
    v_fmamk_f32 v41, v61, 0x41900000, v60
    v_fmamk_f32 v42, v61, 0x41980000, v60
    v_fmamk_f32 v43, v61, 0x41a00000, v60
    v_mfma_f32_32x32x16_bf16 a[64:79], a[4:7], v[232:235], a[64:79]
    ds_read_b64_tr_b16 a[18:19], v12 offset:3072
    buffer_load_dwordx4 v[184:187], v16, s[32:35], s68 offen offset:3072 sc1
    v_cos_f32 v44, v40
    v_mfma_f32_32x32x16_bf16 a[80:95], a[0:3], v[236:239], a[80:95]
    ds_read_b64_tr_b16 a[20:21], v13 offset:2048
    v_cos_f32 v45, v41
    v_cos_f32 v46, v42
    v_mfma_f32_32x32x16_bf16 a[96:111], a[4:7], v[236:239], a[96:111]
    ds_read_b64_tr_b16 a[22:23], v13 offset:3072
    buffer_load_dwordx4 v[188:191], v17, s[32:35], s68 offen offset:3072 sc1
    v_cos_f32 v47, v43
    s_waitcnt lgkmcnt(4)
    v_mfma_f32_32x32x16_bf16 a[48:63], a[8:11], v[240:243], a[48:63]
    ds_read_b64_tr_b16 a[0:1], v12 offset:49152
    v_sin_f32_e64 v48, -v40
    s_waitcnt vmcnt(8)
    v_mfma_f32_32x32x16_bf16 a[64:79], a[12:15], v[240:243], a[64:79]
    ds_read_b64_tr_b16 a[2:3], v12 offset:50176
    buffer_load_dword v24, v18, s[32:35], s76 offen sc1
    buffer_load_dword v25, v19, s[32:35], s76 offen sc1
    v_mfma_f32_32x32x16_bf16 a[80:95], a[8:11], v[244:247], a[80:95]
    ds_read_b64_tr_b16 a[4:5], v13 offset:49152
    v_add3_u32 v30, v128, v129, v30
    v_add3_u32 v30, v130, v131, v30
    v_add3_u32 v30, v136, v137, v30
    v_add3_u32 v30, v138, v139, v30
    v_add3_u32 v30, v144, v145, v30
    v_mfma_f32_32x32x16_bf16 a[96:111], a[12:15], v[244:247], a[96:111]
    ds_read_b64_tr_b16 a[6:7], v13 offset:50176
    s_add_u32 m0, s50, 114688
    s_xor_b32 s51, s63, 0
    s_add_u32 s51, s51, 0xa00000
    buffer_load_dwordx4 v38, s[32:35], s51 offen offset:0 sc1 lds
    s_waitcnt lgkmcnt(4)
    v_mfma_f32_32x32x16_bf16 a[48:63], a[16:19], v[248:251], a[48:63]
    ds_read_b64_tr_b16 a[8:9], v12 offset:51200
    v_add3_u32 v30, v146, v147, v30
    v_add3_u32 v30, v152, v153, v30
    v_add3_u32 v30, v154, v155, v30
    v_add3_u32 v31, v132, v133, v31
    v_add3_u32 v31, v134, v135, v31
    v_mfma_f32_32x32x16_bf16 a[64:79], a[20:23], v[248:251], a[64:79]
    ds_read_b64_tr_b16 a[10:11], v12 offset:52224
    buffer_load_dwordx4 v38, s[32:35], s51 offen offset:1024 sc1 lds
    v_add3_u32 v31, v140, v141, v31
    v_add3_u32 v31, v142, v143, v31
    v_mfma_f32_32x32x16_bf16 a[80:95], a[16:19], v[252:255], a[80:95]
    ds_read_b64_tr_b16 a[12:13], v13 offset:51200
    v_add3_u32 v31, v148, v149, v31
    v_add3_u32 v31, v150, v151, v31
    v_add3_u32 v31, v156, v157, v31
    v_add3_u32 v31, v158, v159, v31
    v_bitop3_b32 v30, v30, v31, s60 bitop3:0x7e
    v_mfma_f32_32x32x16_bf16 a[96:111], a[20:23], v[252:255], a[96:111]
    ds_read_b64_tr_b16 a[14:15], v13 offset:52224
    buffer_load_dwordx4 v38, s[32:35], s51 offen offset:2048 sc1 lds
    v_cmp_ne_u32 vcc, 0, v30
    s_cbranch_vccnz L_spin_42
L_ok_41:
    s_waitcnt lgkmcnt(4)
    v_mfma_f32_32x32x16_bf16 a[48:63], a[0:3], v[128:131], a[48:63]
    v_add_u32 v12, 0x10000, v12
    v_add_u32 v13, 0x10000, v13
    v_add_u32 v14, 0x10000, v14
    ds_read_b64_tr_b16 a[16:17], v12 offset:0
    v_sin_f32_e64 v49, -v41
    v_mfma_f32_32x32x16_bf16 a[64:79], a[4:7], v[128:131], a[64:79]
    ds_read_b64_tr_b16 a[18:19], v12 offset:1024
    buffer_load_dwordx4 v38, s[32:35], s51 offen offset:3072 sc1 lds
    s_sub_u32 s52, s51, 0xa00000
    s_lshr_b32 s52, s52, 3
    s_add_u32 s52, s52, 0xd40000
    buffer_load_dwordx2 v[4:5], v35, s[32:35], s52 offen sc1
    v_mfma_f32_32x32x16_bf16 a[80:95], a[0:3], v[132:135], a[80:95]
    ds_read_b64_tr_b16 a[20:21], v13 offset:0
    v_sin_f32_e64 v50, -v42
    v_sin_f32_e64 v51, -v43
    v_cvt_pk_bf16_f32 v76, v44, v45
    v_mfma_f32_32x32x16_bf16 a[96:111], a[4:7], v[132:135], a[96:111]
    ds_read_b64_tr_b16 a[22:23], v13 offset:1024
    s_add_u32 m0, s50, 81920
    s_xor_b32 s51, s63, 0
    s_add_u32 s51, s51, 0xa04000
    buffer_load_dwordx4 v38, s[32:35], s51 offen offset:0 sc1 lds
    s_waitcnt lgkmcnt(4)
    v_mfma_f32_32x32x16_bf16 a[48:63], a[8:11], v[136:139], a[48:63]
    ds_read_b64_tr_b16 a[0:1], v12 offset:2048
    v_cvt_pk_bf16_f32 v92, v48, v49
    v_cndmask_b32 v108, v76, v92, s[84:85]
    v_cndmask_b32 v124, v92, v76, s[84:85]
    v_xor_b32 v108, v58, v108
    v_xor_b32 v124, v59, v124
    v_mfma_f32_32x32x16_bf16 a[64:79], a[12:15], v[136:139], a[64:79]
    ds_read_b64_tr_b16 a[2:3], v12 offset:3072
    buffer_load_dwordx4 v38, s[32:35], s51 offen offset:1024 sc1 lds
    v_cvt_pk_bf16_f32 v77, v46, v47
    v_cvt_pk_bf16_f32 v93, v50, v51
    v_mfma_f32_32x32x16_bf16 a[80:95], a[8:11], v[140:143], a[80:95]
    ds_read_b64_tr_b16 a[4:5], v13 offset:2048
    v_cndmask_b32 v109, v77, v93, s[84:85]
    v_cndmask_b32 v125, v93, v77, s[84:85]
    v_xor_b32 v109, v58, v109
    v_xor_b32 v125, v59, v125
    v_fmamk_f32 v40, v61, 0x41c80000, v60
    v_mfma_f32_32x32x16_bf16 a[96:111], a[12:15], v[140:143], a[96:111]
    ds_read_b64_tr_b16 a[6:7], v13 offset:3072
    buffer_load_dwordx4 v38, s[32:35], s51 offen offset:2048 sc1 lds
    v_fmamk_f32 v41, v61, 0x41d00000, v60
    v_fmamk_f32 v42, v61, 0x41d80000, v60
    s_waitcnt lgkmcnt(4)
    v_mfma_f32_32x32x16_bf16 a[48:63], a[16:19], v[144:147], a[48:63]
    v_add_u32 v12, 0xffff0000, v12
    v_add_u32 v13, 0xffff0000, v13
    v_add_u32 v14, 0xffff0000, v14
    ds_read_b64_tr_b16 a[8:9], v12 offset:16384
    v_fmamk_f32 v43, v61, 0x41e00000, v60
    v_cos_f32 v44, v40
    buffer_load_dwordx4 v38, s[32:35], s51 offen offset:3072 sc1 lds
    s_sub_u32 s52, s51, 0xa00000
    s_lshr_b32 s52, s52, 3
    s_add_u32 s52, s52, 0xd40000
    buffer_load_dwordx2 v[6:7], v35, s[32:35], s52 offen sc1
    s_waitcnt vmcnt(10)
    v_mfma_f32_32x32x16_bf16 a[64:79], a[20:23], v[144:147], a[64:79]
    ds_read_b64_tr_b16 a[10:11], v12 offset:17408
    s_add_u32 m0, s50, 32768
    s_xor_b32 s51, s63, 32768
    s_add_u32 s51, s51, 0xa00000
    buffer_load_dwordx4 v38, s[32:35], s51 offen offset:0 sc1 lds
    v_mfma_f32_32x32x16_bf16 a[80:95], a[16:19], v[148:151], a[80:95]
    ds_read_b64_tr_b16 a[12:13], v13 offset:16384
    v_add3_u32 v24, v160, v161, v24
    v_add3_u32 v24, v162, v163, v24
    v_add3_u32 v24, v168, v169, v24
    v_add3_u32 v24, v170, v171, v24
    v_add3_u32 v24, v176, v177, v24
    v_mfma_f32_32x32x16_bf16 a[96:111], a[20:23], v[148:151], a[96:111]
    ds_read_b64_tr_b16 a[14:15], v13 offset:17408
    buffer_load_dwordx4 v38, s[32:35], s51 offen offset:1024 sc1 lds
    v_add3_u32 v24, v178, v179, v24
    v_add3_u32 v24, v184, v185, v24
    s_waitcnt lgkmcnt(4)
    v_mfma_f32_32x32x16_bf16 a[48:63], a[0:3], v[152:155], a[48:63]
    ds_read_b64_tr_b16 a[16:17], v12 offset:18432
    v_add3_u32 v24, v186, v187, v24
    v_add3_u32 v25, v164, v165, v25
    v_add3_u32 v25, v166, v167, v25
    v_add3_u32 v25, v172, v173, v25
    v_add3_u32 v25, v174, v175, v25
    v_mfma_f32_32x32x16_bf16 a[64:79], a[4:7], v[152:155], a[64:79]
    ds_read_b64_tr_b16 a[18:19], v12 offset:19456
    buffer_load_dwordx4 v38, s[32:35], s51 offen offset:2048 sc1 lds
    v_add3_u32 v25, v180, v181, v25
    v_add3_u32 v25, v182, v183, v25
    v_mfma_f32_32x32x16_bf16 a[80:95], a[0:3], v[156:159], a[80:95]
    ds_read_b64_tr_b16 a[20:21], v13 offset:18432
    v_add3_u32 v25, v188, v189, v25
    v_add3_u32 v25, v190, v191, v25
    v_bitop3_b32 v24, v24, v25, s60 bitop3:0x7e
    v_cmp_ne_u32 vcc, 0, v24
    s_cbranch_vccnz L_spin_44
L_ok_43:
    v_mfma_f32_32x32x16_bf16 a[96:111], a[4:7], v[156:159], a[96:111]
    ds_read_b64_tr_b16 a[22:23], v13 offset:19456
    buffer_load_dwordx4 v38, s[32:35], s51 offen offset:3072 sc1 lds
    s_sub_u32 s52, s51, 0xa00000
    s_lshr_b32 s52, s52, 3
    s_add_u32 s52, s52, 0xd40000
    buffer_load_dwordx2 v[20:21], v35, s[32:35], s52 offen sc1
    s_waitcnt lgkmcnt(4)
    v_mfma_f32_32x32x16_bf16 a[48:63], a[8:11], v[160:163], a[48:63]
    v_add_u32 v12, 0x10000, v12
    v_add_u32 v13, 0x10000, v13
    v_add_u32 v14, 0x10000, v14
    ds_read_b64_tr_b16 a[0:1], v12 offset:32768
    v_cos_f32 v45, v41
    v_mfma_f32_32x32x16_bf16 a[64:79], a[12:15], v[160:163], a[64:79]
    ds_read_b64_tr_b16 a[2:3], v12 offset:33792
    s_add_u32 m0, s50, 131072
    s_xor_b32 s51, s63, 32768
    s_add_u32 s51, s51, 0xa04000
    buffer_load_dwordx4 v38, s[32:35], s51 offen offset:0 sc1 lds
    v_mfma_f32_32x32x16_bf16 a[80:95], a[8:11], v[164:167], a[80:95]
    ds_read_b64_tr_b16 a[4:5], v13 offset:32768
    v_cos_f32 v46, v42
    v_cos_f32 v47, v43
    v_mfma_f32_32x32x16_bf16 a[96:111], a[12:15], v[164:167], a[96:111]
    ds_read_b64_tr_b16 a[6:7], v13 offset:33792
    buffer_load_dwordx4 v38, s[32:35], s51 offen offset:1024 sc1 lds
    v_sin_f32_e64 v48, -v40
    s_waitcnt lgkmcnt(4)
    v_mfma_f32_32x32x16_bf16 a[48:63], a[16:19], v[168:171], a[48:63]
    ds_read_b64_tr_b16 a[8:9], v12 offset:34816
    v_sin_f32_e64 v49, -v41
    v_sin_f32_e64 v50, -v42
    v_mfma_f32_32x32x16_bf16 a[64:79], a[20:23], v[168:171], a[64:79]
    ds_read_b64_tr_b16 a[10:11], v12 offset:35840
    buffer_load_dwordx4 v38, s[32:35], s51 offen offset:2048 sc1 lds
    v_sin_f32_e64 v51, -v43
    v_mfma_f32_32x32x16_bf16 a[80:95], a[16:19], v[172:175], a[80:95]
    ds_read_b64_tr_b16 a[12:13], v13 offset:34816
    v_cvt_pk_bf16_f32 v78, v44, v45
    v_cvt_pk_bf16_f32 v94, v48, v49
    v_cndmask_b32 v110, v78, v94, s[84:85]
    v_cndmask_b32 v126, v94, v78, s[84:85]
    v_xor_b32 v110, v58, v110
    v_mfma_f32_32x32x16_bf16 a[96:111], a[20:23], v[172:175], a[96:111]
    ds_read_b64_tr_b16 a[14:15], v13 offset:35840
    buffer_load_dwordx4 v38, s[32:35], s51 offen offset:3072 sc1 lds
    s_sub_u32 s52, s51, 0xa00000
    s_lshr_b32 s52, s52, 3
    s_add_u32 s52, s52, 0xd40000
    buffer_load_dwordx2 v[22:23], v35, s[32:35], s52 offen sc1
    s_waitcnt lgkmcnt(4)
    v_mfma_f32_32x32x16_bf16 a[48:63], a[0:3], v[176:179], a[48:63]
    v_xor_b32 v126, v59, v126
    v_cvt_pk_bf16_f32 v79, v46, v47
    v_cvt_pk_bf16_f32 v95, v50, v51
    v_cndmask_b32 v111, v79, v95, s[84:85]
    v_cndmask_b32 v127, v95, v79, s[84:85]
    v_xor_b32 v111, v58, v111
    v_mfma_f32_32x32x16_bf16 a[64:79], a[4:7], v[176:179], a[64:79]
    v_xor_b32 v127, v59, v127
    s_waitcnt vmcnt(15)
    ds_read_b128 v[40:43], v14 offset:49152
    ds_read_b128 v[44:47], v14 offset:49216
    ds_read_b128 v[48:51], v14 offset:49168
    ds_read_b128 v[52:55], v14 offset:49232
    v_mfma_f32_32x32x16_bf16 a[80:95], a[0:3], v[180:183], a[80:95]
    buffer_load_dwordx4 v[192:195], v16, s[32:35], s69 offen offset:0 sc1
    v_mfma_f32_32x32x16_bf16 a[96:111], a[4:7], v[180:183], a[96:111]
    s_waitcnt lgkmcnt(4)
    v_mfma_f32_32x32x16_bf16 a[48:63], a[8:11], v[184:187], a[48:63]
    buffer_load_dwordx4 v[196:199], v17, s[32:35], s69 offen offset:0 sc1
    v_mfma_f32_32x32x16_bf16 a[64:79], a[12:15], v[184:187], a[64:79]
    v_mfma_f32_32x32x16_bf16 a[80:95], a[8:11], v[188:191], a[80:95]
    buffer_load_dwordx4 v[200:203], v16, s[32:35], s69 offen offset:1024 sc1
    s_waitcnt lgkmcnt(0)
    v_add3_u32 v4, v40, v41, v4
    v_add3_u32 v4, v42, v43, v4
    v_mfma_f32_32x32x16_bf16 a[96:111], a[12:15], v[188:191], a[96:111]
    v_add3_u32 v4, v44, v45, v4
    v_add3_u32 v4, v46, v47, v4
    v_add3_u32 v5, v48, v49, v5
    v_add3_u32 v5, v50, v51, v5
    v_add3_u32 v5, v52, v53, v5
    v_add3_u32 v5, v54, v55, v5
    v_bitop3_b32 v4, v4, v5, s60 bitop3:0x7e
    v_cmp_ne_u32 vcc, 0, v4
    s_cbranch_vccnz L_spin_46
L_ok_45:
    ds_read_b64_tr_b16 a[112:113], v12 offset:49152
    ds_read_b64_tr_b16 a[114:115], v12 offset:50176
    ds_read_b64_tr_b16 a[120:121], v13 offset:49152
    ds_read_b64_tr_b16 a[122:123], v13 offset:50176
    ds_read_b64_tr_b16 a[116:117], v12 offset:51200
    ds_read_b64_tr_b16 a[118:119], v12 offset:52224
    ds_read_b64_tr_b16 a[124:125], v13 offset:51200
    ds_read_b64_tr_b16 a[126:127], v13 offset:52224
    buffer_load_dwordx4 v[204:207], v17, s[32:35], s69 offen offset:1024 sc1
    s_waitcnt vmcnt(14)
    ds_read_b128 v[40:43], v14 offset:16384
    ds_read_b128 v[44:47], v14 offset:16448
    ds_read_b128 v[48:51], v14 offset:16400
    ds_read_b128 v[52:55], v14 offset:16464
    s_waitcnt lgkmcnt(0)
    v_add3_u32 v6, v40, v41, v6
    v_add3_u32 v6, v42, v43, v6
    buffer_load_dwordx4 v[208:211], v16, s[32:35], s69 offen offset:2048 sc1
    v_add3_u32 v6, v44, v45, v6
    v_add3_u32 v6, v46, v47, v6
    v_add3_u32 v7, v48, v49, v7
    v_add3_u32 v7, v50, v51, v7
    v_add3_u32 v7, v52, v53, v7
    v_add3_u32 v7, v54, v55, v7
    v_bitop3_b32 v6, v6, v7, s60 bitop3:0x7e
    v_cmp_ne_u32 vcc, 0, v6
    s_cbranch_vccnz L_spin_48
L_ok_47:
    v_mfma_f32_32x32x16_bf16 v[128:143], a[112:115], a[24:27], 0
    ds_read_b64_tr_b16 a[128:129], v12 offset:16384
    ds_read_b64_tr_b16 a[130:131], v12 offset:17408
    buffer_load_dwordx2 v[56:57], v36, s[8:11], s7 offen offset:0
    s_waitcnt vmcnt(11)
    v_add_u32 v12, 0xffff0000, v12
    v_add_u32 v13, 0xffff0000, v13
    v_add_u32 v14, 0xffff0000, v14
    ds_read_b128 v[40:43], v14 offset:32768
    ds_read_b128 v[44:47], v14 offset:32832
    ds_read_b128 v[48:51], v14 offset:32784
    ds_read_b128 v[52:55], v14 offset:32848
    v_mfma_f32_32x32x16_bf16 v[144:159], a[120:123], a[24:27], 0
    v_add_u32 v12, 0x10000, v12
    v_add_u32 v13, 0x10000, v13
    v_add_u32 v14, 0x10000, v14
    ds_read_b64_tr_b16 a[136:137], v13 offset:16384
    ds_read_b64_tr_b16 a[138:139], v13 offset:17408
    buffer_load_dwordx2 v[58:59], v36, s[8:11], s7 offen offset:16
    v_mfma_f32_32x32x16_bf16 v[128:143], a[120:123], a[40:43], v[128:143]
    ds_read_b64_tr_b16 a[132:133], v12 offset:18432
    v_mfma_f32_32x32x16_bf16 v[144:159], a[112:115], a[32:35], v[144:159]
    ds_read_b64_tr_b16 a[134:135], v12 offset:19456
    buffer_load_dwordx2 v[60:61], v36, s[8:11], s7 offen offset:32
    v_mfma_f32_32x32x16_bf16 v[128:143], a[116:119], a[28:31], v[128:143]
    ds_read_b64_tr_b16 a[140:141], v13 offset:18432
    s_waitcnt lgkmcnt(5)
    v_add3_u32 v20, v40, v41, v20
    v_add3_u32 v20, v42, v43, v20
    v_add3_u32 v20, v44, v45, v20
    v_add3_u32 v20, v46, v47, v20
    v_mfma_f32_32x32x16_bf16 v[144:159], a[124:127], a[28:31], v[144:159]
    ds_read_b64_tr_b16 a[142:143], v13 offset:19456
    buffer_load_dwordx2 v[62:63], v36, s[8:11], s7 offen offset:48
    v_add3_u32 v21, v48, v49, v21
    v_add3_u32 v21, v50, v51, v21
    v_mfma_f32_32x32x16_bf16 v[128:143], a[124:127], a[44:47], v[128:143]
    v_add3_u32 v21, v52, v53, v21
    v_add3_u32 v21, v54, v55, v21
    v_bitop3_b32 v20, v20, v21, s60 bitop3:0x7e
    v_cmp_ne_u32 vcc, 0, v20
    s_cbranch_vccnz L_spin_50
L_ok_49:
    s_waitcnt vmcnt(9)
    v_add_u32 v12, 0x10000, v12
    v_add_u32 v13, 0x10000, v13
    v_add_u32 v14, 0x10000, v14
    ds_read_b128 v[40:43], v14 offset:0
    ds_read_b128 v[44:47], v14 offset:64
    ds_read_b128 v[48:51], v14 offset:16
    ds_read_b128 v[52:55], v14 offset:80
    v_mfma_f32_32x32x16_bf16 v[144:159], a[116:119], a[36:39], v[144:159]
    buffer_load_dwordx4 v[212:215], v17, s[32:35], s69 offen offset:2048 sc1
    s_waitcnt lgkmcnt(4)
    v_mfma_f32_32x32x16_bf16 v[160:175], a[128:131], a[24:27], 0
    v_mfma_f32_32x32x16_bf16 v[176:191], a[136:139], a[24:27], 0
    buffer_load_dwordx4 v[216:219], v16, s[32:35], s69 offen offset:3072 sc1
    v_mfma_f32_32x32x16_bf16 v[160:175], a[136:139], a[40:43], v[160:175]
    v_cvt_pk_bf16_f32 v128, v128, v129
    v_cvt_pk_bf16_f32 v129, v130, v131
    v_cvt_pk_bf16_f32 v130, v132, v133
    v_cvt_pk_bf16_f32 v131, v134, v135
    s_waitcnt lgkmcnt(0)
    v_add3_u32 v22, v40, v41, v22
    v_mfma_f32_32x32x16_bf16 v[176:191], a[128:131], a[32:35], v[176:191]
    v_cvt_pk_bf16_f32 v132, v136, v137
    v_cvt_pk_bf16_f32 v133, v138, v139
    v_cvt_pk_bf16_f32 v134, v140, v141
    v_cvt_pk_bf16_f32 v135, v142, v143
    buffer_load_dwordx4 v[220:223], v17, s[32:35], s69 offen offset:3072 sc1
    v_mfma_f32_32x32x16_bf16 v[160:175], a[132:135], a[28:31], v[160:175]
    v_cvt_pk_bf16_f32 v144, v144, v145
    v_cvt_pk_bf16_f32 v145, v146, v147
    v_cvt_pk_bf16_f32 v146, v148, v149
    v_cvt_pk_bf16_f32 v147, v150, v151
    v_add3_u32 v22, v42, v43, v22
    v_add3_u32 v22, v44, v45, v22
    v_mfma_f32_32x32x16_bf16 v[176:191], a[140:143], a[28:31], v[176:191]
    v_cvt_pk_bf16_f32 v148, v152, v153
    v_cvt_pk_bf16_f32 v149, v154, v155
    v_cvt_pk_bf16_f32 v150, v156, v157
    v_cvt_pk_bf16_f32 v151, v158, v159
    buffer_load_dword v26, v18, s[32:35], s77 offen sc1
    buffer_load_dword v27, v19, s[32:35], s77 offen sc1
    v_mfma_f32_32x32x16_bf16 v[160:175], a[140:143], a[44:47], v[160:175]
    v_add3_u32 v22, v46, v47, v22
    v_add3_u32 v23, v48, v49, v23
    v_add3_u32 v23, v50, v51, v23
    v_add3_u32 v23, v52, v53, v23
    v_add3_u32 v23, v54, v55, v23
    v_bitop3_b32 v22, v22, v23, s60 bitop3:0x7e
    v_mfma_f32_32x32x16_bf16 v[176:191], a[132:135], a[36:39], v[176:191]
    v_cmp_ne_u32 vcc, 0, v22
    s_cbranch_vccnz L_spin_52
L_ok_51:
    v_mfma_f32_32x32x16_bf16 a[48:63], v[64:67], v[128:131], a[48:63]
    v_add_u32 v12, 0xfffe0000, v12
    v_add_u32 v13, 0xfffe0000, v13
    v_add_u32 v14, 0xfffe0000, v14
    ds_read_b64_tr_b16 a[112:113], v12 offset:32768
    ds_read_b64_tr_b16 a[114:115], v12 offset:33792
    s_add_u32 m0, s50, 0
    s_lshl_b32 s51, s69, 4
    s_add_u32 s51, s51, s59
    buffer_load_dwordx4 v8, s[16:19], s51 offen offset:0 lds
    v_mfma_f32_32x32x16_bf16 a[64:79], v[68:71], v[128:131], a[64:79]
    ds_read_b64_tr_b16 a[120:121], v13 offset:32768
    ds_read_b64_tr_b16 a[122:123], v13 offset:33792
    v_mfma_f32_32x32x16_bf16 a[48:63], v[72:75], v[132:135], a[48:63]
    ds_read_b64_tr_b16 a[116:117], v12 offset:34816
    buffer_load_dwordx4 v9, s[16:19], s51 offen offset:1024 lds
    v_mfma_f32_32x32x16_bf16 a[64:79], v[76:79], v[132:135], a[64:79]
    ds_read_b64_tr_b16 a[118:119], v12 offset:35840
    v_mfma_f32_32x32x16_bf16 a[48:63], v[80:83], v[144:147], a[48:63]
    ds_read_b64_tr_b16 a[124:125], v13 offset:34816
    buffer_load_dwordx4 v10, s[16:19], s51 offen offset:2048 lds
    v_mfma_f32_32x32x16_bf16 a[64:79], v[84:87], v[144:147], a[64:79]
    ds_read_b64_tr_b16 a[126:127], v13 offset:35840
    v_mfma_f32_32x32x16_bf16 a[48:63], v[88:91], v[148:151], a[48:63]
    buffer_load_dwordx4 v11, s[16:19], s51 offen offset:3072 lds
    v_mfma_f32_32x32x16_bf16 a[64:79], v[92:95], v[148:151], a[64:79]
    s_waitcnt lgkmcnt(0)
    v_mfma_f32_32x32x16_bf16 v[128:143], a[112:115], a[24:27], 0
    s_add_u32 m0, s50, 49152
    s_lshl_b32 s51, s69, 4
    s_add_u32 s51, s51, s59
    s_add_u32 s51, s51, 32768
    buffer_load_dwordx4 v8, s[16:19], s51 offen offset:0 lds
    v_mfma_f32_32x32x16_bf16 v[144:159], a[120:123], a[24:27], 0
    v_mfma_f32_32x32x16_bf16 v[128:143], a[120:123], a[40:43], v[128:143]
    v_cvt_pk_bf16_f32 v160, v160, v161
    v_cvt_pk_bf16_f32 v161, v162, v163
    v_cvt_pk_bf16_f32 v162, v164, v165
    v_cvt_pk_bf16_f32 v163, v166, v167
    buffer_load_dwordx4 v9, s[16:19], s51 offen offset:1024 lds
    v_mfma_f32_32x32x16_bf16 v[144:159], a[112:115], a[32:35], v[144:159]
    v_cvt_pk_bf16_f32 v164, v168, v169
    v_cvt_pk_bf16_f32 v165, v170, v171
    v_cvt_pk_bf16_f32 v166, v172, v173
    v_cvt_pk_bf16_f32 v167, v174, v175
    v_mfma_f32_32x32x16_bf16 v[128:143], a[116:119], a[28:31], v[128:143]
    v_cvt_pk_bf16_f32 v176, v176, v177
    v_cvt_pk_bf16_f32 v177, v178, v179
    v_cvt_pk_bf16_f32 v178, v180, v181
    v_cvt_pk_bf16_f32 v179, v182, v183
    buffer_load_dwordx4 v10, s[16:19], s51 offen offset:2048 lds
    v_mfma_f32_32x32x16_bf16 v[144:159], a[124:127], a[28:31], v[144:159]
    v_cvt_pk_bf16_f32 v180, v184, v185
    v_cvt_pk_bf16_f32 v181, v186, v187
    v_cvt_pk_bf16_f32 v182, v188, v189
    v_cvt_pk_bf16_f32 v183, v190, v191
    v_mfma_f32_32x32x16_bf16 v[128:143], a[124:127], a[44:47], v[128:143]
    v_mfma_f32_32x32x16_bf16 v[144:159], a[116:119], a[36:39], v[144:159]
    buffer_load_dwordx4 v11, s[16:19], s51 offen offset:3072 lds
    v_mfma_f32_32x32x16_bf16 a[48:63], v[96:99], v[160:163], a[48:63]
    v_add_u32 v12, 0x20000, v12
    v_add_u32 v13, 0x20000, v13
    v_add_u32 v14, 0x20000, v14
    ds_read_b64_tr_b16 a[128:129], v12 offset:0
    ds_read_b64_tr_b16 a[130:131], v12 offset:1024
    v_mfma_f32_32x32x16_bf16 a[64:79], v[100:103], v[160:163], a[64:79]
    ds_read_b64_tr_b16 a[136:137], v13 offset:0
    ds_read_b64_tr_b16 a[138:139], v13 offset:1024
    buffer_load_dwordx4 v[224:227], v16, s[32:35], s70 offen offset:0 sc1
    v_mfma_f32_32x32x16_bf16 a[48:63], v[104:107], v[164:167], a[48:63]
    ds_read_b64_tr_b16 a[132:133], v12 offset:2048
    v_mfma_f32_32x32x16_bf16 a[64:79], v[108:111], v[164:167], a[64:79]
    ds_read_b64_tr_b16 a[134:135], v12 offset:3072
    buffer_load_dwordx4 v[228:231], v17, s[32:35], s70 offen offset:0 sc1
    v_mfma_f32_32x32x16_bf16 a[48:63], v[112:115], v[176:179], a[48:63]
    ds_read_b64_tr_b16 a[140:141], v13 offset:2048
    v_mfma_f32_32x32x16_bf16 a[64:79], v[116:119], v[176:179], a[64:79]
    ds_read_b64_tr_b16 a[142:143], v13 offset:3072
    buffer_load_dwordx4 v[232:235], v16, s[32:35], s70 offen offset:1024 sc1
    v_mfma_f32_32x32x16_bf16 a[48:63], v[120:123], v[180:183], a[48:63]
    v_mfma_f32_32x32x16_bf16 a[64:79], v[124:127], v[180:183], a[64:79]
    buffer_load_dwordx4 v[236:239], v17, s[32:35], s70 offen offset:1024 sc1
    s_waitcnt lgkmcnt(0)
    v_mfma_f32_32x32x16_bf16 v[160:175], a[128:131], a[24:27], 0
    buffer_load_dwordx4 v[240:243], v16, s[32:35], s70 offen offset:2048 sc1
    v_mfma_f32_32x32x16_bf16 v[176:191], a[136:139], a[24:27], 0
    v_mfma_f32_32x32x16_bf16 v[160:175], a[136:139], a[40:43], v[160:175]
    v_cvt_pk_bf16_f32 v128, v128, v129
    v_cvt_pk_bf16_f32 v129, v130, v131
    v_cvt_pk_bf16_f32 v130, v132, v133
    v_cvt_pk_bf16_f32 v131, v134, v135
    buffer_load_dwordx4 v[244:247], v17, s[32:35], s70 offen offset:2048 sc1
    v_mfma_f32_32x32x16_bf16 v[176:191], a[128:131], a[32:35], v[176:191]
    v_cvt_pk_bf16_f32 v132, v136, v137
    v_cvt_pk_bf16_f32 v133, v138, v139
    v_cvt_pk_bf16_f32 v134, v140, v141
    v_cvt_pk_bf16_f32 v135, v142, v143
    v_mfma_f32_32x32x16_bf16 v[160:175], a[132:135], a[28:31], v[160:175]
    v_cvt_pk_bf16_f32 v144, v144, v145
    v_cvt_pk_bf16_f32 v145, v146, v147
    v_cvt_pk_bf16_f32 v146, v148, v149
    v_cvt_pk_bf16_f32 v147, v150, v151
    buffer_load_dwordx4 v[248:251], v16, s[32:35], s70 offen offset:3072 sc1
    v_mfma_f32_32x32x16_bf16 v[176:191], a[140:143], a[28:31], v[176:191]
    v_cvt_pk_bf16_f32 v148, v152, v153
    v_cvt_pk_bf16_f32 v149, v154, v155
    v_cvt_pk_bf16_f32 v150, v156, v157
    v_cvt_pk_bf16_f32 v151, v158, v159
    v_mfma_f32_32x32x16_bf16 v[160:175], a[140:143], a[44:47], v[160:175]
    v_mfma_f32_32x32x16_bf16 v[176:191], a[132:135], a[36:39], v[176:191]
    buffer_load_dwordx4 v[252:255], v17, s[32:35], s70 offen offset:3072 sc1
    v_mfma_f32_32x32x16_bf16 a[80:95], v[64:67], v[128:131], a[80:95]
    s_waitcnt vmcnt(16)
    v_add3_u32 v26, v192, v193, v26
    v_add3_u32 v26, v194, v195, v26
    v_add3_u32 v26, v200, v201, v26
    v_add3_u32 v26, v202, v203, v26
    v_add3_u32 v26, v208, v209, v26
    v_mfma_f32_32x32x16_bf16 a[96:111], v[68:71], v[128:131], a[96:111]
    buffer_load_dword v28, v18, s[32:35], s78 offen sc1
    buffer_load_dword v29, v19, s[32:35], s78 offen sc1
    v_mfma_f32_32x32x16_bf16 a[80:95], v[72:75], v[132:135], a[80:95]
    v_cvt_pk_bf16_f32 v160, v160, v161
    v_cvt_pk_bf16_f32 v161, v162, v163
    v_cvt_pk_bf16_f32 v162, v164, v165
    v_cvt_pk_bf16_f32 v163, v166, v167
    v_add3_u32 v26, v210, v211, v26
    v_add3_u32 v26, v216, v217, v26
    v_mfma_f32_32x32x16_bf16 a[96:111], v[76:79], v[132:135], a[96:111]
    v_cvt_pk_bf16_f32 v164, v168, v169
    v_cvt_pk_bf16_f32 v165, v170, v171
    v_cvt_pk_bf16_f32 v166, v172, v173
    v_cvt_pk_bf16_f32 v167, v174, v175
    s_add_u32 m0, s50, 65536
    s_lshl_b32 s51, s70, 4
    s_add_u32 s51, s51, s59
    buffer_load_dwordx4 v8, s[16:19], s51 offen offset:0 lds
    v_mfma_f32_32x32x16_bf16 a[80:95], v[80:83], v[144:147], a[80:95]
    v_cvt_pk_bf16_f32 v176, v176, v177
    v_cvt_pk_bf16_f32 v177, v178, v179
    v_cvt_pk_bf16_f32 v178, v180, v181
    v_cvt_pk_bf16_f32 v179, v182, v183
    v_add3_u32 v26, v218, v219, v26
    v_add3_u32 v27, v196, v197, v27
    v_mfma_f32_32x32x16_bf16 a[96:111], v[84:87], v[144:147], a[96:111]
    v_cvt_pk_bf16_f32 v180, v184, v185
    v_cvt_pk_bf16_f32 v181, v186, v187
    v_cvt_pk_bf16_f32 v182, v188, v189
    v_cvt_pk_bf16_f32 v183, v190, v191
    buffer_load_dwordx4 v9, s[16:19], s51 offen offset:1024 lds
    v_mfma_f32_32x32x16_bf16 a[80:95], v[88:91], v[148:151], a[80:95]
    v_add3_u32 v27, v198, v199, v27
    v_add3_u32 v27, v204, v205, v27
    v_add3_u32 v27, v206, v207, v27
    v_add3_u32 v27, v212, v213, v27
    v_add3_u32 v27, v214, v215, v27
    v_add3_u32 v27, v220, v221, v27
    v_mfma_f32_32x32x16_bf16 a[96:111], v[92:95], v[148:151], a[96:111]
    v_add3_u32 v27, v222, v223, v27
    v_bitop3_b32 v26, v26, v27, s60 bitop3:0x7e
    v_cmp_ne_u32 vcc, 0, v26
    s_cbranch_vccnz L_spin_54
L_ok_53:
    v_mfma_f32_32x32x16_bf16 a[80:95], v[96:99], v[160:163], a[80:95]
    buffer_load_dwordx4 v10, s[16:19], s51 offen offset:2048 lds
    s_waitcnt vmcnt(17)
    v_add_u32 v12, 0xfffe0000, v12
    v_add_u32 v13, 0xfffe0000, v13
    v_add_u32 v14, 0xfffe0000, v14
    ds_read_b64_tr_b16 a[16:17], v12 offset:0
    ds_read_b64_tr_b16 a[18:19], v12 offset:1024
    v_mfma_f32_32x32x16_bf16 a[96:111], v[100:103], v[160:163], a[96:111]
    ds_read_b64_tr_b16 a[20:21], v13 offset:0
    ds_read_b64_tr_b16 a[22:23], v13 offset:1024
    v_mfma_f32_32x32x16_bf16 a[80:95], v[104:107], v[164:167], a[80:95]
    ds_read_b64_tr_b16 a[0:1], v12 offset:2048
    buffer_load_dwordx4 v11, s[16:19], s51 offen offset:3072 lds
    v_mfma_f32_32x32x16_bf16 a[96:111], v[108:111], v[164:167], a[96:111]
    ds_read_b64_tr_b16 a[2:3], v12 offset:3072
    v_mfma_f32_32x32x16_bf16 a[80:95], v[112:115], v[176:179], a[80:95]
    ds_read_b64_tr_b16 a[4:5], v13 offset:2048
    s_add_u32 m0, s50, 16384
    s_lshl_b32 s51, s70, 4
    s_add_u32 s51, s51, s59
    s_add_u32 s51, s51, 32768
    buffer_load_dwordx4 v8, s[16:19], s51 offen offset:0 lds
    v_mfma_f32_32x32x16_bf16 a[96:111], v[116:119], v[176:179], a[96:111]
    ds_read_b64_tr_b16 a[6:7], v13 offset:3072
    v_mfma_f32_32x32x16_bf16 a[80:95], v[120:123], v[180:183], a[80:95]
    v_mfma_f32_32x32x16_bf16 a[96:111], v[124:127], v[180:183], a[96:111]
    buffer_load_dwordx4 v9, s[16:19], s51 offen offset:1024 lds
    s_waitcnt lgkmcnt(4)
    v_mfma_f32_32x32x16_bf16 a[48:63], a[16:19], v[192:195], a[48:63]
    s_waitcnt vmcnt(16)
    ds_read_b64_tr_b16 a[8:9], v12 offset:49152
    v_mfma_f32_32x32x16_bf16 a[64:79], a[20:23], v[192:195], a[64:79]
    ds_read_b64_tr_b16 a[10:11], v12 offset:50176
    buffer_load_dwordx4 v10, s[16:19], s51 offen offset:2048 lds
    v_mfma_f32_32x32x16_bf16 a[80:95], a[16:19], v[196:199], a[80:95]
    ds_read_b64_tr_b16 a[12:13], v13 offset:49152
    v_mfma_f32_32x32x16_bf16 a[96:111], a[20:23], v[196:199], a[96:111]
    ds_read_b64_tr_b16 a[14:15], v13 offset:50176
    buffer_load_dwordx4 v11, s[16:19], s51 offen offset:3072 lds
    s_waitcnt lgkmcnt(4)
    v_mfma_f32_32x32x16_bf16 a[48:63], a[0:3], v[200:203], a[48:63]
    ds_read_b64_tr_b16 a[16:17], v12 offset:51200
    v_mfma_f32_32x32x16_bf16 a[64:79], a[4:7], v[200:203], a[64:79]
    ds_read_b64_tr_b16 a[18:19], v12 offset:52224
    v_mfma_f32_32x32x16_bf16 a[80:95], a[0:3], v[204:207], a[80:95]
    ds_read_b64_tr_b16 a[20:21], v13 offset:51200
    v_mfma_f32_32x32x16_bf16 a[96:111], a[4:7], v[204:207], a[96:111]
    ds_read_b64_tr_b16 a[22:23], v13 offset:52224
    s_waitcnt lgkmcnt(4)
    v_mfma_f32_32x32x16_bf16 a[48:63], a[8:11], v[208:211], a[48:63]
    v_lshlrev_b32 v128, 16, v56
    v_and_b32 v129, 0xffff0000, v56
    v_lshlrev_b32 v130, 16, v57
    v_and_b32 v131, 0xffff0000, v57
    v_lshlrev_b32 v132, 16, v58
    v_and_b32 v133, 0xffff0000, v58
    v_lshlrev_b32 v134, 16, v59
    v_and_b32 v135, 0xffff0000, v59
    v_lshlrev_b32 v136, 16, v60
    v_and_b32 v137, 0xffff0000, v60
    v_lshlrev_b32 v138, 16, v61
    v_and_b32 v139, 0xffff0000, v61
    v_lshlrev_b32 v140, 16, v62
    v_and_b32 v141, 0xffff0000, v62
    v_lshlrev_b32 v142, 16, v63
    v_and_b32 v143, 0xffff0000, v63
    v_add_u32 v0, s50, v2
    s_waitcnt vmcnt(4)
    v_add_u32 v12, 0x10000, v12
    v_add_u32 v13, 0x10000, v13
    v_add_u32 v14, 0x10000, v14
    ds_read_b64_tr_b16 a[184:185], v12 offset:0
    ds_read_b64_tr_b16 a[186:187], v12 offset:1024
    v_mfma_f32_32x32x16_bf16 a[64:79], a[12:15], v[208:211], a[64:79]
    ds_read_b64_tr_b16 a[188:189], v13 offset:0
    ds_read_b64_tr_b16 a[190:191], v13 offset:1024
    v_add3_u32 v28, v224, v225, v28
    v_add3_u32 v28, v226, v227, v28
    v_add3_u32 v28, v232, v233, v28
    v_add3_u32 v28, v234, v235, v28
    v_mfma_f32_32x32x16_bf16 a[80:95], a[8:11], v[212:215], a[80:95]
    s_waitcnt vmcnt(0)
    v_add_u32 v12, 0xffff0000, v12
    v_add_u32 v13, 0xffff0000, v13
    v_add_u32 v14, 0xffff0000, v14
    ds_read_b64_tr_b16 a[200:201], v12 offset:16384
    ds_read_b64_tr_b16 a[202:203], v12 offset:17408
    v_mfma_f32_32x32x16_bf16 a[96:111], a[12:15], v[212:215], a[96:111]
    ds_read_b64_tr_b16 a[204:205], v13 offset:16384
    ds_read_b64_tr_b16 a[206:207], v13 offset:17408
    v_add3_u32 v28, v240, v241, v28
    v_add3_u32 v28, v242, v243, v28
    v_add3_u32 v28, v248, v249, v28
    v_add3_u32 v28, v250, v251, v28
    s_waitcnt lgkmcnt(8)
    v_mfma_f32_32x32x16_bf16 a[48:63], a[16:19], v[216:219], a[48:63]
    v_add_u32 v12, 0x10000, v12
    v_add_u32 v13, 0x10000, v13
    v_add_u32 v14, 0x10000, v14
    ds_read_b64_tr_b16 a[192:193], v12 offset:2048
    ds_read_b64_tr_b16 a[194:195], v12 offset:3072
    v_add3_u32 v29, v228, v229, v29
    v_mfma_f32_32x32x16_bf16 a[64:79], a[20:23], v[216:219], a[64:79]
    ds_read_b64_tr_b16 a[196:197], v13 offset:2048
    ds_read_b64_tr_b16 a[198:199], v13 offset:3072
    v_add3_u32 v29, v230, v231, v29
    v_add3_u32 v29, v236, v237, v29
    v_add3_u32 v29, v238, v239, v29
    v_add3_u32 v29, v244, v245, v29
    v_mfma_f32_32x32x16_bf16 a[80:95], a[16:19], v[220:223], a[80:95]
    v_add_u32 v12, 0xffff0000, v12
    v_add_u32 v13, 0xffff0000, v13
    v_add_u32 v14, 0xffff0000, v14
    ds_read_b64_tr_b16 a[208:209], v12 offset:18432
    ds_read_b64_tr_b16 a[210:211], v12 offset:19456
    v_add3_u32 v29, v246, v247, v29
    v_mfma_f32_32x32x16_bf16 a[96:111], a[20:23], v[220:223], a[96:111]
    ds_read_b64_tr_b16 a[212:213], v13 offset:18432
    ds_read_b64_tr_b16 a[214:215], v13 offset:19456
    v_add3_u32 v29, v252, v253, v29
    v_add3_u32 v29, v254, v255, v29
    v_bitop3_b32 v28, v28, v29, s60 bitop3:0x7e
    v_cmp_ne_u32 vcc, 0, v28
    s_cbranch_vccnz L_spin_56
L_ok_55:
    s_waitcnt lgkmcnt(0)
    v_mfma_f32_32x32x16_bf16 a[96:111], a[188:191], v[228:231], a[96:111]
    v_mfma_f32_32x32x16_bf16 a[96:111], a[196:199], v[236:239], a[96:111]
    v_mfma_f32_32x32x16_bf16 a[96:111], a[204:207], v[244:247], a[96:111]
    v_mfma_f32_32x32x16_bf16 a[96:111], a[212:215], v[252:255], a[96:111]
    v_mfma_f32_32x32x16_bf16 a[80:95], a[184:187], v[228:231], a[80:95]
    v_mfma_f32_32x32x16_bf16 a[80:95], a[192:195], v[236:239], a[80:95]
    v_mfma_f32_32x32x16_bf16 a[80:95], a[200:203], v[244:247], a[80:95]
    s_nop 8
    ds_write_b128 v0, a[96:99] offset:32768
    ds_write_b128 v0, a[100:103] offset:33792
    v_mfma_f32_32x32x16_bf16 a[80:95], a[208:211], v[252:255], a[80:95]
    ds_write_b128 v0, a[104:107] offset:34816
    ds_write_b128 v0, a[108:111] offset:35840
    v_mfma_f32_32x32x16_bf16 a[64:79], a[188:191], v[224:227], a[64:79]
    v_mfma_f32_32x32x16_bf16 a[64:79], a[196:199], v[232:235], a[64:79]
    v_mfma_f32_32x32x16_bf16 a[64:79], a[204:207], v[240:243], a[64:79]
    s_nop 6
    ds_write_b128 v0, a[80:83] offset:16384
    ds_write_b128 v0, a[84:87] offset:17408
    v_mfma_f32_32x32x16_bf16 a[64:79], a[212:215], v[248:251], a[64:79]
    ds_write_b128 v0, a[88:91] offset:18432
    ds_write_b128 v0, a[92:95] offset:19456
    v_mfma_f32_32x32x16_bf16 a[48:63], a[184:187], v[224:227], a[48:63]
    v_mfma_f32_32x32x16_bf16 a[48:63], a[192:195], v[232:235], a[48:63]
    v_mfma_f32_32x32x16_bf16 a[48:63], a[200:203], v[240:243], a[48:63]
    s_nop 6
    ds_write_b128 v0, a[64:67] offset:0
    ds_write_b128 v0, a[68:71] offset:1024
    v_mfma_f32_32x32x16_bf16 a[48:63], a[208:211], v[248:251], a[48:63]
    ds_write_b128 v0, a[72:75] offset:2048
    ds_write_b128 v0, a[76:79] offset:3072
    s_nop 9
    v_accvgpr_read_b32 v144, a48
    v_accvgpr_read_b32 v145, a49
    v_accvgpr_read_b32 v146, a50
    v_accvgpr_read_b32 v147, a51
    v_accvgpr_read_b32 v148, a52
    v_accvgpr_read_b32 v149, a53
    v_accvgpr_read_b32 v150, a54
    v_accvgpr_read_b32 v151, a55
    v_accvgpr_read_b32 v152, a56
    v_accvgpr_read_b32 v153, a57
    v_accvgpr_read_b32 v154, a58
    v_accvgpr_read_b32 v155, a59
    v_accvgpr_read_b32 v156, a60
    v_accvgpr_read_b32 v157, a61
    v_accvgpr_read_b32 v158, a62
    v_accvgpr_read_b32 v159, a63
    v_pk_add_f32 v[128:129], v[128:129], v[144:145]
    v_pk_add_f32 v[130:131], v[130:131], v[146:147]
    v_pk_add_f32 v[132:133], v[132:133], v[148:149]
    v_pk_add_f32 v[134:135], v[134:135], v[150:151]
    v_pk_add_f32 v[136:137], v[136:137], v[152:153]
    v_pk_add_f32 v[138:139], v[138:139], v[154:155]
    v_pk_add_f32 v[140:141], v[140:141], v[156:157]
    v_pk_add_f32 v[142:143], v[142:143], v[158:159]
    s_waitcnt lgkmcnt(0)
    s_barrier
    v_xor_b32 v3, 4096, v0
    ds_read_b128 v[144:147], v3 offset:0
    ds_read_b128 v[148:151], v3 offset:1024
    ds_read_b128 v[152:155], v3 offset:2048
    ds_read_b128 v[156:159], v3 offset:3072
    v_xor_b32 v3, 8192, v0
    ds_read_b128 v[160:163], v3 offset:16384
    ds_read_b128 v[164:167], v3 offset:17408
    ds_read_b128 v[168:171], v3 offset:18432
    ds_read_b128 v[172:175], v3 offset:19456
    v_xor_b32 v3, 12288, v0
    ds_read_b128 v[176:179], v3 offset:32768
    ds_read_b128 v[180:183], v3 offset:33792
    ds_read_b128 v[184:187], v3 offset:34816
    ds_read_b128 v[188:191], v3 offset:35840
    s_waitcnt lgkmcnt(8)
    v_pk_add_f32 v[128:129], v[128:129], v[144:145]
    v_pk_add_f32 v[130:131], v[130:131], v[146:147]
    v_pk_add_f32 v[132:133], v[132:133], v[148:149]
    v_pk_add_f32 v[134:135], v[134:135], v[150:151]
    v_pk_add_f32 v[136:137], v[136:137], v[152:153]
    v_pk_add_f32 v[138:139], v[138:139], v[154:155]
    v_pk_add_f32 v[140:141], v[140:141], v[156:157]
    v_pk_add_f32 v[142:143], v[142:143], v[158:159]
    s_waitcnt lgkmcnt(4)
    v_pk_add_f32 v[128:129], v[128:129], v[160:161]
    v_pk_add_f32 v[130:131], v[130:131], v[162:163]
    v_pk_add_f32 v[132:133], v[132:133], v[164:165]
    v_pk_add_f32 v[134:135], v[134:135], v[166:167]
    v_pk_add_f32 v[136:137], v[136:137], v[168:169]
    v_pk_add_f32 v[138:139], v[138:139], v[170:171]
    v_pk_add_f32 v[140:141], v[140:141], v[172:173]
    v_pk_add_f32 v[142:143], v[142:143], v[174:175]
    s_waitcnt lgkmcnt(0)
    v_pk_add_f32 v[128:129], v[128:129], v[176:177]
    v_pk_add_f32 v[130:131], v[130:131], v[178:179]
    v_pk_add_f32 v[132:133], v[132:133], v[180:181]
    v_pk_add_f32 v[134:135], v[134:135], v[182:183]
    v_pk_add_f32 v[136:137], v[136:137], v[184:185]
    v_pk_add_f32 v[138:139], v[138:139], v[186:187]
    v_pk_add_f32 v[140:141], v[140:141], v[188:189]
    v_pk_add_f32 v[142:143], v[142:143], v[190:191]
    v_cvt_pk_bf16_f32 v144, v128, v129
    v_cvt_pk_bf16_f32 v145, v130, v131
    v_cvt_pk_bf16_f32 v146, v132, v133
    v_cvt_pk_bf16_f32 v147, v134, v135
    v_cvt_pk_bf16_f32 v148, v136, v137
    v_cvt_pk_bf16_f32 v149, v138, v139
    v_cvt_pk_bf16_f32 v150, v140, v141
    v_cvt_pk_bf16_f32 v151, v142, v143
    v_permlane32_swap_b32 v144, v146
    v_permlane32_swap_b32 v145, v147
    v_permlane32_swap_b32 v148, v150
    v_permlane32_swap_b32 v149, v151
    buffer_store_dwordx4 v[144:147], v37, s[28:31], s7 offen offset:0
    buffer_store_dwordx4 v[148:151], v37, s[28:31], s7 offen offset:32
    s_endpgm
L_spin_2:
    s_mov_b32 s58, 0
L_spin_2_l:
    s_sleep 1
    buffer_load_dwordx2 v[36:37], off, s[36:39], 0 sc1
    s_add_u32 s58, s58, 1

    s_waitcnt vmcnt(0)
    v_readfirstlane_b32 s60, v36
    v_readfirstlane_b32 s61, v37
    s_cmp_gt_u32 s58, 4000
    s_cbranch_scc1 L_ok_1
    s_cmp_eq_u32 s60, 0
    s_cbranch_scc1 L_spin_2_l
    s_branch L_ok_1
L_spin_4:
    s_mov_b32 s58, 0
    s_mov_b32 s52, 0xc00000
L_spin_4_l:
    s_sleep 1
    buffer_load_dwordx2 v[36:37], v35, s[32:35], s52 offen sc1
    s_add_u32 s58, s58, 1

    s_waitcnt vmcnt(0)
    v_cmp_ne_u32 vcc, s60, v37
    s_cmp_gt_u32 s58, 4000
    s_cbranch_scc1 L_ok_3
    s_cbranch_vccnz L_spin_4_l
    s_branch L_ok_3
L_spin_6:
    s_mov_b32 s58, 0
    s_lshr_b32 s51, s50, 1
    s_add_u32 m0, s51, 147456
    s_lshl_b32 s93, s95, 4
    s_add_u32 s51, s93, 0x800000
L_spin_6_l:
    buffer_load_dwordx4 v36, s[32:35], s51 offen sc1 lds
    buffer_load_dwordx4 v37, s[32:35], s51 offen offset:1024 sc1 lds
    buffer_load_dword v38, v35, s[32:35], 0 offen sc1
    s_add_u32 s58, s58, 1

    s_waitcnt vmcnt(0)
    ds_read_b128 v[40:43], v48
    ds_read_b128 v[44:47], v48 offset:16
    s_waitcnt lgkmcnt(0)
    v_add3_u32 v40, v40, v41, v42
            v_add3_u32 v44, v44, v45, v46
            v_add3_u32 v40, v40, v43, v47
            v_add_u32 v40, v40, v44
            s_nop 1
            v_add_u32_dpp v40, v40, v40 quad_perm:[1,0,3,2] row_mask:0xf bank_mask:0xf
            s_nop 1
            v_add_u32_dpp v40, v40, v40 quad_perm:[2,3,0,1] row_mask:0xf bank_mask:0xf
            v_add_u32 v40, v40, v38
            v_cmp_ne_u32 vcc, s60, v40
    s_cmp_gt_u32 s58, 4000
    s_cbranch_scc1 L_ok_5
    s_cbranch_vccnz L_spin_6_l
    s_branch L_ok_5
L_spin_8:
    s_mov_b32 s58, 0
    s_waitcnt vmcnt(0)
L_spin_8_l:
    buffer_load_dwordx4 v[160:163], v16, s[32:35], s64 offen offset:0 sc1
    buffer_load_dwordx4 v[164:167], v17, s[32:35], s64 offen offset:0 sc1
    buffer_load_dwordx4 v[168:171], v16, s[32:35], s64 offen offset:1024 sc1
    buffer_load_dwordx4 v[172:175], v17, s[32:35], s64 offen offset:1024 sc1
    buffer_load_dwordx4 v[176:179], v16, s[32:35], s64 offen offset:2048 sc1
    buffer_load_dwordx4 v[180:183], v17, s[32:35], s64 offen offset:2048 sc1
    buffer_load_dwordx4 v[184:187], v16, s[32:35], s64 offen offset:3072 sc1
    buffer_load_dwordx4 v[188:191], v17, s[32:35], s64 offen offset:3072 sc1
    buffer_load_dword v24, v18, s[32:35], s72 offen sc1
    buffer_load_dword v25, v19, s[32:35], s72 offen sc1
    buffer_load_dwordx4 v[192:195], v16, s[32:35], s65 offen offset:0 sc1
    buffer_load_dwordx4 v[196:199], v17, s[32:35], s65 offen offset:0 sc1
    buffer_load_dwordx4 v[200:203], v16, s[32:35], s65 offen offset:1024 sc1
    buffer_load_dwordx4 v[204:207], v17, s[32:35], s65 offen offset:1024 sc1
    buffer_load_dwordx4 v[208:211], v16, s[32:35], s65 offen offset:2048 sc1
    buffer_load_dwordx4 v[212:215], v17, s[32:35], s65 offen offset:2048 sc1
    buffer_load_dwordx4 v[216:219], v16, s[32:35], s65 offen offset:3072 sc1
    buffer_load_dwordx4 v[220:223], v17, s[32:35], s65 offen offset:3072 sc1
    s_add_u32 s58, s58, 1

    s_waitcnt vmcnt(0)
    v_add3_u32 v24, v160, v161, v24
    v_add3_u32 v24, v162, v163, v24
    v_add3_u32 v24, v168, v169, v24
    v_add3_u32 v24, v170, v171, v24
    v_add3_u32 v24, v176, v177, v24
    v_add3_u32 v24, v178, v179, v24
    v_add3_u32 v24, v184, v185, v24
    v_add3_u32 v24, v186, v187, v24
    v_add3_u32 v25, v164, v165, v25
    v_add3_u32 v25, v166, v167, v25
    v_add3_u32 v25, v172, v173, v25
    v_add3_u32 v25, v174, v175, v25
    v_add3_u32 v25, v180, v181, v25
    v_add3_u32 v25, v182, v183, v25
    v_add3_u32 v25, v188, v189, v25
    v_add3_u32 v25, v190, v191, v25
    v_bitop3_b32 v24, v24, v25, s60 bitop3:0x7e
    v_cmp_ne_u32 vcc, 0, v24
    s_cmp_gt_u32 s58, 4000
    s_cbranch_scc1 L_ok_7
    s_cbranch_vccnz L_spin_8_l
    s_branch L_ok_7
L_spin_10:
    s_mov_b32 s58, 0
    s_waitcnt vmcnt(0)
L_spin_10_l:
    buffer_load_dwordx4 v[192:195], v16, s[32:35], s65 offen offset:0 sc1
    buffer_load_dwordx4 v[196:199], v17, s[32:35], s65 offen offset:0 sc1
    buffer_load_dwordx4 v[200:203], v16, s[32:35], s65 offen offset:1024 sc1
    buffer_load_dwordx4 v[204:207], v17, s[32:35], s65 offen offset:1024 sc1
    buffer_load_dwordx4 v[208:211], v16, s[32:35], s65 offen offset:2048 sc1
    buffer_load_dwordx4 v[212:215], v17, s[32:35], s65 offen offset:2048 sc1
    buffer_load_dwordx4 v[216:219], v16, s[32:35], s65 offen offset:3072 sc1
    buffer_load_dwordx4 v[220:223], v17, s[32:35], s65 offen offset:3072 sc1
    buffer_load_dword v26, v18, s[32:35], s73 offen sc1
    buffer_load_dword v27, v19, s[32:35], s73 offen sc1
    buffer_load_dwordx4 v[224:227], v16, s[32:35], s66 offen offset:0 sc1
    buffer_load_dwordx4 v[228:231], v17, s[32:35], s66 offen offset:0 sc1
    buffer_load_dwordx4 v[232:235], v16, s[32:35], s66 offen offset:1024 sc1
    buffer_load_dwordx4 v[236:239], v17, s[32:35], s66 offen offset:1024 sc1
    buffer_load_dwordx4 v[240:243], v16, s[32:35], s66 offen offset:2048 sc1
    buffer_load_dwordx4 v[244:247], v17, s[32:35], s66 offen offset:2048 sc1
    buffer_load_dwordx4 v[248:251], v16, s[32:35], s66 offen offset:3072 sc1
    buffer_load_dwordx4 v[252:255], v17, s[32:35], s66 offen offset:3072 sc1
    buffer_load_dword v28, v18, s[32:35], s74 offen sc1
    buffer_load_dword v29, v19, s[32:35], s74 offen sc1
    buffer_load_dwordx4 v[128:131], v16, s[32:35], s67 offen offset:0 sc1
    buffer_load_dwordx4 v[132:135], v17, s[32:35], s67 offen offset:0 sc1
    buffer_load_dwordx4 v[136:139], v16, s[32:35], s67 offen offset:1024 sc1
    buffer_load_dwordx4 v[140:143], v17, s[32:35], s67 offen offset:1024 sc1
    s_add_u32 s58, s58, 1

    s_waitcnt vmcnt(0)
    v_add3_u32 v26, v192, v193, v26
    v_add3_u32 v26, v194, v195, v26
    v_add3_u32 v26, v200, v201, v26
    v_add3_u32 v26, v202, v203, v26
    v_add3_u32 v26, v208, v209, v26
    v_add3_u32 v26, v210, v211, v26
    v_add3_u32 v26, v216, v217, v26
    v_add3_u32 v26, v218, v219, v26
    v_add3_u32 v27, v196, v197, v27
    v_add3_u32 v27, v198, v199, v27
    v_add3_u32 v27, v204, v205, v27
    v_add3_u32 v27, v206, v207, v27
    v_add3_u32 v27, v212, v213, v27
    v_add3_u32 v27, v214, v215, v27
    v_add3_u32 v27, v220, v221, v27
    v_add3_u32 v27, v222, v223, v27
    v_bitop3_b32 v26, v26, v27, s60 bitop3:0x7e
    v_cmp_ne_u32 vcc, 0, v26
    s_cmp_gt_u32 s58, 4000
    s_cbranch_scc1 L_ok_9
    s_cbranch_vccnz L_spin_10_l
    s_branch L_ok_9
L_spin_12:
    s_mov_b32 s58, 0
    s_waitcnt vmcnt(0)
L_spin_12_l:
    buffer_load_dwordx4 v[224:227], v16, s[32:35], s66 offen offset:0 sc1
    buffer_load_dwordx4 v[228:231], v17, s[32:35], s66 offen offset:0 sc1
    buffer_load_dwordx4 v[232:235], v16, s[32:35], s66 offen offset:1024 sc1
    buffer_load_dwordx4 v[236:239], v17, s[32:35], s66 offen offset:1024 sc1
    buffer_load_dwordx4 v[240:243], v16, s[32:35], s66 offen offset:2048 sc1
    buffer_load_dwordx4 v[244:247], v17, s[32:35], s66 offen offset:2048 sc1
    buffer_load_dwordx4 v[248:251], v16, s[32:35], s66 offen offset:3072 sc1
    buffer_load_dwordx4 v[252:255], v17, s[32:35], s66 offen offset:3072 sc1
    buffer_load_dword v28, v18, s[32:35], s74 offen sc1
    buffer_load_dword v29, v19, s[32:35], s74 offen sc1
    buffer_load_dwordx4 v[128:131], v16, s[32:35], s67 offen offset:0 sc1
    buffer_load_dwordx4 v[132:135], v17, s[32:35], s67 offen offset:0 sc1
    buffer_load_dwordx4 v[136:139], v16, s[32:35], s67 offen offset:1024 sc1
    buffer_load_dwordx4 v[140:143], v17, s[32:35], s67 offen offset:1024 sc1
    buffer_load_dwordx4 v[144:147], v16, s[32:35], s67 offen offset:2048 sc1
    buffer_load_dwordx4 v[148:151], v17, s[32:35], s67 offen offset:2048 sc1
    buffer_load_dwordx4 v[152:155], v16, s[32:35], s67 offen offset:3072 sc1
    buffer_load_dwordx4 v[156:159], v17, s[32:35], s67 offen offset:3072 sc1
    buffer_load_dword v30, v18, s[32:35], s75 offen sc1
    buffer_load_dword v31, v19, s[32:35], s75 offen sc1
    buffer_load_dwordx4 v[160:163], v16, s[32:35], s68 offen offset:0 sc1
    buffer_load_dwordx4 v[164:167], v17, s[32:35], s68 offen offset:0 sc1
    buffer_load_dwordx4 v[168:171], v16, s[32:35], s68 offen offset:1024 sc1
    s_add_u32 s58, s58, 1

    s_waitcnt vmcnt(0)
    v_add3_u32 v28, v224, v225, v28
    v_add3_u32 v28, v226, v227, v28
    v_add3_u32 v28, v232, v233, v28
    v_add3_u32 v28, v234, v235, v28
    v_add3_u32 v28, v240, v241, v28
    v_add3_u32 v28, v242, v243, v28
    v_add3_u32 v28, v248, v249, v28
    v_add3_u32 v28, v250, v251, v28
    v_add3_u32 v29, v228, v229, v29
    v_add3_u32 v29, v230, v231, v29
    v_add3_u32 v29, v236, v237, v29
    v_add3_u32 v29, v238, v239, v29
    v_add3_u32 v29, v244, v245, v29
    v_add3_u32 v29, v246, v247, v29
    v_add3_u32 v29, v252, v253, v29
    v_add3_u32 v29, v254, v255, v29
    v_bitop3_b32 v28, v28, v29, s60 bitop3:0x7e
    v_cmp_ne_u32 vcc, 0, v28
    s_cmp_gt_u32 s58, 4000
    s_cbranch_scc1 L_ok_11
    s_cbranch_vccnz L_spin_12_l
    s_branch L_ok_11
L_spin_14:
    s_mov_b32 s58, 0
    s_waitcnt vmcnt(0)
L_spin_14_l:
    buffer_load_dwordx4 v[128:131], v16, s[32:35], s67 offen offset:0 sc1
    buffer_load_dwordx4 v[132:135], v17, s[32:35], s67 offen offset:0 sc1
    buffer_load_dwordx4 v[136:139], v16, s[32:35], s67 offen offset:1024 sc1
    buffer_load_dwordx4 v[140:143], v17, s[32:35], s67 offen offset:1024 sc1
    buffer_load_dwordx4 v[144:147], v16, s[32:35], s67 offen offset:2048 sc1
    buffer_load_dwordx4 v[148:151], v17, s[32:35], s67 offen offset:2048 sc1
    buffer_load_dwordx4 v[152:155], v16, s[32:35], s67 offen offset:3072 sc1
    buffer_load_dwordx4 v[156:159], v17, s[32:35], s67 offen offset:3072 sc1
    buffer_load_dword v30, v18, s[32:35], s75 offen sc1
    buffer_load_dword v31, v19, s[32:35], s75 offen sc1
    buffer_load_dwordx4 v[160:163], v16, s[32:35], s68 offen offset:0 sc1
    buffer_load_dwordx4 v[164:167], v17, s[32:35], s68 offen offset:0 sc1
    buffer_load_dwordx4 v[168:171], v16, s[32:35], s68 offen offset:1024 sc1
    buffer_load_dwordx4 v[172:175], v17, s[32:35], s68 offen offset:1024 sc1
    buffer_load_dwordx4 v[176:179], v16, s[32:35], s68 offen offset:2048 sc1
    buffer_load_dwordx4 v[180:183], v17, s[32:35], s68 offen offset:2048 sc1
    buffer_load_dwordx4 v[184:187], v16, s[32:35], s68 offen offset:3072 sc1
    buffer_load_dwordx4 v[188:191], v17, s[32:35], s68 offen offset:3072 sc1
    buffer_load_dword v24, v18, s[32:35], s76 offen sc1
    buffer_load_dword v25, v19, s[32:35], s76 offen sc1
    s_add_u32 s58, s58, 1

    s_waitcnt vmcnt(0)
    v_add3_u32 v30, v128, v129, v30
    v_add3_u32 v30, v130, v131, v30
    v_add3_u32 v30, v136, v137, v30
    v_add3_u32 v30, v138, v139, v30
    v_add3_u32 v30, v144, v145, v30
    v_add3_u32 v30, v146, v147, v30
    v_add3_u32 v30, v152, v153, v30
    v_add3_u32 v30, v154, v155, v30
    v_add3_u32 v31, v132, v133, v31
    v_add3_u32 v31, v134, v135, v31
    v_add3_u32 v31, v140, v141, v31
    v_add3_u32 v31, v142, v143, v31
    v_add3_u32 v31, v148, v149, v31
    v_add3_u32 v31, v150, v151, v31
    v_add3_u32 v31, v156, v157, v31
    v_add3_u32 v31, v158, v159, v31
    v_bitop3_b32 v30, v30, v31, s60 bitop3:0x7e
    v_cmp_ne_u32 vcc, 0, v30
    s_cmp_gt_u32 s58, 4000
    s_cbranch_scc1 L_ok_13
    s_cbranch_vccnz L_spin_14_l
    s_branch L_ok_13
L_spin_16:
    s_mov_b32 s58, 0
    s_waitcnt vmcnt(0)
L_spin_16_l:
    buffer_load_dwordx4 v[160:163], v16, s[32:35], s68 offen offset:0 sc1
    buffer_load_dwordx4 v[164:167], v17, s[32:35], s68 offen offset:0 sc1
    buffer_load_dwordx4 v[168:171], v16, s[32:35], s68 offen offset:1024 sc1
    buffer_load_dwordx4 v[172:175], v17, s[32:35], s68 offen offset:1024 sc1
    buffer_load_dwordx4 v[176:179], v16, s[32:35], s68 offen offset:2048 sc1
    buffer_load_dwordx4 v[180:183], v17, s[32:35], s68 offen offset:2048 sc1
    buffer_load_dwordx4 v[184:187], v16, s[32:35], s68 offen offset:3072 sc1
    buffer_load_dwordx4 v[188:191], v17, s[32:35], s68 offen offset:3072 sc1
    buffer_load_dword v24, v18, s[32:35], s76 offen sc1
    buffer_load_dword v25, v19, s[32:35], s76 offen sc1
    s_add_u32 s58, s58, 1

    s_waitcnt vmcnt(0)
    v_add3_u32 v24, v160, v161, v24
    v_add3_u32 v24, v162, v163, v24
    v_add3_u32 v24, v168, v169, v24
    v_add3_u32 v24, v170, v171, v24
    v_add3_u32 v24, v176, v177, v24
    v_add3_u32 v24, v178, v179, v24
    v_add3_u32 v24, v184, v185, v24
    v_add3_u32 v24, v186, v187, v24
    v_add3_u32 v25, v164, v165, v25
    v_add3_u32 v25, v166, v167, v25
    v_add3_u32 v25, v172, v173, v25
    v_add3_u32 v25, v174, v175, v25
    v_add3_u32 v25, v180, v181, v25
    v_add3_u32 v25, v182, v183, v25
    v_add3_u32 v25, v188, v189, v25
    v_add3_u32 v25, v190, v191, v25
    v_bitop3_b32 v24, v24, v25, s60 bitop3:0x7e
    v_cmp_ne_u32 vcc, 0, v24
    s_cmp_gt_u32 s58, 4000
    s_cbranch_scc1 L_ok_15
    s_cbranch_vccnz L_spin_16_l
    s_branch L_ok_15
L_spin_18:
    s_mov_b32 s58, 0
    s_waitcnt vmcnt(0)
    v_add_u32 v14, 0x0, v14
L_spin_18_l:
    s_add_u32 m0, s50, 114688
    s_xor_b32 s51, s63, 0
    s_add_u32 s51, s51, 0xa00000
    buffer_load_dwordx4 v38, s[32:35], s51 offen offset:0 sc1 lds
    buffer_load_dwordx4 v38, s[32:35], s51 offen offset:1024 sc1 lds
    buffer_load_dwordx4 v38, s[32:35], s51 offen offset:2048 sc1 lds
    buffer_load_dwordx4 v38, s[32:35], s51 offen offset:3072 sc1 lds
    s_sub_u32 s52, s51, 0xa00000
    s_lshr_b32 s52, s52, 3
    s_add_u32 s52, s52, 0xd40000
    buffer_load_dwordx2 v[4:5], v35, s[32:35], s52 offen sc1
    s_add_u32 m0, s50, 0
    s_xor_b32 s51, s63, 0
    s_add_u32 s51, s51, 0xa04000
    buffer_load_dwordx4 v38, s[32:35], s51 offen offset:0 sc1 lds
    buffer_load_dwordx4 v38, s[32:35], s51 offen offset:1024 sc1 lds
    buffer_load_dwordx4 v38, s[32:35], s51 offen offset:2048 sc1 lds
    buffer_load_dwordx4 v38, s[32:35], s51 offen offset:3072 sc1 lds
    s_sub_u32 s52, s51, 0xa00000
    s_lshr_b32 s52, s52, 3
    s_add_u32 s52, s52, 0xd40000
    buffer_load_dwordx2 v[6:7], v35, s[32:35], s52 offen sc1
    s_add_u32 m0, s50, 98304
    s_xor_b32 s51, s63, 32768
    s_add_u32 s51, s51, 0xa00000
    buffer_load_dwordx4 v38, s[32:35], s51 offen offset:0 sc1 lds
    buffer_load_dwordx4 v38, s[32:35], s51 offen offset:1024 sc1 lds
    buffer_load_dwordx4 v38, s[32:35], s51 offen offset:2048 sc1 lds
    buffer_load_dwordx4 v38, s[32:35], s51 offen offset:3072 sc1 lds
    s_sub_u32 s52, s51, 0xa00000
    s_lshr_b32 s52, s52, 3
    s_add_u32 s52, s52, 0xd40000
    buffer_load_dwordx2 v[20:21], v35, s[32:35], s52 offen sc1
    s_add_u32 m0, s50, 32768
    s_xor_b32 s51, s63, 32768
    s_add_u32 s51, s51, 0xa04000
    buffer_load_dwordx4 v38, s[32:35], s51 offen offset:0 sc1 lds
    buffer_load_dwordx4 v38, s[32:35], s51 offen offset:1024 sc1 lds
    buffer_load_dwordx4 v38, s[32:35], s51 offen offset:2048 sc1 lds
    buffer_load_dwordx4 v38, s[32:35], s51 offen offset:3072 sc1 lds
    s_sub_u32 s52, s51, 0xa00000
    s_lshr_b32 s52, s52, 3
    s_add_u32 s52, s52, 0xd40000
    buffer_load_dwordx2 v[22:23], v35, s[32:35], s52 offen sc1
    s_add_u32 s58, s58, 1

    s_waitcnt vmcnt(0)
    ds_read_b128 v[40:43], v14 offset:49152
    ds_read_b128 v[44:47], v14 offset:49216
    ds_read_b128 v[48:51], v14 offset:49168
    ds_read_b128 v[52:55], v14 offset:49232
    s_waitcnt lgkmcnt(0)
    v_add3_u32 v4, v40, v41, v4
    v_add3_u32 v4, v42, v43, v4
    v_add3_u32 v4, v44, v45, v4
    v_add3_u32 v4, v46, v47, v4
    v_add3_u32 v5, v48, v49, v5
    v_add3_u32 v5, v50, v51, v5
    v_add3_u32 v5, v52, v53, v5
    v_add3_u32 v5, v54, v55, v5
    v_bitop3_b32 v4, v4, v5, s60 bitop3:0x7e
    v_cmp_ne_u32 vcc, 0, v4
    s_cmp_gt_u32 s58, 4000
    s_cbranch_scc1 L_spin_18_x
    s_cbranch_vccnz L_spin_18_l
L_spin_18_x:
    v_add_u32 v14, 0x0, v14
    s_branch L_ok_17
L_spin_20:
    s_mov_b32 s58, 0
    s_waitcnt vmcnt(0)
    v_add_u32 v14, 0x0, v14
L_spin_20_l:
    s_add_u32 m0, s50, 0
    s_xor_b32 s51, s63, 0
    s_add_u32 s51, s51, 0xa04000
    buffer_load_dwordx4 v38, s[32:35], s51 offen offset:0 sc1 lds
    buffer_load_dwordx4 v38, s[32:35], s51 offen offset:1024 sc1 lds
    buffer_load_dwordx4 v38, s[32:35], s51 offen offset:2048 sc1 lds
    buffer_load_dwordx4 v38, s[32:35], s51 offen offset:3072 sc1 lds
    s_sub_u32 s52, s51, 0xa00000
    s_lshr_b32 s52, s52, 3
    s_add_u32 s52, s52, 0xd40000
    buffer_load_dwordx2 v[6:7], v35, s[32:35], s52 offen sc1
    s_add_u32 m0, s50, 98304
    s_xor_b32 s51, s63, 32768
    s_add_u32 s51, s51, 0xa00000
    buffer_load_dwordx4 v38, s[32:35], s51 offen offset:0 sc1 lds
    buffer_load_dwordx4 v38, s[32:35], s51 offen offset:1024 sc1 lds
    buffer_load_dwordx4 v38, s[32:35], s51 offen offset:2048 sc1 lds
    buffer_load_dwordx4 v38, s[32:35], s51 offen offset:3072 sc1 lds
    s_sub_u32 s52, s51, 0xa00000
    s_lshr_b32 s52, s52, 3
    s_add_u32 s52, s52, 0xd40000
    buffer_load_dwordx2 v[20:21], v35, s[32:35], s52 offen sc1
    s_add_u32 m0, s50, 32768
    s_xor_b32 s51, s63, 32768
    s_add_u32 s51, s51, 0xa04000
    buffer_load_dwordx4 v38, s[32:35], s51 offen offset:0 sc1 lds
    buffer_load_dwordx4 v38, s[32:35], s51 offen offset:1024 sc1 lds
    buffer_load_dwordx4 v38, s[32:35], s51 offen offset:2048 sc1 lds
    buffer_load_dwordx4 v38, s[32:35], s51 offen offset:3072 sc1 lds
    s_sub_u32 s52, s51, 0xa00000
    s_lshr_b32 s52, s52, 3
    s_add_u32 s52, s52, 0xd40000
    buffer_load_dwordx2 v[22:23], v35, s[32:35], s52 offen sc1
    s_add_u32 s58, s58, 1

    s_waitcnt vmcnt(0)
    ds_read_b128 v[40:43], v14 offset:0
    ds_read_b128 v[44:47], v14 offset:64
    ds_read_b128 v[48:51], v14 offset:16
    ds_read_b128 v[52:55], v14 offset:80
    s_waitcnt lgkmcnt(0)
    v_add3_u32 v6, v40, v41, v6
    v_add3_u32 v6, v42, v43, v6
    v_add3_u32 v6, v44, v45, v6
    v_add3_u32 v6, v46, v47, v6
    v_add3_u32 v7, v48, v49, v7
    v_add3_u32 v7, v50, v51, v7
    v_add3_u32 v7, v52, v53, v7
    v_add3_u32 v7, v54, v55, v7
    v_bitop3_b32 v6, v6, v7, s60 bitop3:0x7e
    v_cmp_ne_u32 vcc, 0, v6
    s_cmp_gt_u32 s58, 4000
    s_cbranch_scc1 L_spin_20_x
    s_cbranch_vccnz L_spin_20_l
L_spin_20_x:
    v_add_u32 v14, 0x0, v14
    s_branch L_ok_19
L_spin_22:
    s_mov_b32 s58, 0
    s_waitcnt vmcnt(0)
    v_add_u32 v14, 0x10000, v14
L_spin_22_l:
    s_add_u32 m0, s50, 98304
    s_xor_b32 s51, s63, 32768
    s_add_u32 s51, s51, 0xa00000
    buffer_load_dwordx4 v38, s[32:35], s51 offen offset:0 sc1 lds
    buffer_load_dwordx4 v38, s[32:35], s51 offen offset:1024 sc1 lds
    buffer_load_dwordx4 v38, s[32:35], s51 offen offset:2048 sc1 lds
    buffer_load_dwordx4 v38, s[32:35], s51 offen offset:3072 sc1 lds
    s_sub_u32 s52, s51, 0xa00000
    s_lshr_b32 s52, s52, 3
    s_add_u32 s52, s52, 0xd40000
    buffer_load_dwordx2 v[20:21], v35, s[32:35], s52 offen sc1
    s_add_u32 m0, s50, 32768
    s_xor_b32 s51, s63, 32768
    s_add_u32 s51, s51, 0xa04000
    buffer_load_dwordx4 v38, s[32:35], s51 offen offset:0 sc1 lds
    buffer_load_dwordx4 v38, s[32:35], s51 offen offset:1024 sc1 lds
    buffer_load_dwordx4 v38, s[32:35], s51 offen offset:2048 sc1 lds
    buffer_load_dwordx4 v38, s[32:35], s51 offen offset:3072 sc1 lds
    s_sub_u32 s52, s51, 0xa00000
    s_lshr_b32 s52, s52, 3
    s_add_u32 s52, s52, 0xd40000
    buffer_load_dwordx2 v[22:23], v35, s[32:35], s52 offen sc1
    s_add_u32 s58, s58, 1

    s_waitcnt vmcnt(0)
    ds_read_b128 v[40:43], v14 offset:32768
    ds_read_b128 v[44:47], v14 offset:32832
    ds_read_b128 v[48:51], v14 offset:32784
    ds_read_b128 v[52:55], v14 offset:32848
    s_waitcnt lgkmcnt(0)
    v_add3_u32 v20, v40, v41, v20
    v_add3_u32 v20, v42, v43, v20
    v_add3_u32 v20, v44, v45, v20
    v_add3_u32 v20, v46, v47, v20
    v_add3_u32 v21, v48, v49, v21
    v_add3_u32 v21, v50, v51, v21
    v_add3_u32 v21, v52, v53, v21
    v_add3_u32 v21, v54, v55, v21
    v_bitop3_b32 v20, v20, v21, s60 bitop3:0x7e
    v_cmp_ne_u32 vcc, 0, v20
    s_cmp_gt_u32 s58, 4000
    s_cbranch_scc1 L_spin_22_x
    s_cbranch_vccnz L_spin_22_l
L_spin_22_x:
    v_add_u32 v14, 0xffff0000, v14
    s_branch L_ok_21
L_spin_24:
    s_mov_b32 s58, 0
    s_waitcnt vmcnt(0)
    v_add_u32 v14, 0xffff0000, v14
L_spin_24_l:
    s_add_u32 m0, s50, 32768
    s_xor_b32 s51, s63, 32768
    s_add_u32 s51, s51, 0xa04000
    buffer_load_dwordx4 v38, s[32:35], s51 offen offset:0 sc1 lds
    buffer_load_dwordx4 v38, s[32:35], s51 offen offset:1024 sc1 lds
    buffer_load_dwordx4 v38, s[32:35], s51 offen offset:2048 sc1 lds
    buffer_load_dwordx4 v38, s[32:35], s51 offen offset:3072 sc1 lds
    s_sub_u32 s52, s51, 0xa00000
    s_lshr_b32 s52, s52, 3
    s_add_u32 s52, s52, 0xd40000
    buffer_load_dwordx2 v[22:23], v35, s[32:35], s52 offen sc1
    s_add_u32 s58, s58, 1

    s_waitcnt vmcnt(0)
    ds_read_b128 v[40:43], v14 offset:32768
    ds_read_b128 v[44:47], v14 offset:32832
    ds_read_b128 v[48:51], v14 offset:32784
    ds_read_b128 v[52:55], v14 offset:32848
    s_waitcnt lgkmcnt(0)
    v_add3_u32 v22, v40, v41, v22
    v_add3_u32 v22, v42, v43, v22
    v_add3_u32 v22, v44, v45, v22
    v_add3_u32 v22, v46, v47, v22
    v_add3_u32 v23, v48, v49, v23
    v_add3_u32 v23, v50, v51, v23
    v_add3_u32 v23, v52, v53, v23
    v_add3_u32 v23, v54, v55, v23
    v_bitop3_b32 v22, v22, v23, s60 bitop3:0x7e
    v_cmp_ne_u32 vcc, 0, v22
    s_cmp_gt_u32 s58, 4000
    s_cbranch_scc1 L_spin_24_x
    s_cbranch_vccnz L_spin_24_l
L_spin_24_x:
    v_add_u32 v14, 0x10000, v14
    s_branch L_ok_23
L_spin_26:
    s_mov_b32 s58, 0
    s_waitcnt vmcnt(0)
L_spin_26_l:
    buffer_load_dwordx4 v[192:195], v16, s[32:35], s69 offen offset:0 sc1
    buffer_load_dwordx4 v[196:199], v17, s[32:35], s69 offen offset:0 sc1
    buffer_load_dwordx4 v[200:203], v16, s[32:35], s69 offen offset:1024 sc1
    buffer_load_dwordx4 v[204:207], v17, s[32:35], s69 offen offset:1024 sc1
    buffer_load_dwordx4 v[208:211], v16, s[32:35], s69 offen offset:2048 sc1
    buffer_load_dwordx4 v[212:215], v17, s[32:35], s69 offen offset:2048 sc1
    buffer_load_dwordx4 v[216:219], v16, s[32:35], s69 offen offset:3072 sc1
    buffer_load_dwordx4 v[220:223], v17, s[32:35], s69 offen offset:3072 sc1
    buffer_load_dword v26, v18, s[32:35], s77 offen sc1
    buffer_load_dword v27, v19, s[32:35], s77 offen sc1
    buffer_load_dwordx4 v[224:227], v16, s[32:35], s70 offen offset:0 sc1
    buffer_load_dwordx4 v[228:231], v17, s[32:35], s70 offen offset:0 sc1
    buffer_load_dwordx4 v[232:235], v16, s[32:35], s70 offen offset:1024 sc1
    buffer_load_dwordx4 v[236:239], v17, s[32:35], s70 offen offset:1024 sc1
    buffer_load_dwordx4 v[240:243], v16, s[32:35], s70 offen offset:2048 sc1
    buffer_load_dwordx4 v[244:247], v17, s[32:35], s70 offen offset:2048 sc1
    buffer_load_dwordx4 v[248:251], v16, s[32:35], s70 offen offset:3072 sc1
    buffer_load_dwordx4 v[252:255], v17, s[32:35], s70 offen offset:3072 sc1
    buffer_load_dword v28, v18, s[32:35], s78 offen sc1
    buffer_load_dword v29, v19, s[32:35], s78 offen sc1
    s_add_u32 s58, s58, 1

    s_waitcnt vmcnt(0)
    v_add3_u32 v26, v192, v193, v26
    v_add3_u32 v26, v194, v195, v26
    v_add3_u32 v26, v200, v201, v26
    v_add3_u32 v26, v202, v203, v26
    v_add3_u32 v26, v208, v209, v26
    v_add3_u32 v26, v210, v211, v26
    v_add3_u32 v26, v216, v217, v26
    v_add3_u32 v26, v218, v219, v26
    v_add3_u32 v27, v196, v197, v27
    v_add3_u32 v27, v198, v199, v27
    v_add3_u32 v27, v204, v205, v27
    v_add3_u32 v27, v206, v207, v27
    v_add3_u32 v27, v212, v213, v27
    v_add3_u32 v27, v214, v215, v27
    v_add3_u32 v27, v220, v221, v27
    v_add3_u32 v27, v222, v223, v27
    v_bitop3_b32 v26, v26, v27, s60 bitop3:0x7e
    v_cmp_ne_u32 vcc, 0, v26
    s_cmp_gt_u32 s58, 4000
    s_cbranch_scc1 L_ok_25
    s_cbranch_vccnz L_spin_26_l
    s_branch L_ok_25
L_spin_28:
    s_mov_b32 s58, 0
    s_waitcnt vmcnt(0)
L_spin_28_l:
    buffer_load_dwordx4 v[224:227], v16, s[32:35], s70 offen offset:0 sc1
    buffer_load_dwordx4 v[228:231], v17, s[32:35], s70 offen offset:0 sc1
    buffer_load_dwordx4 v[232:235], v16, s[32:35], s70 offen offset:1024 sc1
    buffer_load_dwordx4 v[236:239], v17, s[32:35], s70 offen offset:1024 sc1
    buffer_load_dwordx4 v[240:243], v16, s[32:35], s70 offen offset:2048 sc1
    buffer_load_dwordx4 v[244:247], v17, s[32:35], s70 offen offset:2048 sc1
    buffer_load_dwordx4 v[248:251], v16, s[32:35], s70 offen offset:3072 sc1
    buffer_load_dwordx4 v[252:255], v17, s[32:35], s70 offen offset:3072 sc1
    buffer_load_dword v28, v18, s[32:35], s78 offen sc1
    buffer_load_dword v29, v19, s[32:35], s78 offen sc1
    s_add_u32 s58, s58, 1

    s_waitcnt vmcnt(0)
    v_add3_u32 v28, v224, v225, v28
    v_add3_u32 v28, v226, v227, v28
    v_add3_u32 v28, v232, v233, v28
    v_add3_u32 v28, v234, v235, v28
    v_add3_u32 v28, v240, v241, v28
    v_add3_u32 v28, v242, v243, v28
    v_add3_u32 v28, v248, v249, v28
    v_add3_u32 v28, v250, v251, v28
    v_add3_u32 v29, v228, v229, v29
    v_add3_u32 v29, v230, v231, v29
    v_add3_u32 v29, v236, v237, v29
    v_add3_u32 v29, v238, v239, v29
    v_add3_u32 v29, v244, v245, v29
    v_add3_u32 v29, v246, v247, v29
    v_add3_u32 v29, v252, v253, v29
    v_add3_u32 v29, v254, v255, v29
    v_bitop3_b32 v28, v28, v29, s60 bitop3:0x7e
    v_cmp_ne_u32 vcc, 0, v28
    s_cmp_gt_u32 s58, 4000
    s_cbranch_scc1 L_ok_27
    s_cbranch_vccnz L_spin_28_l
    s_branch L_ok_27
L_spin_30:
    s_mov_b32 s58, 0
L_spin_30_l:
    s_sleep 1
    buffer_load_dwordx2 v[36:37], off, s[36:39], 0 sc1
    s_add_u32 s58, s58, 1

    s_waitcnt vmcnt(0)
    v_readfirstlane_b32 s60, v36
    v_readfirstlane_b32 s61, v37
    s_cmp_gt_u32 s58, 4000
    s_cbranch_scc1 L_ok_29
    s_cmp_eq_u32 s60, 0
    s_cbranch_scc1 L_spin_30_l
    s_branch L_ok_29
L_spin_32:
    s_mov_b32 s58, 0
    s_mov_b32 s52, 0xc00000
L_spin_32_l:
    s_sleep 1
    buffer_load_dwordx2 v[36:37], v35, s[32:35], s52 offen sc1
    s_add_u32 s58, s58, 1

    s_waitcnt vmcnt(0)
    v_cmp_ne_u32 vcc, s60, v37
    s_cmp_gt_u32 s58, 4000
    s_cbranch_scc1 L_ok_31
    s_cbranch_vccnz L_spin_32_l
    s_branch L_ok_31
L_spin_34:
    s_mov_b32 s58, 0
    s_lshr_b32 s51, s50, 1
    s_add_u32 m0, s51, 147456
    s_lshl_b32 s93, s95, 4
    s_add_u32 s51, s93, 0x800000
L_spin_34_l:
    buffer_load_dwordx4 v36, s[32:35], s51 offen sc1 lds
    buffer_load_dwordx4 v37, s[32:35], s51 offen offset:1024 sc1 lds
    buffer_load_dword v38, v35, s[32:35], 0 offen sc1
    s_add_u32 s58, s58, 1

    s_waitcnt vmcnt(0)
    ds_read_b128 v[40:43], v48
    ds_read_b128 v[44:47], v48 offset:16
    s_waitcnt lgkmcnt(0)
    v_add3_u32 v40, v40, v41, v42
            v_add3_u32 v44, v44, v45, v46
            v_add3_u32 v40, v40, v43, v47
            v_add_u32 v40, v40, v44
            s_nop 1
            v_add_u32_dpp v40, v40, v40 quad_perm:[1,0,3,2] row_mask:0xf bank_mask:0xf
            s_nop 1
            v_add_u32_dpp v40, v40, v40 quad_perm:[2,3,0,1] row_mask:0xf bank_mask:0xf
            v_add_u32 v40, v40, v38
            v_cmp_ne_u32 vcc, s60, v40
    s_cmp_gt_u32 s58, 4000
    s_cbranch_scc1 L_ok_33
    s_cbranch_vccnz L_spin_34_l
    s_branch L_ok_33
L_spin_36:
    s_mov_b32 s58, 0
    s_waitcnt vmcnt(0)
L_spin_36_l:
    buffer_load_dwordx4 v[160:163], v16, s[32:35], s64 offen offset:0 sc1
    buffer_load_dwordx4 v[164:167], v17, s[32:35], s64 offen offset:0 sc1
    buffer_load_dwordx4 v[168:171], v16, s[32:35], s64 offen offset:1024 sc1
    buffer_load_dwordx4 v[172:175], v17, s[32:35], s64 offen offset:1024 sc1
    buffer_load_dwordx4 v[176:179], v16, s[32:35], s64 offen offset:2048 sc1
    buffer_load_dwordx4 v[180:183], v17, s[32:35], s64 offen offset:2048 sc1
    buffer_load_dwordx4 v[184:187], v16, s[32:35], s64 offen offset:3072 sc1
    buffer_load_dwordx4 v[188:191], v17, s[32:35], s64 offen offset:3072 sc1
    buffer_load_dword v24, v18, s[32:35], s72 offen sc1
    buffer_load_dword v25, v19, s[32:35], s72 offen sc1
    buffer_load_dwordx4 v[192:195], v16, s[32:35], s65 offen offset:0 sc1
    buffer_load_dwordx4 v[196:199], v17, s[32:35], s65 offen offset:0 sc1
    buffer_load_dwordx4 v[200:203], v16, s[32:35], s65 offen offset:1024 sc1
    buffer_load_dwordx4 v[204:207], v17, s[32:35], s65 offen offset:1024 sc1
    buffer_load_dwordx4 v[208:211], v16, s[32:35], s65 offen offset:2048 sc1
    buffer_load_dwordx4 v[212:215], v17, s[32:35], s65 offen offset:2048 sc1
    buffer_load_dwordx4 v[216:219], v16, s[32:35], s65 offen offset:3072 sc1
    buffer_load_dwordx4 v[220:223], v17, s[32:35], s65 offen offset:3072 sc1
    s_add_u32 s58, s58, 1

    s_waitcnt vmcnt(0)
    v_add3_u32 v24, v160, v161, v24
    v_add3_u32 v24, v162, v163, v24
    v_add3_u32 v24, v168, v169, v24
    v_add3_u32 v24, v170, v171, v24
    v_add3_u32 v24, v176, v177, v24
    v_add3_u32 v24, v178, v179, v24
    v_add3_u32 v24, v184, v185, v24
    v_add3_u32 v24, v186, v187, v24
    v_add3_u32 v25, v164, v165, v25
    v_add3_u32 v25, v166, v167, v25
    v_add3_u32 v25, v172, v173, v25
    v_add3_u32 v25, v174, v175, v25
    v_add3_u32 v25, v180, v181, v25
    v_add3_u32 v25, v182, v183, v25
    v_add3_u32 v25, v188, v189, v25
    v_add3_u32 v25, v190, v191, v25
    v_bitop3_b32 v24, v24, v25, s60 bitop3:0x7e
    v_cmp_ne_u32 vcc, 0, v24
    s_cmp_gt_u32 s58, 4000
    s_cbranch_scc1 L_ok_35
    s_cbranch_vccnz L_spin_36_l
    s_branch L_ok_35
L_spin_38:
    s_mov_b32 s58, 0
    s_waitcnt vmcnt(0)
L_spin_38_l:
    buffer_load_dwordx4 v[192:195], v16, s[32:35], s65 offen offset:0 sc1
    buffer_load_dwordx4 v[196:199], v17, s[32:35], s65 offen offset:0 sc1
    buffer_load_dwordx4 v[200:203], v16, s[32:35], s65 offen offset:1024 sc1
    buffer_load_dwordx4 v[204:207], v17, s[32:35], s65 offen offset:1024 sc1
    buffer_load_dwordx4 v[208:211], v16, s[32:35], s65 offen offset:2048 sc1
    buffer_load_dwordx4 v[212:215], v17, s[32:35], s65 offen offset:2048 sc1
    buffer_load_dwordx4 v[216:219], v16, s[32:35], s65 offen offset:3072 sc1
    buffer_load_dwordx4 v[220:223], v17, s[32:35], s65 offen offset:3072 sc1
    buffer_load_dword v26, v18, s[32:35], s73 offen sc1
    buffer_load_dword v27, v19, s[32:35], s73 offen sc1
    buffer_load_dwordx4 v[224:227], v16, s[32:35], s66 offen offset:0 sc1
    buffer_load_dwordx4 v[228:231], v17, s[32:35], s66 offen offset:0 sc1
    buffer_load_dwordx4 v[232:235], v16, s[32:35], s66 offen offset:1024 sc1
    buffer_load_dwordx4 v[236:239], v17, s[32:35], s66 offen offset:1024 sc1
    buffer_load_dwordx4 v[240:243], v16, s[32:35], s66 offen offset:2048 sc1
    buffer_load_dwordx4 v[244:247], v17, s[32:35], s66 offen offset:2048 sc1
    buffer_load_dwordx4 v[248:251], v16, s[32:35], s66 offen offset:3072 sc1
    buffer_load_dwordx4 v[252:255], v17, s[32:35], s66 offen offset:3072 sc1
    buffer_load_dword v28, v18, s[32:35], s74 offen sc1
    buffer_load_dword v29, v19, s[32:35], s74 offen sc1
    buffer_load_dwordx4 v[128:131], v16, s[32:35], s67 offen offset:0 sc1
    buffer_load_dwordx4 v[132:135], v17, s[32:35], s67 offen offset:0 sc1
    buffer_load_dwordx4 v[136:139], v16, s[32:35], s67 offen offset:1024 sc1
    buffer_load_dwordx4 v[140:143], v17, s[32:35], s67 offen offset:1024 sc1
    s_add_u32 s58, s58, 1

    s_waitcnt vmcnt(0)
    v_add3_u32 v26, v192, v193, v26
    v_add3_u32 v26, v194, v195, v26
    v_add3_u32 v26, v200, v201, v26
    v_add3_u32 v26, v202, v203, v26
    v_add3_u32 v26, v208, v209, v26
    v_add3_u32 v26, v210, v211, v26
    v_add3_u32 v26, v216, v217, v26
    v_add3_u32 v26, v218, v219, v26
    v_add3_u32 v27, v196, v197, v27
    v_add3_u32 v27, v198, v199, v27
    v_add3_u32 v27, v204, v205, v27
    v_add3_u32 v27, v206, v207, v27
    v_add3_u32 v27, v212, v213, v27
    v_add3_u32 v27, v214, v215, v27
    v_add3_u32 v27, v220, v221, v27
    v_add3_u32 v27, v222, v223, v27
    v_bitop3_b32 v26, v26, v27, s60 bitop3:0x7e
    v_cmp_ne_u32 vcc, 0, v26
    s_cmp_gt_u32 s58, 4000
    s_cbranch_scc1 L_ok_37
    s_cbranch_vccnz L_spin_38_l
    s_branch L_ok_37
L_spin_40:
    s_mov_b32 s58, 0
    s_waitcnt vmcnt(0)
L_spin_40_l:
    buffer_load_dwordx4 v[224:227], v16, s[32:35], s66 offen offset:0 sc1
    buffer_load_dwordx4 v[228:231], v17, s[32:35], s66 offen offset:0 sc1
    buffer_load_dwordx4 v[232:235], v16, s[32:35], s66 offen offset:1024 sc1
    buffer_load_dwordx4 v[236:239], v17, s[32:35], s66 offen offset:1024 sc1
    buffer_load_dwordx4 v[240:243], v16, s[32:35], s66 offen offset:2048 sc1
    buffer_load_dwordx4 v[244:247], v17, s[32:35], s66 offen offset:2048 sc1
    buffer_load_dwordx4 v[248:251], v16, s[32:35], s66 offen offset:3072 sc1
    buffer_load_dwordx4 v[252:255], v17, s[32:35], s66 offen offset:3072 sc1
    buffer_load_dword v28, v18, s[32:35], s74 offen sc1
    buffer_load_dword v29, v19, s[32:35], s74 offen sc1
    buffer_load_dwordx4 v[128:131], v16, s[32:35], s67 offen offset:0 sc1
    buffer_load_dwordx4 v[132:135], v17, s[32:35], s67 offen offset:0 sc1
    buffer_load_dwordx4 v[136:139], v16, s[32:35], s67 offen offset:1024 sc1
    buffer_load_dwordx4 v[140:143], v17, s[32:35], s67 offen offset:1024 sc1
    buffer_load_dwordx4 v[144:147], v16, s[32:35], s67 offen offset:2048 sc1
    buffer_load_dwordx4 v[148:151], v17, s[32:35], s67 offen offset:2048 sc1
    buffer_load_dwordx4 v[152:155], v16, s[32:35], s67 offen offset:3072 sc1
    buffer_load_dwordx4 v[156:159], v17, s[32:35], s67 offen offset:3072 sc1
    buffer_load_dword v30, v18, s[32:35], s75 offen sc1
    buffer_load_dword v31, v19, s[32:35], s75 offen sc1
    buffer_load_dwordx4 v[160:163], v16, s[32:35], s68 offen offset:0 sc1
    buffer_load_dwordx4 v[164:167], v17, s[32:35], s68 offen offset:0 sc1
    buffer_load_dwordx4 v[168:171], v16, s[32:35], s68 offen offset:1024 sc1
    s_add_u32 s58, s58, 1

    s_waitcnt vmcnt(0)
    v_add3_u32 v28, v224, v225, v28
    v_add3_u32 v28, v226, v227, v28
    v_add3_u32 v28, v232, v233, v28
    v_add3_u32 v28, v234, v235, v28
    v_add3_u32 v28, v240, v241, v28
    v_add3_u32 v28, v242, v243, v28
    v_add3_u32 v28, v248, v249, v28
    v_add3_u32 v28, v250, v251, v28
    v_add3_u32 v29, v228, v229, v29
    v_add3_u32 v29, v230, v231, v29
    v_add3_u32 v29, v236, v237, v29
    v_add3_u32 v29, v238, v239, v29
    v_add3_u32 v29, v244, v245, v29
    v_add3_u32 v29, v246, v247, v29
    v_add3_u32 v29, v252, v253, v29
    v_add3_u32 v29, v254, v255, v29
    v_bitop3_b32 v28, v28, v29, s60 bitop3:0x7e
    v_cmp_ne_u32 vcc, 0, v28
    s_cmp_gt_u32 s58, 4000
    s_cbranch_scc1 L_ok_39
    s_cbranch_vccnz L_spin_40_l
    s_branch L_ok_39
L_spin_42:
    s_mov_b32 s58, 0
    s_waitcnt vmcnt(0)
L_spin_42_l:
    buffer_load_dwordx4 v[128:131], v16, s[32:35], s67 offen offset:0 sc1
    buffer_load_dwordx4 v[132:135], v17, s[32:35], s67 offen offset:0 sc1
    buffer_load_dwordx4 v[136:139], v16, s[32:35], s67 offen offset:1024 sc1
    buffer_load_dwordx4 v[140:143], v17, s[32:35], s67 offen offset:1024 sc1
    buffer_load_dwordx4 v[144:147], v16, s[32:35], s67 offen offset:2048 sc1
    buffer_load_dwordx4 v[148:151], v17, s[32:35], s67 offen offset:2048 sc1
    buffer_load_dwordx4 v[152:155], v16, s[32:35], s67 offen offset:3072 sc1
    buffer_load_dwordx4 v[156:159], v17, s[32:35], s67 offen offset:3072 sc1
    buffer_load_dword v30, v18, s[32:35], s75 offen sc1
    buffer_load_dword v31, v19, s[32:35], s75 offen sc1
    buffer_load_dwordx4 v[160:163], v16, s[32:35], s68 offen offset:0 sc1
    buffer_load_dwordx4 v[164:167], v17, s[32:35], s68 offen offset:0 sc1
    buffer_load_dwordx4 v[168:171], v16, s[32:35], s68 offen offset:1024 sc1
    buffer_load_dwordx4 v[172:175], v17, s[32:35], s68 offen offset:1024 sc1
    buffer_load_dwordx4 v[176:179], v16, s[32:35], s68 offen offset:2048 sc1
    buffer_load_dwordx4 v[180:183], v17, s[32:35], s68 offen offset:2048 sc1
    buffer_load_dwordx4 v[184:187], v16, s[32:35], s68 offen offset:3072 sc1
    buffer_load_dwordx4 v[188:191], v17, s[32:35], s68 offen offset:3072 sc1
    buffer_load_dword v24, v18, s[32:35], s76 offen sc1
    buffer_load_dword v25, v19, s[32:35], s76 offen sc1
    s_add_u32 s58, s58, 1

    s_waitcnt vmcnt(0)
    v_add3_u32 v30, v128, v129, v30
    v_add3_u32 v30, v130, v131, v30
    v_add3_u32 v30, v136, v137, v30
    v_add3_u32 v30, v138, v139, v30
    v_add3_u32 v30, v144, v145, v30
    v_add3_u32 v30, v146, v147, v30
    v_add3_u32 v30, v152, v153, v30
    v_add3_u32 v30, v154, v155, v30
    v_add3_u32 v31, v132, v133, v31
    v_add3_u32 v31, v134, v135, v31
    v_add3_u32 v31, v140, v141, v31
    v_add3_u32 v31, v142, v143, v31
    v_add3_u32 v31, v148, v149, v31
    v_add3_u32 v31, v150, v151, v31
    v_add3_u32 v31, v156, v157, v31
    v_add3_u32 v31, v158, v159, v31
    v_bitop3_b32 v30, v30, v31, s60 bitop3:0x7e
    v_cmp_ne_u32 vcc, 0, v30
    s_cmp_gt_u32 s58, 4000
    s_cbranch_scc1 L_ok_41
    s_cbranch_vccnz L_spin_42_l
    s_branch L_ok_41
L_spin_44:
    s_mov_b32 s58, 0
    s_waitcnt vmcnt(0)
L_spin_44_l:
    buffer_load_dwordx4 v[160:163], v16, s[32:35], s68 offen offset:0 sc1
    buffer_load_dwordx4 v[164:167], v17, s[32:35], s68 offen offset:0 sc1
    buffer_load_dwordx4 v[168:171], v16, s[32:35], s68 offen offset:1024 sc1
    buffer_load_dwordx4 v[172:175], v17, s[32:35], s68 offen offset:1024 sc1
    buffer_load_dwordx4 v[176:179], v16, s[32:35], s68 offen offset:2048 sc1
    buffer_load_dwordx4 v[180:183], v17, s[32:35], s68 offen offset:2048 sc1
    buffer_load_dwordx4 v[184:187], v16, s[32:35], s68 offen offset:3072 sc1
    buffer_load_dwordx4 v[188:191], v17, s[32:35], s68 offen offset:3072 sc1
    buffer_load_dword v24, v18, s[32:35], s76 offen sc1
    buffer_load_dword v25, v19, s[32:35], s76 offen sc1
    s_add_u32 s58, s58, 1

    s_waitcnt vmcnt(0)
    v_add3_u32 v24, v160, v161, v24
    v_add3_u32 v24, v162, v163, v24
    v_add3_u32 v24, v168, v169, v24
    v_add3_u32 v24, v170, v171, v24
    v_add3_u32 v24, v176, v177, v24
    v_add3_u32 v24, v178, v179, v24
    v_add3_u32 v24, v184, v185, v24
    v_add3_u32 v24, v186, v187, v24
    v_add3_u32 v25, v164, v165, v25
    v_add3_u32 v25, v166, v167, v25
    v_add3_u32 v25, v172, v173, v25
    v_add3_u32 v25, v174, v175, v25
    v_add3_u32 v25, v180, v181, v25
    v_add3_u32 v25, v182, v183, v25
    v_add3_u32 v25, v188, v189, v25
    v_add3_u32 v25, v190, v191, v25
    v_bitop3_b32 v24, v24, v25, s60 bitop3:0x7e
    v_cmp_ne_u32 vcc, 0, v24
    s_cmp_gt_u32 s58, 4000
    s_cbranch_scc1 L_ok_43
    s_cbranch_vccnz L_spin_44_l
    s_branch L_ok_43
L_spin_46:
    s_mov_b32 s58, 0
    s_waitcnt vmcnt(0)
    v_add_u32 v14, 0x0, v14
L_spin_46_l:
    s_add_u32 m0, s50, 114688
    s_xor_b32 s51, s63, 0
    s_add_u32 s51, s51, 0xa00000
    buffer_load_dwordx4 v38, s[32:35], s51 offen offset:0 sc1 lds
    buffer_load_dwordx4 v38, s[32:35], s51 offen offset:1024 sc1 lds
    buffer_load_dwordx4 v38, s[32:35], s51 offen offset:2048 sc1 lds
    buffer_load_dwordx4 v38, s[32:35], s51 offen offset:3072 sc1 lds
    s_sub_u32 s52, s51, 0xa00000
    s_lshr_b32 s52, s52, 3
    s_add_u32 s52, s52, 0xd40000
    buffer_load_dwordx2 v[4:5], v35, s[32:35], s52 offen sc1
    s_add_u32 m0, s50, 81920
    s_xor_b32 s51, s63, 0
    s_add_u32 s51, s51, 0xa04000
    buffer_load_dwordx4 v38, s[32:35], s51 offen offset:0 sc1 lds
    buffer_load_dwordx4 v38, s[32:35], s51 offen offset:1024 sc1 lds
    buffer_load_dwordx4 v38, s[32:35], s51 offen offset:2048 sc1 lds
    buffer_load_dwordx4 v38, s[32:35], s51 offen offset:3072 sc1 lds
    s_sub_u32 s52, s51, 0xa00000
    s_lshr_b32 s52, s52, 3
    s_add_u32 s52, s52, 0xd40000
    buffer_load_dwordx2 v[6:7], v35, s[32:35], s52 offen sc1
    s_add_u32 m0, s50, 32768
    s_xor_b32 s51, s63, 32768
    s_add_u32 s51, s51, 0xa00000
    buffer_load_dwordx4 v38, s[32:35], s51 offen offset:0 sc1 lds
    buffer_load_dwordx4 v38, s[32:35], s51 offen offset:1024 sc1 lds
    buffer_load_dwordx4 v38, s[32:35], s51 offen offset:2048 sc1 lds
    buffer_load_dwordx4 v38, s[32:35], s51 offen offset:3072 sc1 lds
    s_sub_u32 s52, s51, 0xa00000
    s_lshr_b32 s52, s52, 3
    s_add_u32 s52, s52, 0xd40000
    buffer_load_dwordx2 v[20:21], v35, s[32:35], s52 offen sc1
    s_add_u32 m0, s50, 131072
    s_xor_b32 s51, s63, 32768
    s_add_u32 s51, s51, 0xa04000
    buffer_load_dwordx4 v38, s[32:35], s51 offen offset:0 sc1 lds
    buffer_load_dwordx4 v38, s[32:35], s51 offen offset:1024 sc1 lds
    buffer_load_dwordx4 v38, s[32:35], s51 offen offset:2048 sc1 lds
    buffer_load_dwordx4 v38, s[32:35], s51 offen offset:3072 sc1 lds
    s_sub_u32 s52, s51, 0xa00000
    s_lshr_b32 s52, s52, 3
    s_add_u32 s52, s52, 0xd40000
    buffer_load_dwordx2 v[22:23], v35, s[32:35], s52 offen sc1
    s_add_u32 s58, s58, 1

    s_waitcnt vmcnt(0)
    ds_read_b128 v[40:43], v14 offset:49152
    ds_read_b128 v[44:47], v14 offset:49216
    ds_read_b128 v[48:51], v14 offset:49168
    ds_read_b128 v[52:55], v14 offset:49232
    s_waitcnt lgkmcnt(0)
    v_add3_u32 v4, v40, v41, v4
    v_add3_u32 v4, v42, v43, v4
    v_add3_u32 v4, v44, v45, v4
    v_add3_u32 v4, v46, v47, v4
    v_add3_u32 v5, v48, v49, v5
    v_add3_u32 v5, v50, v51, v5
    v_add3_u32 v5, v52, v53, v5
    v_add3_u32 v5, v54, v55, v5
    v_bitop3_b32 v4, v4, v5, s60 bitop3:0x7e
    v_cmp_ne_u32 vcc, 0, v4
    s_cmp_gt_u32 s58, 4000
    s_cbranch_scc1 L_spin_46_x
    s_cbranch_vccnz L_spin_46_l
L_spin_46_x:
    v_add_u32 v14, 0x0, v14
    s_branch L_ok_45
L_spin_48:
    s_mov_b32 s58, 0
    s_waitcnt vmcnt(0)
    v_add_u32 v14, 0x0, v14
L_spin_48_l:
    s_add_u32 m0, s50, 81920
    s_xor_b32 s51, s63, 0
    s_add_u32 s51, s51, 0xa04000
    buffer_load_dwordx4 v38, s[32:35], s51 offen offset:0 sc1 lds
    buffer_load_dwordx4 v38, s[32:35], s51 offen offset:1024 sc1 lds
    buffer_load_dwordx4 v38, s[32:35], s51 offen offset:2048 sc1 lds
    buffer_load_dwordx4 v38, s[32:35], s51 offen offset:3072 sc1 lds
    s_sub_u32 s52, s51, 0xa00000
    s_lshr_b32 s52, s52, 3
    s_add_u32 s52, s52, 0xd40000
    buffer_load_dwordx2 v[6:7], v35, s[32:35], s52 offen sc1
    s_add_u32 m0, s50, 32768
    s_xor_b32 s51, s63, 32768
    s_add_u32 s51, s51, 0xa00000
    buffer_load_dwordx4 v38, s[32:35], s51 offen offset:0 sc1 lds
    buffer_load_dwordx4 v38, s[32:35], s51 offen offset:1024 sc1 lds
    buffer_load_dwordx4 v38, s[32:35], s51 offen offset:2048 sc1 lds
    buffer_load_dwordx4 v38, s[32:35], s51 offen offset:3072 sc1 lds
    s_sub_u32 s52, s51, 0xa00000
    s_lshr_b32 s52, s52, 3
    s_add_u32 s52, s52, 0xd40000
    buffer_load_dwordx2 v[20:21], v35, s[32:35], s52 offen sc1
    s_add_u32 m0, s50, 131072
    s_xor_b32 s51, s63, 32768
    s_add_u32 s51, s51, 0xa04000
    buffer_load_dwordx4 v38, s[32:35], s51 offen offset:0 sc1 lds
    buffer_load_dwordx4 v38, s[32:35], s51 offen offset:1024 sc1 lds
    buffer_load_dwordx4 v38, s[32:35], s51 offen offset:2048 sc1 lds
    buffer_load_dwordx4 v38, s[32:35], s51 offen offset:3072 sc1 lds
    s_sub_u32 s52, s51, 0xa00000
    s_lshr_b32 s52, s52, 3
    s_add_u32 s52, s52, 0xd40000
    buffer_load_dwordx2 v[22:23], v35, s[32:35], s52 offen sc1
    s_add_u32 s58, s58, 1

    s_waitcnt vmcnt(0)
    ds_read_b128 v[40:43], v14 offset:16384
    ds_read_b128 v[44:47], v14 offset:16448
    ds_read_b128 v[48:51], v14 offset:16400
    ds_read_b128 v[52:55], v14 offset:16464
    s_waitcnt lgkmcnt(0)
    v_add3_u32 v6, v40, v41, v6
    v_add3_u32 v6, v42, v43, v6
    v_add3_u32 v6, v44, v45, v6
    v_add3_u32 v6, v46, v47, v6
    v_add3_u32 v7, v48, v49, v7
    v_add3_u32 v7, v50, v51, v7
    v_add3_u32 v7, v52, v53, v7
    v_add3_u32 v7, v54, v55, v7
    v_bitop3_b32 v6, v6, v7, s60 bitop3:0x7e
    v_cmp_ne_u32 vcc, 0, v6
    s_cmp_gt_u32 s58, 4000
    s_cbranch_scc1 L_spin_48_x
    s_cbranch_vccnz L_spin_48_l
L_spin_48_x:
    v_add_u32 v14, 0x0, v14
    s_branch L_ok_47
L_spin_50:
    s_mov_b32 s58, 0
    s_waitcnt vmcnt(0)
    v_add_u32 v14, 0xffff0000, v14
L_spin_50_l:
    s_add_u32 m0, s50, 32768
    s_xor_b32 s51, s63, 32768
    s_add_u32 s51, s51, 0xa00000
    buffer_load_dwordx4 v38, s[32:35], s51 offen offset:0 sc1 lds
    buffer_load_dwordx4 v38, s[32:35], s51 offen offset:1024 sc1 lds
    buffer_load_dwordx4 v38, s[32:35], s51 offen offset:2048 sc1 lds
    buffer_load_dwordx4 v38, s[32:35], s51 offen offset:3072 sc1 lds
    s_sub_u32 s52, s51, 0xa00000
    s_lshr_b32 s52, s52, 3
    s_add_u32 s52, s52, 0xd40000
    buffer_load_dwordx2 v[20:21], v35, s[32:35], s52 offen sc1
    s_add_u32 m0, s50, 131072
    s_xor_b32 s51, s63, 32768
    s_add_u32 s51, s51, 0xa04000
    buffer_load_dwordx4 v38, s[32:35], s51 offen offset:0 sc1 lds
    buffer_load_dwordx4 v38, s[32:35], s51 offen offset:1024 sc1 lds
    buffer_load_dwordx4 v38, s[32:35], s51 offen offset:2048 sc1 lds
    buffer_load_dwordx4 v38, s[32:35], s51 offen offset:3072 sc1 lds
    s_sub_u32 s52, s51, 0xa00000
    s_lshr_b32 s52, s52, 3
    s_add_u32 s52, s52, 0xd40000
    buffer_load_dwordx2 v[22:23], v35, s[32:35], s52 offen sc1
    s_add_u32 s58, s58, 1

    s_waitcnt vmcnt(0)
    ds_read_b128 v[40:43], v14 offset:32768
    ds_read_b128 v[44:47], v14 offset:32832
    ds_read_b128 v[48:51], v14 offset:32784
    ds_read_b128 v[52:55], v14 offset:32848
    s_waitcnt lgkmcnt(0)
    v_add3_u32 v20, v40, v41, v20
    v_add3_u32 v20, v42, v43, v20
    v_add3_u32 v20, v44, v45, v20
    v_add3_u32 v20, v46, v47, v20
    v_add3_u32 v21, v48, v49, v21
    v_add3_u32 v21, v50, v51, v21
    v_add3_u32 v21, v52, v53, v21
    v_add3_u32 v21, v54, v55, v21
    v_bitop3_b32 v20, v20, v21, s60 bitop3:0x7e
    v_cmp_ne_u32 vcc, 0, v20
    s_cmp_gt_u32 s58, 4000
    s_cbranch_scc1 L_spin_50_x
    s_cbranch_vccnz L_spin_50_l
L_spin_50_x:
    v_add_u32 v14, 0x10000, v14
    s_branch L_ok_49
L_spin_52:
    s_mov_b32 s58, 0
    s_waitcnt vmcnt(0)
    v_add_u32 v14, 0x0, v14
L_spin_52_l:
    s_add_u32 m0, s50, 131072
    s_xor_b32 s51, s63, 32768
    s_add_u32 s51, s51, 0xa04000
    buffer_load_dwordx4 v38, s[32:35], s51 offen offset:0 sc1 lds
    buffer_load_dwordx4 v38, s[32:35], s51 offen offset:1024 sc1 lds
    buffer_load_dwordx4 v38, s[32:35], s51 offen offset:2048 sc1 lds
    buffer_load_dwordx4 v38, s[32:35], s51 offen offset:3072 sc1 lds
    s_sub_u32 s52, s51, 0xa00000
    s_lshr_b32 s52, s52, 3
    s_add_u32 s52, s52, 0xd40000
    buffer_load_dwordx2 v[22:23], v35, s[32:35], s52 offen sc1
    s_add_u32 s58, s58, 1

    s_waitcnt vmcnt(0)
    ds_read_b128 v[40:43], v14 offset:0
    ds_read_b128 v[44:47], v14 offset:64
    ds_read_b128 v[48:51], v14 offset:16
    ds_read_b128 v[52:55], v14 offset:80
    s_waitcnt lgkmcnt(0)
    v_add3_u32 v22, v40, v41, v22
    v_add3_u32 v22, v42, v43, v22
    v_add3_u32 v22, v44, v45, v22
    v_add3_u32 v22, v46, v47, v22
    v_add3_u32 v23, v48, v49, v23
    v_add3_u32 v23, v50, v51, v23
    v_add3_u32 v23, v52, v53, v23
    v_add3_u32 v23, v54, v55, v23
    v_bitop3_b32 v22, v22, v23, s60 bitop3:0x7e
    v_cmp_ne_u32 vcc, 0, v22
    s_cmp_gt_u32 s58, 4000
    s_cbranch_scc1 L_spin_52_x
    s_cbranch_vccnz L_spin_52_l
L_spin_52_x:
    v_add_u32 v14, 0x0, v14
    s_branch L_ok_51
L_spin_54:
    s_mov_b32 s58, 0
    s_waitcnt vmcnt(0)
L_spin_54_l:
    buffer_load_dwordx4 v[192:195], v16, s[32:35], s69 offen offset:0 sc1
    buffer_load_dwordx4 v[196:199], v17, s[32:35], s69 offen offset:0 sc1
    buffer_load_dwordx4 v[200:203], v16, s[32:35], s69 offen offset:1024 sc1
    buffer_load_dwordx4 v[204:207], v17, s[32:35], s69 offen offset:1024 sc1
    buffer_load_dwordx4 v[208:211], v16, s[32:35], s69 offen offset:2048 sc1
    buffer_load_dwordx4 v[212:215], v17, s[32:35], s69 offen offset:2048 sc1
    buffer_load_dwordx4 v[216:219], v16, s[32:35], s69 offen offset:3072 sc1
    buffer_load_dwordx4 v[220:223], v17, s[32:35], s69 offen offset:3072 sc1
    buffer_load_dword v26, v18, s[32:35], s77 offen sc1
    buffer_load_dword v27, v19, s[32:35], s77 offen sc1
    buffer_load_dwordx4 v[224:227], v16, s[32:35], s70 offen offset:0 sc1
    buffer_load_dwordx4 v[228:231], v17, s[32:35], s70 offen offset:0 sc1
    buffer_load_dwordx4 v[232:235], v16, s[32:35], s70 offen offset:1024 sc1
    buffer_load_dwordx4 v[236:239], v17, s[32:35], s70 offen offset:1024 sc1
    buffer_load_dwordx4 v[240:243], v16, s[32:35], s70 offen offset:2048 sc1
    buffer_load_dwordx4 v[244:247], v17, s[32:35], s70 offen offset:2048 sc1
    buffer_load_dwordx4 v[248:251], v16, s[32:35], s70 offen offset:3072 sc1
    buffer_load_dwordx4 v[252:255], v17, s[32:35], s70 offen offset:3072 sc1
    buffer_load_dword v28, v18, s[32:35], s78 offen sc1
    buffer_load_dword v29, v19, s[32:35], s78 offen sc1
    s_add_u32 s58, s58, 1

    s_waitcnt vmcnt(0)
    v_add3_u32 v26, v192, v193, v26
    v_add3_u32 v26, v194, v195, v26
    v_add3_u32 v26, v200, v201, v26
    v_add3_u32 v26, v202, v203, v26
    v_add3_u32 v26, v208, v209, v26
    v_add3_u32 v26, v210, v211, v26
    v_add3_u32 v26, v216, v217, v26
    v_add3_u32 v26, v218, v219, v26
    v_add3_u32 v27, v196, v197, v27
    v_add3_u32 v27, v198, v199, v27
    v_add3_u32 v27, v204, v205, v27
    v_add3_u32 v27, v206, v207, v27
    v_add3_u32 v27, v212, v213, v27
    v_add3_u32 v27, v214, v215, v27
    v_add3_u32 v27, v220, v221, v27
    v_add3_u32 v27, v222, v223, v27
    v_bitop3_b32 v26, v26, v27, s60 bitop3:0x7e
    v_cmp_ne_u32 vcc, 0, v26
    s_cmp_gt_u32 s58, 4000
    s_cbranch_scc1 L_ok_53
    s_cbranch_vccnz L_spin_54_l
    s_branch L_ok_53
L_spin_56:
    s_mov_b32 s58, 0
    s_waitcnt vmcnt(0)
L_spin_56_l:
    buffer_load_dwordx4 v[224:227], v16, s[32:35], s70 offen offset:0 sc1
    buffer_load_dwordx4 v[228:231], v17, s[32:35], s70 offen offset:0 sc1
    buffer_load_dwordx4 v[232:235], v16, s[32:35], s70 offen offset:1024 sc1
    buffer_load_dwordx4 v[236:239], v17, s[32:35], s70 offen offset:1024 sc1
    buffer_load_dwordx4 v[240:243], v16, s[32:35], s70 offen offset:2048 sc1
    buffer_load_dwordx4 v[244:247], v17, s[32:35], s70 offen offset:2048 sc1
    buffer_load_dwordx4 v[248:251], v16, s[32:35], s70 offen offset:3072 sc1
    buffer_load_dwordx4 v[252:255], v17, s[32:35], s70 offen offset:3072 sc1
    buffer_load_dword v28, v18, s[32:35], s78 offen sc1
    buffer_load_dword v29, v19, s[32:35], s78 offen sc1
    s_add_u32 s58, s58, 1

    s_waitcnt vmcnt(0)
    v_add3_u32 v28, v224, v225, v28
    v_add3_u32 v28, v226, v227, v28
    v_add3_u32 v28, v232, v233, v28
    v_add3_u32 v28, v234, v235, v28
    v_add3_u32 v28, v240, v241, v28
    v_add3_u32 v28, v242, v243, v28
    v_add3_u32 v28, v248, v249, v28
    v_add3_u32 v28, v250, v251, v28
    v_add3_u32 v29, v228, v229, v29
    v_add3_u32 v29, v230, v231, v29
    v_add3_u32 v29, v236, v237, v29
    v_add3_u32 v29, v238, v239, v29
    v_add3_u32 v29, v244, v245, v29
    v_add3_u32 v29, v246, v247, v29
    v_add3_u32 v29, v252, v253, v29
    v_add3_u32 v29, v254, v255, v29
    v_bitop3_b32 v28, v28, v29, s60 bitop3:0x7e
    v_cmp_ne_u32 vcc, 0, v28
    s_cmp_gt_u32 s58, 4000
    s_cbranch_scc1 L_ok_55
    s_cbranch_vccnz L_spin_56_l
    s_branch L_ok_55
L_end:
    s_endpgm
.section .rodata,"a"
.p2align 6
.amdhsa_kernel parallel_sum__spectral_gfnet__glu_gated_bilinear__prompt_kernel
  .amdhsa_next_free_vgpr 512
  .amdhsa_next_free_sgpr 102
  .amdhsa_accum_offset 256
  .amdhsa_group_segment_fixed_size 0
  .amdhsa_kernarg_size 80
  .amdhsa_user_sgpr_count 2
  .amdhsa_user_sgpr_kernarg_segment_ptr 1
  .amdhsa_system_sgpr_workgroup_id_x 1
.end_amdhsa_kernel
```
